```python
import torch

def _softmax(x, axis=-1):
    return torch.softmax(x, dim=axis)
def _gelu(x):
    return torch.nn.functional.gelu(x, approximate="tanh")
def _silu(x):
    return torch.nn.functional.silu(x)
def _sigmoid(x):
    return torch.sigmoid(x)
def _layernorm(x, axis=-1, eps=1e-5):
    m = x.mean(dim=axis, keepdim=True)
    v = x.var(dim=axis, keepdim=True, unbiased=False)
    return (x - m) / torch.sqrt(v + eps)
def _scatter_add(tgt, idx, src, axis=0):
    return tgt.clone().index_add_(axis, idx, src)
def _segment_sum(src, seg, n):
    out = torch.zeros((n,) + src.shape[1:], dtype=src.dtype)
    return out.index_add_(0, seg, src)
def _pad(x, pw):
    flat = tuple(v for pair in reversed(pw) for v in pair)
    return torch.nn.functional.pad(x, flat)

kernel_name = 'concat_heads__mha_block_cached__gqa_block_cached__near_ridge'

def setup_inputs():

    _w = (lambda a: (lambda t: t.to(torch.bfloat16) if t.is_floating_point() else t)(torch.as_tensor(a)))
    def _A_setup():
        B, Sq, D = 8, 240, 512
        H, Sk, Dh = 32, 512, 128
        return {
            "x": _w((lambda *s: torch.randn(*s, dtype=torch.bfloat16) * 0.8)(B, Sq, D)),
            "k_cache": _w((lambda *s: torch.randn(*s, dtype=torch.bfloat16) * 0.8)(B, H, Sk, Dh)),
            "v_cache": _w((lambda *s: torch.randn(*s, dtype=torch.bfloat16) * 0.05)(B, H, Sk, Dh)),
            "wq": _w((lambda *s: torch.randn(*s, dtype=torch.bfloat16) * 0.8)(D, H * Dh) * (D ** -0.5)),
            "wo": _w((lambda *s: torch.randn(*s, dtype=torch.bfloat16) * 0.05)(H * Dh, D) * ((H * Dh) ** -0.5)),
        }
    _A_in = _A_setup()

    def _B_setup():
        B, Sq, D = 8, 240, 512
        Hq, Hkv, Sk, Dh = 32, 32, 512, 128
        assert Hq % Hkv == 0, (Hq, Hkv)
        return {
            "x": _w((lambda *s: torch.randn(*s, dtype=torch.bfloat16) * 0.8)(B, Sq, D)),
            "k_cache": _w((lambda *s: torch.randn(*s, dtype=torch.bfloat16) * 0.8)(B, Hkv, Sk, Dh)),
            "v_cache": _w((lambda *s: torch.randn(*s, dtype=torch.bfloat16) * 0.05)(B, Hkv, Sk, Dh)),
            "wq": _w((lambda *s: torch.randn(*s, dtype=torch.bfloat16) * 0.8)(D, Hq * Dh) * (D ** -0.5)),
            "wo": _w((lambda *s: torch.randn(*s, dtype=torch.bfloat16) * 0.05)(Hq * Dh, D) * ((Hq * Dh) ** -0.5)),
        }
    _B_in = _B_setup()

    return {
        "A_x": _A_in["x"],
        "A_k_cache": _A_in["k_cache"],
        "A_v_cache": _A_in["v_cache"],
        "A_wq": _A_in["wq"],
        "A_wo": _A_in["wo"],
        "B_x": _B_in["x"],
        "B_k_cache": _B_in["k_cache"],
        "B_v_cache": _B_in["v_cache"],
        "B_wq": _B_in["wq"],
        "B_wo": _B_in["wo"],
    }

def reference(A_x, A_k_cache, A_v_cache, A_wq, A_wo, B_x, B_k_cache, B_v_cache, B_wq, B_wo):
    def _A_ref(x, k_cache, v_cache, wq, wo):
        B, Sq, D = x.shape
        H, Dh = 32, 128
        q = (lambda x, *d: x.permute(*d))((x @ wq).reshape(B, Sq, H, Dh), 0, 2, 1, 3)
        scores = torch.einsum("bhqd,bhkd->bhqk", q, k_cache) * (Dh ** -0.5)
        p = _softmax(scores, axis=-1)
        o = torch.einsum("bhqk,bhkd->bhqd", p, v_cache)
        return (lambda x, *d: x.permute(*d))(o, 0, 2, 1, 3).reshape(B, Sq, H * Dh) @ wo

    def _B_ref(x, k_cache, v_cache, wq, wo):
        B, Sq, D = x.shape
        Hq, Dh = 32, 128
        Hkv = k_cache.shape[1]
        rep = Hq // Hkv
        q = (lambda x, *d: x.permute(*d))((x @ wq).reshape(B, Sq, Hq, Dh), 0, 2, 1, 3)
        k = (lambda x, n, axis: torch.repeat_interleave(x, n, dim=axis))(k_cache, rep, axis=1)
        v = (lambda x, n, axis: torch.repeat_interleave(x, n, dim=axis))(v_cache, rep, axis=1)
        scores = torch.einsum("bhqd,bhkd->bhqk", q, k) * (Dh ** -0.5)
        p = _softmax(scores, axis=-1)
        o = torch.einsum("bhqk,bhkd->bhqd", p, v)
        return (lambda x, *d: x.permute(*d))(o, 0, 2, 1, 3).reshape(B, Sq, Hq * Dh) @ wo

    a = _A_ref(A_x, A_k_cache, A_v_cache, A_wq, A_wo)
    b = _B_ref(B_x, B_k_cache, B_v_cache, B_wq, B_wo)
    return torch.concatenate([a, b], axis=-1)
```

```asm
; @launch kernel=attn_kernel grid=(256,1,1) block=(512,1,1) lds=163840
; @launch kernel=reduce_kernel grid=(1024,1,1) block=(256,1,1) lds=0
.amdgcn_target "amdgcn-amd-amdhsa--gfx950"
.text
.globl attn_kernel
.p2align 8
.type attn_kernel,@function
attn_kernel:
    s_cmp_ge_u32 s2, 256
    s_cbranch_scc1 L_k1_end
    s_load_dwordx16 s[16:31], s[0:1], 0
    s_load_dwordx4 s[32:35], s[0:1], 64
    s_load_dwordx2 s[36:37], s[0:1], 96
    s_and_b32 s3, s2, 7
    s_lshr_b32 s4, s2, 3
    s_lshr_b32 s64, s3, 2
    s_and_b32 s3, s3, 3
    s_lshl_b32 s3, s3, 1
    s_lshr_b32 s5, s4, 4
    s_add_u32 s65, s3, s5
    s_and_b32 s66, s4, 15
    v_lshrrev_b32 v250, 6, v0
    v_and_b32 v0, 63, v0
    v_readfirstlane_b32 s3, v250
    v_lshrrev_b32 v251, 5, v0
    v_lshl_add_u32 v252, v250, 1, v251
    v_and_b32 v253, 3, v252
    v_lshlrev_b32 v253, 2, v253
    v_and_b32 v254, 31, v0
    v_xor_b32 v253, v253, v254
    v_lshlrev_b32 v253, 4, v253
    v_lshl_add_u32 v247, v252, 13, v253
    v_lshl_add_u32 v252, v250, 5, v254
    v_lshlrev_b32 v253, 4, v251
    v_lshl_add_u32 v248, v252, 10, v253
    s_lshl_b32 s67, s3, 10
    s_mul_i32 s68, s65, 245760
    s_lshl_b32 s70, s66, 9
    s_waitcnt lgkmcnt(0)
    s_cmp_eq_u32 s64, 0
    s_cselect_b64 s[56:57], s[22:23], s[32:33]
    s_cselect_b64 s[44:45], s[16:17], s[26:27]
    s_cselect_b64 s[48:49], s[18:19], s[28:29]
    s_cselect_b64 s[52:53], s[20:21], s[30:31]
    s_cselect_b64 s[88:89], s[24:25], s[34:35]
    s_mov_b64 s[60:61], s[36:37]
    s_mov_b32 s58, 4194304
    s_mov_b32 s59, 0x20000
    s_mov_b32 s46, 1966080
    s_mov_b32 s47, 0x20000
    s_mov_b32 s50, 33554432
    s_mov_b32 s51, 0x20000
    s_mov_b32 s54, 33554432
    s_mov_b32 s55, 0x20000
    s_mov_b32 s62, 67108864
    s_mov_b32 s63, 0x20000
    s_mov_b32 s90, 4194304
    s_mov_b32 s91, 0x20000
    s_add_u32 m0, s67, 98304
    s_add_u32 s71, s70, 0
    buffer_load_dwordx4 v247, s[56:59], s71 offen  lds
    s_add_u32 m0, s67, 106496
    s_add_u32 s71, s70, 131072
    buffer_load_dwordx4 v247, s[56:59], s71 offen  lds
    s_add_u32 m0, s67, 114688
    s_add_u32 s71, s70, 262144
    buffer_load_dwordx4 v247, s[56:59], s71 offen  lds
    s_add_u32 m0, s67, 122880
    s_add_u32 s71, s70, 393216
    buffer_load_dwordx4 v247, s[56:59], s71 offen  lds
    buffer_load_dwordx4 v[64:67], v248, s[44:47], s68 offen offset:0
    buffer_load_dwordx4 v[68:71], v248, s[44:47], s68 offen offset:32
    buffer_load_dwordx4 v[72:75], v248, s[44:47], s68 offen offset:64
    buffer_load_dwordx4 v[76:79], v248, s[44:47], s68 offen offset:96
    s_lshl_b32 s4, s65, 5
    s_lshl_b32 s5, s66, 1
    s_add_u32 s4, s4, s5
    s_lshl_b32 s69, s4, 17
    s_mov_b32 s72, 0
    s_mov_b32 s73, 0x3e0293ee
    s_mov_b32 s74, 0x41000000
    s_lshl_b32 s4, s64, 3
    s_add_u32 s4, s4, s65
    s_lshl_b32 s4, s4, 4
    s_add_u32 s4, s4, s66
    s_lshl_b32 s4, s4, 3
    s_add_u32 s4, s4, s3
    s_lshl_b32 s75, s4, 15
    s_lshl_b32 s77, s66, 18
    v_lshrrev_b32 v252, 4, v0
    v_lshl_add_u32 v253, v250, 2, v252
    v_and_b32 v255, 15, v0
    v_xor_b32 v236, v253, v255
    v_and_b32 v236, 15, v236
    v_lshlrev_b32 v236, 4, v236
    v_lshl_add_u32 v236, v253, 8, v236
    v_lshlrev_b32 v237, 2, v252
    v_xor_b32 v237, v237, v255
    v_lshlrev_b32 v237, 4, v237
    v_lshl_add_u32 v249, v253, 10, v237
    v_lshl_add_u32 v237, v253, 8, v237
    v_bfe_u32 v252, v0, 2, 2
    v_bfe_u32 v253, v0, 4, 1
    v_and_b32 v255, 1, v0
    v_lshl_add_u32 v253, v253, 1, v255
    v_lshlrev_b32 v253, 4, v253
    v_bfe_u32 v255, v0, 1, 1
    v_lshl_add_u32 v253, v255, 3, v253
    v_lshl_add_u32 v255, v251, 2, v252
    v_lshl_add_u32 v255, v255, 8, v253
    v_add_u32 v255, 0x10000, v255
    v_xor_b32 v232, 0, v252
    v_lshl_add_u32 v232, v232, 6, v255
    v_xor_b32 v233, 1, v252
    v_lshl_add_u32 v233, v233, 6, v255
    v_xor_b32 v234, 2, v252
    v_lshl_add_u32 v234, v234, 6, v255
    v_xor_b32 v235, 3, v252
    v_lshl_add_u32 v235, v235, 6, v255
    v_lshl_add_u32 v255, v251, 3, v252
    v_lshl_add_u32 v255, v255, 9, v253
    v_add_u32 v255, 0x10000, v255
    v_xor_b32 v238, 0, v252
    v_lshl_add_u32 v238, v238, 6, v255
    v_add_u32 v242, 0x10000, v238
    v_xor_b32 v239, 1, v252
    v_lshl_add_u32 v239, v239, 6, v255
    v_add_u32 v243, 0x10000, v239
    v_xor_b32 v240, 2, v252
    v_lshl_add_u32 v240, v240, 6, v255
    v_add_u32 v244, 0x10000, v240
    v_xor_b32 v241, 3, v252
    v_lshl_add_u32 v241, v241, 6, v255
    v_add_u32 v245, 0x10000, v241
    v_and_b32 v255, 15, v254
    v_xor_b32 v255, v255, v251
    v_lshlrev_b32 v255, 4, v255
    v_lshl_add_u32 v255, v254, 8, v255
    v_xor_b32 v224, 0, v255
    v_xor_b32 v225, 32, v255
    v_xor_b32 v226, 64, v255
    v_xor_b32 v227, 96, v255
    v_xor_b32 v228, 128, v255
    v_xor_b32 v229, 160, v255
    v_xor_b32 v230, 192, v255
    v_xor_b32 v231, 224, v255
    v_lshlrev_b32 v246, 4, v0
    s_waitcnt vmcnt(4) lgkmcnt(0)
    s_barrier
    ds_read_b64_tr_b16 v[192:193], v238 offset:32768
    ds_read_b64_tr_b16 v[194:195], v238 offset:34816
    ds_read_b64_tr_b16 v[196:197], v239 offset:32768
    ds_read_b64_tr_b16 v[198:199], v239 offset:34816
    ds_read_b64_tr_b16 v[200:201], v240 offset:32768
    ds_read_b64_tr_b16 v[202:203], v240 offset:34816
    ds_read_b64_tr_b16 v[204:205], v241 offset:32768
    ds_read_b64_tr_b16 v[206:207], v241 offset:34816
    ds_read_b64_tr_b16 v[208:209], v238 offset:33024
    ds_read_b64_tr_b16 v[210:211], v238 offset:35072
    ds_read_b64_tr_b16 v[212:213], v239 offset:33024
    ds_read_b64_tr_b16 v[214:215], v239 offset:35072
    s_add_u32 m0, s67, 131072
    s_add_u32 s71, s70, 524288
    buffer_load_dwordx4 v247, s[56:59], s71 offen  lds
    s_add_u32 m0, s67, 139264
    s_add_u32 s71, s70, 655360
    buffer_load_dwordx4 v247, s[56:59], s71 offen  lds
    s_add_u32 m0, s67, 147456
    s_add_u32 s71, s70, 786432
    buffer_load_dwordx4 v247, s[56:59], s71 offen  lds
    s_add_u32 m0, s67, 155648
    s_add_u32 s71, s70, 917504
    buffer_load_dwordx4 v247, s[56:59], s71 offen  lds
    buffer_load_dwordx4 v[80:83], v248, s[44:47], s68 offen offset:128
    buffer_load_dwordx4 v[84:87], v248, s[44:47], s68 offen offset:160
    buffer_load_dwordx4 v[88:91], v248, s[44:47], s68 offen offset:192
    buffer_load_dwordx4 v[92:95], v248, s[44:47], s68 offen offset:224
    s_add_u32 m0, s67, 65536
    s_add_u32 s71, s70, 1048576
    buffer_load_dwordx4 v247, s[56:59], s71 offen  lds
    s_add_u32 m0, s67, 73728
    s_add_u32 s71, s70, 1179648
    buffer_load_dwordx4 v247, s[56:59], s71 offen  lds
    s_add_u32 m0, s67, 81920
    s_add_u32 s71, s70, 1310720
    buffer_load_dwordx4 v247, s[56:59], s71 offen  lds
    s_add_u32 m0, s67, 90112
    s_add_u32 s71, s70, 1441792
    buffer_load_dwordx4 v247, s[56:59], s71 offen  lds
    buffer_load_dwordx4 v[96:99], v248, s[44:47], s68 offen offset:256
    buffer_load_dwordx4 v[100:103], v248, s[44:47], s68 offen offset:288
    buffer_load_dwordx4 v[104:107], v248, s[44:47], s68 offen offset:320
    buffer_load_dwordx4 v[108:111], v248, s[44:47], s68 offen offset:352
    ds_read_b64_tr_b16 v[216:217], v240 offset:33024
    ds_read_b64_tr_b16 v[218:219], v240 offset:35072
    s_waitcnt vmcnt(19) lgkmcnt(12)
    v_mfma_f32_32x32x16_bf16 v[128:143], v[192:195], v[64:67], 0
    ds_read_b64_tr_b16 v[220:221], v241 offset:33024
    ds_read_b64_tr_b16 v[222:223], v241 offset:35072
    s_waitcnt lgkmcnt(12)
    v_mfma_f32_32x32x16_bf16 v[144:159], v[196:199], v[64:67], 0
    ds_read_b64_tr_b16 v[192:193], v238 offset:40960
    ds_read_b64_tr_b16 v[194:195], v238 offset:43008
    s_waitcnt lgkmcnt(12)
    v_mfma_f32_32x32x16_bf16 v[160:175], v[200:203], v[64:67], 0
    ds_read_b64_tr_b16 v[196:197], v239 offset:40960
    ds_read_b64_tr_b16 v[198:199], v239 offset:43008
    s_waitcnt lgkmcnt(12)
    v_mfma_f32_32x32x16_bf16 v[176:191], v[204:207], v[64:67], 0
    ds_read_b64_tr_b16 v[200:201], v240 offset:40960
    ds_read_b64_tr_b16 v[202:203], v240 offset:43008
    s_waitcnt lgkmcnt(12)
    v_mfma_f32_32x32x16_bf16 v[0:15], v[208:211], v[64:67], 0
    ds_read_b64_tr_b16 v[204:205], v241 offset:40960
    ds_read_b64_tr_b16 v[206:207], v241 offset:43008
    s_waitcnt lgkmcnt(12)
    v_mfma_f32_32x32x16_bf16 v[16:31], v[212:215], v[64:67], 0
    ds_read_b64_tr_b16 v[208:209], v238 offset:41216
    ds_read_b64_tr_b16 v[210:211], v238 offset:43264
    s_waitcnt lgkmcnt(12)
    v_mfma_f32_32x32x16_bf16 v[32:47], v[216:219], v[64:67], 0
    ds_read_b64_tr_b16 v[212:213], v239 offset:41216
    ds_read_b64_tr_b16 v[214:215], v239 offset:43264
    s_waitcnt lgkmcnt(12)
    v_mfma_f32_32x32x16_bf16 v[48:63], v[220:223], v[64:67], 0
    ds_read_b64_tr_b16 v[216:217], v240 offset:41216
    ds_read_b64_tr_b16 v[218:219], v240 offset:43264
    s_waitcnt vmcnt(18) lgkmcnt(12)
    v_mfma_f32_32x32x16_bf16 v[128:143], v[192:195], v[68:71], v[128:143]
    ds_read_b64_tr_b16 v[220:221], v241 offset:41216
    ds_read_b64_tr_b16 v[222:223], v241 offset:43264
    s_waitcnt lgkmcnt(12)
    v_mfma_f32_32x32x16_bf16 v[144:159], v[196:199], v[68:71], v[144:159]
    ds_read_b64_tr_b16 v[192:193], v238 offset:49152
    ds_read_b64_tr_b16 v[194:195], v238 offset:51200
    s_waitcnt lgkmcnt(12)
    v_mfma_f32_32x32x16_bf16 v[160:175], v[200:203], v[68:71], v[160:175]
    ds_read_b64_tr_b16 v[196:197], v239 offset:49152
    ds_read_b64_tr_b16 v[198:199], v239 offset:51200
    s_waitcnt lgkmcnt(12)
    v_mfma_f32_32x32x16_bf16 v[176:191], v[204:207], v[68:71], v[176:191]
    ds_read_b64_tr_b16 v[200:201], v240 offset:49152
    ds_read_b64_tr_b16 v[202:203], v240 offset:51200
    s_waitcnt lgkmcnt(12)
    v_mfma_f32_32x32x16_bf16 v[0:15], v[208:211], v[68:71], v[0:15]
    ds_read_b64_tr_b16 v[204:205], v241 offset:49152
    ds_read_b64_tr_b16 v[206:207], v241 offset:51200
    s_waitcnt lgkmcnt(12)
    v_mfma_f32_32x32x16_bf16 v[16:31], v[212:215], v[68:71], v[16:31]
    ds_read_b64_tr_b16 v[208:209], v238 offset:49408
    ds_read_b64_tr_b16 v[210:211], v238 offset:51456
    s_waitcnt lgkmcnt(12)
    v_mfma_f32_32x32x16_bf16 v[32:47], v[216:219], v[68:71], v[32:47]
    ds_read_b64_tr_b16 v[212:213], v239 offset:49408
    ds_read_b64_tr_b16 v[214:215], v239 offset:51456
    s_waitcnt lgkmcnt(12)
    v_mfma_f32_32x32x16_bf16 v[48:63], v[220:223], v[68:71], v[48:63]
    ds_read_b64_tr_b16 v[216:217], v240 offset:49408
    ds_read_b64_tr_b16 v[218:219], v240 offset:51456
    s_waitcnt vmcnt(17) lgkmcnt(12)
    v_mfma_f32_32x32x16_bf16 v[128:143], v[192:195], v[72:75], v[128:143]
    ds_read_b64_tr_b16 v[220:221], v241 offset:49408
    ds_read_b64_tr_b16 v[222:223], v241 offset:51456
    s_waitcnt lgkmcnt(12)
    v_mfma_f32_32x32x16_bf16 v[144:159], v[196:199], v[72:75], v[144:159]
    ds_read_b64_tr_b16 v[192:193], v238 offset:57344
    ds_read_b64_tr_b16 v[194:195], v238 offset:59392
    s_waitcnt lgkmcnt(12)
    v_mfma_f32_32x32x16_bf16 v[160:175], v[200:203], v[72:75], v[160:175]
    ds_read_b64_tr_b16 v[196:197], v239 offset:57344
    ds_read_b64_tr_b16 v[198:199], v239 offset:59392
    s_waitcnt lgkmcnt(12)
    v_mfma_f32_32x32x16_bf16 v[176:191], v[204:207], v[72:75], v[176:191]
    ds_read_b64_tr_b16 v[200:201], v240 offset:57344
    ds_read_b64_tr_b16 v[202:203], v240 offset:59392
    s_waitcnt lgkmcnt(12)
    v_mfma_f32_32x32x16_bf16 v[0:15], v[208:211], v[72:75], v[0:15]
    ds_read_b64_tr_b16 v[204:205], v241 offset:57344
    ds_read_b64_tr_b16 v[206:207], v241 offset:59392
    s_waitcnt lgkmcnt(12)
    v_mfma_f32_32x32x16_bf16 v[16:31], v[212:215], v[72:75], v[16:31]
    ds_read_b64_tr_b16 v[208:209], v238 offset:57600
    ds_read_b64_tr_b16 v[210:211], v238 offset:59648
    s_waitcnt lgkmcnt(12)
    v_mfma_f32_32x32x16_bf16 v[32:47], v[216:219], v[72:75], v[32:47]
    ds_read_b64_tr_b16 v[212:213], v239 offset:57600
    ds_read_b64_tr_b16 v[214:215], v239 offset:59648
    s_waitcnt lgkmcnt(12)
    v_mfma_f32_32x32x16_bf16 v[48:63], v[220:223], v[72:75], v[48:63]
    ds_read_b64_tr_b16 v[216:217], v240 offset:57600
    ds_read_b64_tr_b16 v[218:219], v240 offset:59648
    s_waitcnt vmcnt(16) lgkmcnt(12)
    v_mfma_f32_32x32x16_bf16 v[128:143], v[192:195], v[76:79], v[128:143]
    ds_read_b64_tr_b16 v[220:221], v241 offset:57600
    ds_read_b64_tr_b16 v[222:223], v241 offset:59648
    s_waitcnt lgkmcnt(12)
    v_mfma_f32_32x32x16_bf16 v[144:159], v[196:199], v[76:79], v[144:159]
    s_waitcnt vmcnt(12) lgkmcnt(0)
    s_barrier
    s_add_u32 m0, s67, 98304
    s_add_u32 s71, s70, 1572864
    buffer_load_dwordx4 v247, s[56:59], s71 offen  lds
    s_add_u32 m0, s67, 106496
    s_add_u32 s71, s70, 1703936
    buffer_load_dwordx4 v247, s[56:59], s71 offen  lds
    s_add_u32 m0, s67, 114688
    s_add_u32 s71, s70, 1835008
    buffer_load_dwordx4 v247, s[56:59], s71 offen  lds
    s_add_u32 m0, s67, 122880
    s_add_u32 s71, s70, 1966080
    buffer_load_dwordx4 v247, s[56:59], s71 offen  lds
    buffer_load_dwordx4 v[112:115], v248, s[44:47], s68 offen offset:384
    buffer_load_dwordx4 v[116:119], v248, s[44:47], s68 offen offset:416
    buffer_load_dwordx4 v[120:123], v248, s[44:47], s68 offen offset:448
    buffer_load_dwordx4 v[124:127], v248, s[44:47], s68 offen offset:480
    s_add_u32 m0, s67, 0
    s_add_u32 s71, s69, 0
    buffer_load_dwordx4 v236, s[48:51], s71 offen sc1 nt lds
    s_add_u32 m0, s67, 8192
    s_add_u32 s71, s69, 8192
    buffer_load_dwordx4 v236, s[48:51], s71 offen sc1 nt lds
    ds_read_b64_tr_b16 v[192:193], v242 offset:0
    ds_read_b64_tr_b16 v[194:195], v242 offset:2048
    v_mfma_f32_32x32x16_bf16 v[160:175], v[200:203], v[76:79], v[160:175]
    ds_read_b64_tr_b16 v[196:197], v243 offset:0
    ds_read_b64_tr_b16 v[198:199], v243 offset:2048
    v_mfma_f32_32x32x16_bf16 v[176:191], v[204:207], v[76:79], v[176:191]
    ds_read_b64_tr_b16 v[200:201], v244 offset:0
    ds_read_b64_tr_b16 v[202:203], v244 offset:2048
    v_mfma_f32_32x32x16_bf16 v[0:15], v[208:211], v[76:79], v[0:15]
    ds_read_b64_tr_b16 v[204:205], v245 offset:0
    ds_read_b64_tr_b16 v[206:207], v245 offset:2048
    v_mfma_f32_32x32x16_bf16 v[16:31], v[212:215], v[76:79], v[16:31]
    ds_read_b64_tr_b16 v[208:209], v242 offset:256
    ds_read_b64_tr_b16 v[210:211], v242 offset:2304
    v_mfma_f32_32x32x16_bf16 v[32:47], v[216:219], v[76:79], v[32:47]
    ds_read_b64_tr_b16 v[212:213], v243 offset:256
    ds_read_b64_tr_b16 v[214:215], v243 offset:2304
    v_mfma_f32_32x32x16_bf16 v[48:63], v[220:223], v[76:79], v[48:63]
    ds_read_b64_tr_b16 v[216:217], v244 offset:256
    ds_read_b64_tr_b16 v[218:219], v244 offset:2304
    s_waitcnt vmcnt(21) lgkmcnt(12)
    v_mfma_f32_32x32x16_bf16 v[128:143], v[192:195], v[80:83], v[128:143]
    ds_read_b64_tr_b16 v[220:221], v245 offset:256
    ds_read_b64_tr_b16 v[222:223], v245 offset:2304
    s_waitcnt lgkmcnt(12)
    v_mfma_f32_32x32x16_bf16 v[144:159], v[196:199], v[80:83], v[144:159]
    ds_read_b64_tr_b16 v[192:193], v242 offset:8192
    ds_read_b64_tr_b16 v[194:195], v242 offset:10240
    s_waitcnt lgkmcnt(12)
    v_mfma_f32_32x32x16_bf16 v[160:175], v[200:203], v[80:83], v[160:175]
    ds_read_b64_tr_b16 v[196:197], v243 offset:8192
    ds_read_b64_tr_b16 v[198:199], v243 offset:10240
    s_waitcnt lgkmcnt(12)
    v_mfma_f32_32x32x16_bf16 v[176:191], v[204:207], v[80:83], v[176:191]
    ds_read_b64_tr_b16 v[200:201], v244 offset:8192
    ds_read_b64_tr_b16 v[202:203], v244 offset:10240
    s_waitcnt lgkmcnt(12)
    v_mfma_f32_32x32x16_bf16 v[0:15], v[208:211], v[80:83], v[0:15]
    ds_read_b64_tr_b16 v[204:205], v245 offset:8192
    ds_read_b64_tr_b16 v[206:207], v245 offset:10240
    s_waitcnt lgkmcnt(12)
    v_mfma_f32_32x32x16_bf16 v[16:31], v[212:215], v[80:83], v[16:31]
    ds_read_b64_tr_b16 v[208:209], v242 offset:8448
    ds_read_b64_tr_b16 v[210:211], v242 offset:10496
    s_waitcnt lgkmcnt(12)
    v_mfma_f32_32x32x16_bf16 v[32:47], v[216:219], v[80:83], v[32:47]
    ds_read_b64_tr_b16 v[212:213], v243 offset:8448
    ds_read_b64_tr_b16 v[214:215], v243 offset:10496
    s_waitcnt lgkmcnt(12)
    v_mfma_f32_32x32x16_bf16 v[48:63], v[220:223], v[80:83], v[48:63]
    ds_read_b64_tr_b16 v[216:217], v244 offset:8448
    ds_read_b64_tr_b16 v[218:219], v244 offset:10496
    s_waitcnt vmcnt(20) lgkmcnt(12)
    v_mfma_f32_32x32x16_bf16 v[128:143], v[192:195], v[84:87], v[128:143]
    ds_read_b64_tr_b16 v[220:221], v245 offset:8448
    ds_read_b64_tr_b16 v[222:223], v245 offset:10496
    s_waitcnt lgkmcnt(12)
    v_mfma_f32_32x32x16_bf16 v[144:159], v[196:199], v[84:87], v[144:159]
    ds_read_b64_tr_b16 v[192:193], v242 offset:16384
    ds_read_b64_tr_b16 v[194:195], v242 offset:18432
    s_waitcnt lgkmcnt(12)
    v_mfma_f32_32x32x16_bf16 v[160:175], v[200:203], v[84:87], v[160:175]
    ds_read_b64_tr_b16 v[196:197], v243 offset:16384
    ds_read_b64_tr_b16 v[198:199], v243 offset:18432
    s_waitcnt lgkmcnt(12)
    v_mfma_f32_32x32x16_bf16 v[176:191], v[204:207], v[84:87], v[176:191]
    ds_read_b64_tr_b16 v[200:201], v244 offset:16384
    ds_read_b64_tr_b16 v[202:203], v244 offset:18432
    s_waitcnt lgkmcnt(12)
    v_mfma_f32_32x32x16_bf16 v[0:15], v[208:211], v[84:87], v[0:15]
    ds_read_b64_tr_b16 v[204:205], v245 offset:16384
    ds_read_b64_tr_b16 v[206:207], v245 offset:18432
    s_waitcnt lgkmcnt(12)
    v_mfma_f32_32x32x16_bf16 v[16:31], v[212:215], v[84:87], v[16:31]
    ds_read_b64_tr_b16 v[208:209], v242 offset:16640
    ds_read_b64_tr_b16 v[210:211], v242 offset:18688
    s_waitcnt lgkmcnt(12)
    v_mfma_f32_32x32x16_bf16 v[32:47], v[216:219], v[84:87], v[32:47]
    ds_read_b64_tr_b16 v[212:213], v243 offset:16640
    ds_read_b64_tr_b16 v[214:215], v243 offset:18688
    s_waitcnt lgkmcnt(12)
    v_mfma_f32_32x32x16_bf16 v[48:63], v[220:223], v[84:87], v[48:63]
    ds_read_b64_tr_b16 v[216:217], v244 offset:16640
    ds_read_b64_tr_b16 v[218:219], v244 offset:18688
    s_waitcnt vmcnt(19) lgkmcnt(12)
    v_mfma_f32_32x32x16_bf16 v[128:143], v[192:195], v[88:91], v[128:143]
    ds_read_b64_tr_b16 v[220:221], v245 offset:16640
    ds_read_b64_tr_b16 v[222:223], v245 offset:18688
    s_waitcnt lgkmcnt(12)
    v_mfma_f32_32x32x16_bf16 v[144:159], v[196:199], v[88:91], v[144:159]
    ds_read_b64_tr_b16 v[192:193], v242 offset:24576
    ds_read_b64_tr_b16 v[194:195], v242 offset:26624
    s_waitcnt lgkmcnt(12)
    v_mfma_f32_32x32x16_bf16 v[160:175], v[200:203], v[88:91], v[160:175]
    ds_read_b64_tr_b16 v[196:197], v243 offset:24576
    ds_read_b64_tr_b16 v[198:199], v243 offset:26624
    s_waitcnt lgkmcnt(12)
    v_mfma_f32_32x32x16_bf16 v[176:191], v[204:207], v[88:91], v[176:191]
    ds_read_b64_tr_b16 v[200:201], v244 offset:24576
    ds_read_b64_tr_b16 v[202:203], v244 offset:26624
    s_waitcnt lgkmcnt(12)
    v_mfma_f32_32x32x16_bf16 v[0:15], v[208:211], v[88:91], v[0:15]
    ds_read_b64_tr_b16 v[204:205], v245 offset:24576
    ds_read_b64_tr_b16 v[206:207], v245 offset:26624
    s_waitcnt lgkmcnt(12)
    v_mfma_f32_32x32x16_bf16 v[16:31], v[212:215], v[88:91], v[16:31]
    ds_read_b64_tr_b16 v[208:209], v242 offset:24832
    ds_read_b64_tr_b16 v[210:211], v242 offset:26880
    s_waitcnt lgkmcnt(12)
    v_mfma_f32_32x32x16_bf16 v[32:47], v[216:219], v[88:91], v[32:47]
    ds_read_b64_tr_b16 v[212:213], v243 offset:24832
    ds_read_b64_tr_b16 v[214:215], v243 offset:26880
    s_waitcnt lgkmcnt(12)
    v_mfma_f32_32x32x16_bf16 v[48:63], v[220:223], v[88:91], v[48:63]
    ds_read_b64_tr_b16 v[216:217], v244 offset:24832
    ds_read_b64_tr_b16 v[218:219], v244 offset:26880
    s_waitcnt vmcnt(18) lgkmcnt(12)
    v_mfma_f32_32x32x16_bf16 v[128:143], v[192:195], v[92:95], v[128:143]
    ds_read_b64_tr_b16 v[220:221], v245 offset:24832
    ds_read_b64_tr_b16 v[222:223], v245 offset:26880
    s_waitcnt lgkmcnt(12)
    v_mfma_f32_32x32x16_bf16 v[144:159], v[196:199], v[92:95], v[144:159]
    s_waitcnt vmcnt(14) lgkmcnt(0)
    s_barrier
    s_add_u32 m0, s67, 131072
    s_add_u32 s71, s70, 2097152
    buffer_load_dwordx4 v247, s[56:59], s71 offen  lds
    s_add_u32 m0, s67, 139264
    s_add_u32 s71, s70, 2228224
    buffer_load_dwordx4 v247, s[56:59], s71 offen  lds
    s_add_u32 m0, s67, 147456
    s_add_u32 s71, s70, 2359296
    buffer_load_dwordx4 v247, s[56:59], s71 offen  lds
    s_add_u32 m0, s67, 155648
    s_add_u32 s71, s70, 2490368
    buffer_load_dwordx4 v247, s[56:59], s71 offen  lds
    buffer_load_dwordx4 v[64:67], v248, s[44:47], s68 offen offset:512
    buffer_load_dwordx4 v[68:71], v248, s[44:47], s68 offen offset:544
    buffer_load_dwordx4 v[72:75], v248, s[44:47], s68 offen offset:576
    buffer_load_dwordx4 v[76:79], v248, s[44:47], s68 offen offset:608
    s_add_u32 m0, s67, 16384
    s_add_u32 s71, s69, 16384
    buffer_load_dwordx4 v236, s[48:51], s71 offen sc1 nt lds
    s_add_u32 m0, s67, 24576
    s_add_u32 s71, s69, 24576
    buffer_load_dwordx4 v236, s[48:51], s71 offen sc1 nt lds
    ds_read_b64_tr_b16 v[192:193], v238 offset:0
    ds_read_b64_tr_b16 v[194:195], v238 offset:2048
    v_mfma_f32_32x32x16_bf16 v[160:175], v[200:203], v[92:95], v[160:175]
    ds_read_b64_tr_b16 v[196:197], v239 offset:0
    ds_read_b64_tr_b16 v[198:199], v239 offset:2048
    v_mfma_f32_32x32x16_bf16 v[176:191], v[204:207], v[92:95], v[176:191]
    ds_read_b64_tr_b16 v[200:201], v240 offset:0
    ds_read_b64_tr_b16 v[202:203], v240 offset:2048
    v_mfma_f32_32x32x16_bf16 v[0:15], v[208:211], v[92:95], v[0:15]
    ds_read_b64_tr_b16 v[204:205], v241 offset:0
    ds_read_b64_tr_b16 v[206:207], v241 offset:2048
    v_mfma_f32_32x32x16_bf16 v[16:31], v[212:215], v[92:95], v[16:31]
    ds_read_b64_tr_b16 v[208:209], v238 offset:256
    ds_read_b64_tr_b16 v[210:211], v238 offset:2304
    v_mfma_f32_32x32x16_bf16 v[32:47], v[216:219], v[92:95], v[32:47]
    ds_read_b64_tr_b16 v[212:213], v239 offset:256
    ds_read_b64_tr_b16 v[214:215], v239 offset:2304
    v_mfma_f32_32x32x16_bf16 v[48:63], v[220:223], v[92:95], v[48:63]
    ds_read_b64_tr_b16 v[216:217], v240 offset:256
    ds_read_b64_tr_b16 v[218:219], v240 offset:2304
    s_waitcnt vmcnt(23) lgkmcnt(12)
    v_mfma_f32_32x32x16_bf16 v[128:143], v[192:195], v[96:99], v[128:143]
    ds_read_b64_tr_b16 v[220:221], v241 offset:256
    ds_read_b64_tr_b16 v[222:223], v241 offset:2304
    s_waitcnt lgkmcnt(12)
    v_mfma_f32_32x32x16_bf16 v[144:159], v[196:199], v[96:99], v[144:159]
    ds_read_b64_tr_b16 v[192:193], v238 offset:8192
    ds_read_b64_tr_b16 v[194:195], v238 offset:10240
    s_waitcnt lgkmcnt(12)
    v_mfma_f32_32x32x16_bf16 v[160:175], v[200:203], v[96:99], v[160:175]
    ds_read_b64_tr_b16 v[196:197], v239 offset:8192
    ds_read_b64_tr_b16 v[198:199], v239 offset:10240
    s_waitcnt lgkmcnt(12)
    v_mfma_f32_32x32x16_bf16 v[176:191], v[204:207], v[96:99], v[176:191]
    ds_read_b64_tr_b16 v[200:201], v240 offset:8192
    ds_read_b64_tr_b16 v[202:203], v240 offset:10240
    s_waitcnt lgkmcnt(12)
    v_mfma_f32_32x32x16_bf16 v[0:15], v[208:211], v[96:99], v[0:15]
    ds_read_b64_tr_b16 v[204:205], v241 offset:8192
    ds_read_b64_tr_b16 v[206:207], v241 offset:10240
    s_waitcnt lgkmcnt(12)
    v_mfma_f32_32x32x16_bf16 v[16:31], v[212:215], v[96:99], v[16:31]
    ds_read_b64_tr_b16 v[208:209], v238 offset:8448
    ds_read_b64_tr_b16 v[210:211], v238 offset:10496
    s_waitcnt lgkmcnt(12)
    v_mfma_f32_32x32x16_bf16 v[32:47], v[216:219], v[96:99], v[32:47]
    ds_read_b64_tr_b16 v[212:213], v239 offset:8448
    ds_read_b64_tr_b16 v[214:215], v239 offset:10496
    s_waitcnt lgkmcnt(12)
    v_mfma_f32_32x32x16_bf16 v[48:63], v[220:223], v[96:99], v[48:63]
    ds_read_b64_tr_b16 v[216:217], v240 offset:8448
    ds_read_b64_tr_b16 v[218:219], v240 offset:10496
    s_waitcnt vmcnt(22) lgkmcnt(12)
    v_mfma_f32_32x32x16_bf16 v[128:143], v[192:195], v[100:103], v[128:143]
    ds_read_b64_tr_b16 v[220:221], v241 offset:8448
    ds_read_b64_tr_b16 v[222:223], v241 offset:10496
    s_waitcnt lgkmcnt(12)
    v_mfma_f32_32x32x16_bf16 v[144:159], v[196:199], v[100:103], v[144:159]
    ds_read_b64_tr_b16 v[192:193], v238 offset:16384
    ds_read_b64_tr_b16 v[194:195], v238 offset:18432
    s_waitcnt lgkmcnt(12)
    v_mfma_f32_32x32x16_bf16 v[160:175], v[200:203], v[100:103], v[160:175]
    ds_read_b64_tr_b16 v[196:197], v239 offset:16384
    ds_read_b64_tr_b16 v[198:199], v239 offset:18432
    s_waitcnt lgkmcnt(12)
    v_mfma_f32_32x32x16_bf16 v[176:191], v[204:207], v[100:103], v[176:191]
    ds_read_b64_tr_b16 v[200:201], v240 offset:16384
    ds_read_b64_tr_b16 v[202:203], v240 offset:18432
    s_waitcnt lgkmcnt(12)
    v_mfma_f32_32x32x16_bf16 v[0:15], v[208:211], v[100:103], v[0:15]
    ds_read_b64_tr_b16 v[204:205], v241 offset:16384
    ds_read_b64_tr_b16 v[206:207], v241 offset:18432
    s_waitcnt lgkmcnt(12)
    v_mfma_f32_32x32x16_bf16 v[16:31], v[212:215], v[100:103], v[16:31]
    ds_read_b64_tr_b16 v[208:209], v238 offset:16640
    ds_read_b64_tr_b16 v[210:211], v238 offset:18688
    s_waitcnt lgkmcnt(12)
    v_mfma_f32_32x32x16_bf16 v[32:47], v[216:219], v[100:103], v[32:47]
    ds_read_b64_tr_b16 v[212:213], v239 offset:16640
    ds_read_b64_tr_b16 v[214:215], v239 offset:18688
    s_waitcnt lgkmcnt(12)
    v_mfma_f32_32x32x16_bf16 v[48:63], v[220:223], v[100:103], v[48:63]
    ds_read_b64_tr_b16 v[216:217], v240 offset:16640
    ds_read_b64_tr_b16 v[218:219], v240 offset:18688
    s_waitcnt vmcnt(21) lgkmcnt(12)
    v_mfma_f32_32x32x16_bf16 v[128:143], v[192:195], v[104:107], v[128:143]
    ds_read_b64_tr_b16 v[220:221], v241 offset:16640
    ds_read_b64_tr_b16 v[222:223], v241 offset:18688
    s_waitcnt lgkmcnt(12)
    v_mfma_f32_32x32x16_bf16 v[144:159], v[196:199], v[104:107], v[144:159]
    ds_read_b64_tr_b16 v[192:193], v238 offset:24576
    ds_read_b64_tr_b16 v[194:195], v238 offset:26624
    s_waitcnt lgkmcnt(12)
    v_mfma_f32_32x32x16_bf16 v[160:175], v[200:203], v[104:107], v[160:175]
    ds_read_b64_tr_b16 v[196:197], v239 offset:24576
    ds_read_b64_tr_b16 v[198:199], v239 offset:26624
    s_waitcnt lgkmcnt(12)
    v_mfma_f32_32x32x16_bf16 v[176:191], v[204:207], v[104:107], v[176:191]
    ds_read_b64_tr_b16 v[200:201], v240 offset:24576
    ds_read_b64_tr_b16 v[202:203], v240 offset:26624
    s_waitcnt lgkmcnt(12)
    v_mfma_f32_32x32x16_bf16 v[0:15], v[208:211], v[104:107], v[0:15]
    ds_read_b64_tr_b16 v[204:205], v241 offset:24576
    ds_read_b64_tr_b16 v[206:207], v241 offset:26624
    s_waitcnt lgkmcnt(12)
    v_mfma_f32_32x32x16_bf16 v[16:31], v[212:215], v[104:107], v[16:31]
    ds_read_b64_tr_b16 v[208:209], v238 offset:24832
    ds_read_b64_tr_b16 v[210:211], v238 offset:26880
    s_waitcnt lgkmcnt(12)
    v_mfma_f32_32x32x16_bf16 v[32:47], v[216:219], v[104:107], v[32:47]
    ds_read_b64_tr_b16 v[212:213], v239 offset:24832
    ds_read_b64_tr_b16 v[214:215], v239 offset:26880
    s_waitcnt lgkmcnt(12)
    v_mfma_f32_32x32x16_bf16 v[48:63], v[220:223], v[104:107], v[48:63]
    ds_read_b64_tr_b16 v[216:217], v240 offset:24832
    ds_read_b64_tr_b16 v[218:219], v240 offset:26880
    s_waitcnt vmcnt(20) lgkmcnt(12)
    v_mfma_f32_32x32x16_bf16 v[128:143], v[192:195], v[108:111], v[128:143]
    ds_read_b64_tr_b16 v[220:221], v241 offset:24832
    ds_read_b64_tr_b16 v[222:223], v241 offset:26880
    s_waitcnt lgkmcnt(12)
    v_mfma_f32_32x32x16_bf16 v[144:159], v[196:199], v[108:111], v[144:159]
    s_waitcnt vmcnt(16) lgkmcnt(0)
    s_barrier
    s_add_u32 m0, s67, 65536
    s_add_u32 s71, s70, 2621440
    buffer_load_dwordx4 v247, s[56:59], s71 offen  lds
    s_add_u32 m0, s67, 73728
    s_add_u32 s71, s70, 2752512
    buffer_load_dwordx4 v247, s[56:59], s71 offen  lds
    s_add_u32 m0, s67, 81920
    s_add_u32 s71, s70, 2883584
    buffer_load_dwordx4 v247, s[56:59], s71 offen  lds
    s_add_u32 m0, s67, 90112
    s_add_u32 s71, s70, 3014656
    buffer_load_dwordx4 v247, s[56:59], s71 offen  lds
    buffer_load_dwordx4 v[80:83], v248, s[44:47], s68 offen offset:640
    buffer_load_dwordx4 v[84:87], v248, s[44:47], s68 offen offset:672
    buffer_load_dwordx4 v[88:91], v248, s[44:47], s68 offen offset:704
    buffer_load_dwordx4 v[92:95], v248, s[44:47], s68 offen offset:736
    s_add_u32 m0, s67, 32768
    s_add_u32 s71, s69, 32768
    buffer_load_dwordx4 v236, s[48:51], s71 offen sc1 nt lds
    s_add_u32 m0, s67, 40960
    s_add_u32 s71, s69, 40960
    buffer_load_dwordx4 v236, s[48:51], s71 offen sc1 nt lds
    ds_read_b64_tr_b16 v[192:193], v238 offset:32768
    ds_read_b64_tr_b16 v[194:195], v238 offset:34816
    v_mfma_f32_32x32x16_bf16 v[160:175], v[200:203], v[108:111], v[160:175]
    ds_read_b64_tr_b16 v[196:197], v239 offset:32768
    ds_read_b64_tr_b16 v[198:199], v239 offset:34816
    v_mfma_f32_32x32x16_bf16 v[176:191], v[204:207], v[108:111], v[176:191]
    ds_read_b64_tr_b16 v[200:201], v240 offset:32768
    ds_read_b64_tr_b16 v[202:203], v240 offset:34816
    v_mfma_f32_32x32x16_bf16 v[0:15], v[208:211], v[108:111], v[0:15]
    ds_read_b64_tr_b16 v[204:205], v241 offset:32768
    ds_read_b64_tr_b16 v[206:207], v241 offset:34816
    v_mfma_f32_32x32x16_bf16 v[16:31], v[212:215], v[108:111], v[16:31]
    ds_read_b64_tr_b16 v[208:209], v238 offset:33024
    ds_read_b64_tr_b16 v[210:211], v238 offset:35072
    v_mfma_f32_32x32x16_bf16 v[32:47], v[216:219], v[108:111], v[32:47]
    ds_read_b64_tr_b16 v[212:213], v239 offset:33024
    ds_read_b64_tr_b16 v[214:215], v239 offset:35072
    v_mfma_f32_32x32x16_bf16 v[48:63], v[220:223], v[108:111], v[48:63]
    ds_read_b64_tr_b16 v[216:217], v240 offset:33024
    ds_read_b64_tr_b16 v[218:219], v240 offset:35072
    s_waitcnt vmcnt(25) lgkmcnt(12)
    v_mfma_f32_32x32x16_bf16 v[128:143], v[192:195], v[112:115], v[128:143]
    ds_read_b64_tr_b16 v[220:221], v241 offset:33024
    ds_read_b64_tr_b16 v[222:223], v241 offset:35072
    s_waitcnt lgkmcnt(12)
    v_mfma_f32_32x32x16_bf16 v[144:159], v[196:199], v[112:115], v[144:159]
    ds_read_b64_tr_b16 v[192:193], v238 offset:40960
    ds_read_b64_tr_b16 v[194:195], v238 offset:43008
    s_waitcnt lgkmcnt(12)
    v_mfma_f32_32x32x16_bf16 v[160:175], v[200:203], v[112:115], v[160:175]
    ds_read_b64_tr_b16 v[196:197], v239 offset:40960
    ds_read_b64_tr_b16 v[198:199], v239 offset:43008
    s_waitcnt lgkmcnt(12)
    v_mfma_f32_32x32x16_bf16 v[176:191], v[204:207], v[112:115], v[176:191]
    ds_read_b64_tr_b16 v[200:201], v240 offset:40960
    ds_read_b64_tr_b16 v[202:203], v240 offset:43008
    s_waitcnt lgkmcnt(12)
    v_mfma_f32_32x32x16_bf16 v[0:15], v[208:211], v[112:115], v[0:15]
    ds_read_b64_tr_b16 v[204:205], v241 offset:40960
    ds_read_b64_tr_b16 v[206:207], v241 offset:43008
    s_waitcnt lgkmcnt(12)
    v_mfma_f32_32x32x16_bf16 v[16:31], v[212:215], v[112:115], v[16:31]
    ds_read_b64_tr_b16 v[208:209], v238 offset:41216
    ds_read_b64_tr_b16 v[210:211], v238 offset:43264
    s_waitcnt lgkmcnt(12)
    v_mfma_f32_32x32x16_bf16 v[32:47], v[216:219], v[112:115], v[32:47]
    ds_read_b64_tr_b16 v[212:213], v239 offset:41216
    ds_read_b64_tr_b16 v[214:215], v239 offset:43264
    s_waitcnt lgkmcnt(12)
    v_mfma_f32_32x32x16_bf16 v[48:63], v[220:223], v[112:115], v[48:63]
    ds_read_b64_tr_b16 v[216:217], v240 offset:41216
    ds_read_b64_tr_b16 v[218:219], v240 offset:43264
    s_waitcnt vmcnt(24) lgkmcnt(12)
    v_mfma_f32_32x32x16_bf16 v[128:143], v[192:195], v[116:119], v[128:143]
    ds_read_b64_tr_b16 v[220:221], v241 offset:41216
    ds_read_b64_tr_b16 v[222:223], v241 offset:43264
    s_waitcnt lgkmcnt(12)
    v_mfma_f32_32x32x16_bf16 v[144:159], v[196:199], v[116:119], v[144:159]
    ds_read_b64_tr_b16 v[192:193], v238 offset:49152
    ds_read_b64_tr_b16 v[194:195], v238 offset:51200
    s_waitcnt lgkmcnt(12)
    v_mfma_f32_32x32x16_bf16 v[160:175], v[200:203], v[116:119], v[160:175]
    ds_read_b64_tr_b16 v[196:197], v239 offset:49152
    ds_read_b64_tr_b16 v[198:199], v239 offset:51200
    s_waitcnt lgkmcnt(12)
    v_mfma_f32_32x32x16_bf16 v[176:191], v[204:207], v[116:119], v[176:191]
    ds_read_b64_tr_b16 v[200:201], v240 offset:49152
    ds_read_b64_tr_b16 v[202:203], v240 offset:51200
    s_waitcnt lgkmcnt(12)
    v_mfma_f32_32x32x16_bf16 v[0:15], v[208:211], v[116:119], v[0:15]
    ds_read_b64_tr_b16 v[204:205], v241 offset:49152
    ds_read_b64_tr_b16 v[206:207], v241 offset:51200
    s_waitcnt lgkmcnt(12)
    v_mfma_f32_32x32x16_bf16 v[16:31], v[212:215], v[116:119], v[16:31]
    ds_read_b64_tr_b16 v[208:209], v238 offset:49408
    ds_read_b64_tr_b16 v[210:211], v238 offset:51456
    s_waitcnt lgkmcnt(12)
    v_mfma_f32_32x32x16_bf16 v[32:47], v[216:219], v[116:119], v[32:47]
    ds_read_b64_tr_b16 v[212:213], v239 offset:49408
    ds_read_b64_tr_b16 v[214:215], v239 offset:51456
    s_waitcnt lgkmcnt(12)
    v_mfma_f32_32x32x16_bf16 v[48:63], v[220:223], v[116:119], v[48:63]
    ds_read_b64_tr_b16 v[216:217], v240 offset:49408
    ds_read_b64_tr_b16 v[218:219], v240 offset:51456
    s_waitcnt vmcnt(23) lgkmcnt(12)
    v_mfma_f32_32x32x16_bf16 v[128:143], v[192:195], v[120:123], v[128:143]
    ds_read_b64_tr_b16 v[220:221], v241 offset:49408
    ds_read_b64_tr_b16 v[222:223], v241 offset:51456
    s_waitcnt lgkmcnt(12)
    v_mfma_f32_32x32x16_bf16 v[144:159], v[196:199], v[120:123], v[144:159]
    ds_read_b64_tr_b16 v[192:193], v238 offset:57344
    ds_read_b64_tr_b16 v[194:195], v238 offset:59392
    s_waitcnt lgkmcnt(12)
    v_mfma_f32_32x32x16_bf16 v[160:175], v[200:203], v[120:123], v[160:175]
    ds_read_b64_tr_b16 v[196:197], v239 offset:57344
    ds_read_b64_tr_b16 v[198:199], v239 offset:59392
    s_waitcnt lgkmcnt(12)
    v_mfma_f32_32x32x16_bf16 v[176:191], v[204:207], v[120:123], v[176:191]
    ds_read_b64_tr_b16 v[200:201], v240 offset:57344
    ds_read_b64_tr_b16 v[202:203], v240 offset:59392
    s_waitcnt lgkmcnt(12)
    v_mfma_f32_32x32x16_bf16 v[0:15], v[208:211], v[120:123], v[0:15]
    ds_read_b64_tr_b16 v[204:205], v241 offset:57344
    ds_read_b64_tr_b16 v[206:207], v241 offset:59392
    s_waitcnt lgkmcnt(12)
    v_mfma_f32_32x32x16_bf16 v[16:31], v[212:215], v[120:123], v[16:31]
    ds_read_b64_tr_b16 v[208:209], v238 offset:57600
    ds_read_b64_tr_b16 v[210:211], v238 offset:59648
    s_waitcnt lgkmcnt(12)
    v_mfma_f32_32x32x16_bf16 v[32:47], v[216:219], v[120:123], v[32:47]
    ds_read_b64_tr_b16 v[212:213], v239 offset:57600
    ds_read_b64_tr_b16 v[214:215], v239 offset:59648
    s_waitcnt lgkmcnt(12)
    v_mfma_f32_32x32x16_bf16 v[48:63], v[220:223], v[120:123], v[48:63]
    ds_read_b64_tr_b16 v[216:217], v240 offset:57600
    ds_read_b64_tr_b16 v[218:219], v240 offset:59648
    s_waitcnt vmcnt(22) lgkmcnt(12)
    v_mfma_f32_32x32x16_bf16 v[128:143], v[192:195], v[124:127], v[128:143]
    ds_read_b64_tr_b16 v[220:221], v241 offset:57600
    ds_read_b64_tr_b16 v[222:223], v241 offset:59648
    s_waitcnt lgkmcnt(12)
    v_mfma_f32_32x32x16_bf16 v[144:159], v[196:199], v[124:127], v[144:159]
    s_waitcnt vmcnt(16) lgkmcnt(0)
    s_barrier
    s_add_u32 m0, s67, 98304
    s_add_u32 s71, s70, 3145728
    buffer_load_dwordx4 v247, s[56:59], s71 offen  lds
    s_add_u32 m0, s67, 106496
    s_add_u32 s71, s70, 3276800
    buffer_load_dwordx4 v247, s[56:59], s71 offen  lds
    s_add_u32 m0, s67, 114688
    s_add_u32 s71, s70, 3407872
    buffer_load_dwordx4 v247, s[56:59], s71 offen  lds
    s_add_u32 m0, s67, 122880
    s_add_u32 s71, s70, 3538944
    buffer_load_dwordx4 v247, s[56:59], s71 offen  lds
    buffer_load_dwordx4 v[96:99], v248, s[44:47], s68 offen offset:768
    buffer_load_dwordx4 v[100:103], v248, s[44:47], s68 offen offset:800
    buffer_load_dwordx4 v[104:107], v248, s[44:47], s68 offen offset:832
    buffer_load_dwordx4 v[108:111], v248, s[44:47], s68 offen offset:864
    s_add_u32 m0, s67, 49152
    s_add_u32 s71, s69, 49152
    buffer_load_dwordx4 v236, s[48:51], s71 offen sc1 nt lds
    s_add_u32 m0, s67, 57344
    s_add_u32 s71, s69, 57344
    buffer_load_dwordx4 v236, s[48:51], s71 offen sc1 nt lds
    ds_read_b64_tr_b16 v[192:193], v242 offset:0
    ds_read_b64_tr_b16 v[194:195], v242 offset:2048
    v_mfma_f32_32x32x16_bf16 v[160:175], v[200:203], v[124:127], v[160:175]
    ds_read_b64_tr_b16 v[196:197], v243 offset:0
    ds_read_b64_tr_b16 v[198:199], v243 offset:2048
    v_mfma_f32_32x32x16_bf16 v[176:191], v[204:207], v[124:127], v[176:191]
    ds_read_b64_tr_b16 v[200:201], v244 offset:0
    ds_read_b64_tr_b16 v[202:203], v244 offset:2048
    v_mfma_f32_32x32x16_bf16 v[0:15], v[208:211], v[124:127], v[0:15]
    ds_read_b64_tr_b16 v[204:205], v245 offset:0
    ds_read_b64_tr_b16 v[206:207], v245 offset:2048
    v_mfma_f32_32x32x16_bf16 v[16:31], v[212:215], v[124:127], v[16:31]
    ds_read_b64_tr_b16 v[208:209], v242 offset:256
    ds_read_b64_tr_b16 v[210:211], v242 offset:2304
    v_mfma_f32_32x32x16_bf16 v[32:47], v[216:219], v[124:127], v[32:47]
    ds_read_b64_tr_b16 v[212:213], v243 offset:256
    ds_read_b64_tr_b16 v[214:215], v243 offset:2304
    v_mfma_f32_32x32x16_bf16 v[48:63], v[220:223], v[124:127], v[48:63]
    ds_read_b64_tr_b16 v[216:217], v244 offset:256
    ds_read_b64_tr_b16 v[218:219], v244 offset:2304
    s_waitcnt vmcnt(25) lgkmcnt(12)
    v_mfma_f32_32x32x16_bf16 v[128:143], v[192:195], v[64:67], v[128:143]
    ds_read_b64_tr_b16 v[220:221], v245 offset:256
    ds_read_b64_tr_b16 v[222:223], v245 offset:2304
    s_waitcnt lgkmcnt(12)
    v_mfma_f32_32x32x16_bf16 v[144:159], v[196:199], v[64:67], v[144:159]
    ds_read_b64_tr_b16 v[192:193], v242 offset:8192
    ds_read_b64_tr_b16 v[194:195], v242 offset:10240
    s_waitcnt lgkmcnt(12)
    v_mfma_f32_32x32x16_bf16 v[160:175], v[200:203], v[64:67], v[160:175]
    ds_read_b64_tr_b16 v[196:197], v243 offset:8192
    ds_read_b64_tr_b16 v[198:199], v243 offset:10240
    s_waitcnt lgkmcnt(12)
    v_mfma_f32_32x32x16_bf16 v[176:191], v[204:207], v[64:67], v[176:191]
    ds_read_b64_tr_b16 v[200:201], v244 offset:8192
    ds_read_b64_tr_b16 v[202:203], v244 offset:10240
    s_waitcnt lgkmcnt(12)
    v_mfma_f32_32x32x16_bf16 v[0:15], v[208:211], v[64:67], v[0:15]
    ds_read_b64_tr_b16 v[204:205], v245 offset:8192
    ds_read_b64_tr_b16 v[206:207], v245 offset:10240
    s_waitcnt lgkmcnt(12)
    v_mfma_f32_32x32x16_bf16 v[16:31], v[212:215], v[64:67], v[16:31]
    ds_read_b64_tr_b16 v[208:209], v242 offset:8448
    ds_read_b64_tr_b16 v[210:211], v242 offset:10496
    s_waitcnt lgkmcnt(12)
    v_mfma_f32_32x32x16_bf16 v[32:47], v[216:219], v[64:67], v[32:47]
    ds_read_b64_tr_b16 v[212:213], v243 offset:8448
    ds_read_b64_tr_b16 v[214:215], v243 offset:10496
    s_waitcnt lgkmcnt(12)
    v_mfma_f32_32x32x16_bf16 v[48:63], v[220:223], v[64:67], v[48:63]
    ds_read_b64_tr_b16 v[216:217], v244 offset:8448
    ds_read_b64_tr_b16 v[218:219], v244 offset:10496
    s_waitcnt vmcnt(24) lgkmcnt(12)
    v_mfma_f32_32x32x16_bf16 v[128:143], v[192:195], v[68:71], v[128:143]
    ds_read_b64_tr_b16 v[220:221], v245 offset:8448
    ds_read_b64_tr_b16 v[222:223], v245 offset:10496
    s_waitcnt lgkmcnt(12)
    v_mfma_f32_32x32x16_bf16 v[144:159], v[196:199], v[68:71], v[144:159]
    ds_read_b64_tr_b16 v[192:193], v242 offset:16384
    ds_read_b64_tr_b16 v[194:195], v242 offset:18432
    s_waitcnt lgkmcnt(12)
    v_mfma_f32_32x32x16_bf16 v[160:175], v[200:203], v[68:71], v[160:175]
    ds_read_b64_tr_b16 v[196:197], v243 offset:16384
    ds_read_b64_tr_b16 v[198:199], v243 offset:18432
    s_waitcnt lgkmcnt(12)
    v_mfma_f32_32x32x16_bf16 v[176:191], v[204:207], v[68:71], v[176:191]
    ds_read_b64_tr_b16 v[200:201], v244 offset:16384
    ds_read_b64_tr_b16 v[202:203], v244 offset:18432
    s_waitcnt lgkmcnt(12)
    v_mfma_f32_32x32x16_bf16 v[0:15], v[208:211], v[68:71], v[0:15]
    ds_read_b64_tr_b16 v[204:205], v245 offset:16384
    ds_read_b64_tr_b16 v[206:207], v245 offset:18432
    s_waitcnt lgkmcnt(12)
    v_mfma_f32_32x32x16_bf16 v[16:31], v[212:215], v[68:71], v[16:31]
    ds_read_b64_tr_b16 v[208:209], v242 offset:16640
    ds_read_b64_tr_b16 v[210:211], v242 offset:18688
    s_waitcnt lgkmcnt(12)
    v_mfma_f32_32x32x16_bf16 v[32:47], v[216:219], v[68:71], v[32:47]
    ds_read_b64_tr_b16 v[212:213], v243 offset:16640
    ds_read_b64_tr_b16 v[214:215], v243 offset:18688
    s_waitcnt lgkmcnt(12)
    v_mfma_f32_32x32x16_bf16 v[48:63], v[220:223], v[68:71], v[48:63]
    ds_read_b64_tr_b16 v[216:217], v244 offset:16640
    ds_read_b64_tr_b16 v[218:219], v244 offset:18688
    s_waitcnt vmcnt(23) lgkmcnt(12)
    v_mfma_f32_32x32x16_bf16 v[128:143], v[192:195], v[72:75], v[128:143]
    ds_read_b64_tr_b16 v[220:221], v245 offset:16640
    ds_read_b64_tr_b16 v[222:223], v245 offset:18688
    s_waitcnt lgkmcnt(12)
    v_mfma_f32_32x32x16_bf16 v[144:159], v[196:199], v[72:75], v[144:159]
    ds_read_b64_tr_b16 v[192:193], v242 offset:24576
    ds_read_b64_tr_b16 v[194:195], v242 offset:26624
    s_waitcnt lgkmcnt(12)
    v_mfma_f32_32x32x16_bf16 v[160:175], v[200:203], v[72:75], v[160:175]
    ds_read_b64_tr_b16 v[196:197], v243 offset:24576
    ds_read_b64_tr_b16 v[198:199], v243 offset:26624
    s_waitcnt lgkmcnt(12)
    v_mfma_f32_32x32x16_bf16 v[176:191], v[204:207], v[72:75], v[176:191]
    ds_read_b64_tr_b16 v[200:201], v244 offset:24576
    ds_read_b64_tr_b16 v[202:203], v244 offset:26624
    s_waitcnt lgkmcnt(12)
    v_mfma_f32_32x32x16_bf16 v[0:15], v[208:211], v[72:75], v[0:15]
    ds_read_b64_tr_b16 v[204:205], v245 offset:24576
    ds_read_b64_tr_b16 v[206:207], v245 offset:26624
    s_waitcnt lgkmcnt(12)
    v_mfma_f32_32x32x16_bf16 v[16:31], v[212:215], v[72:75], v[16:31]
    ds_read_b64_tr_b16 v[208:209], v242 offset:24832
    ds_read_b64_tr_b16 v[210:211], v242 offset:26880
    s_waitcnt lgkmcnt(12)
    v_mfma_f32_32x32x16_bf16 v[32:47], v[216:219], v[72:75], v[32:47]
    ds_read_b64_tr_b16 v[212:213], v243 offset:24832
    ds_read_b64_tr_b16 v[214:215], v243 offset:26880
    s_waitcnt lgkmcnt(12)
    v_mfma_f32_32x32x16_bf16 v[48:63], v[220:223], v[72:75], v[48:63]
    ds_read_b64_tr_b16 v[216:217], v244 offset:24832
    ds_read_b64_tr_b16 v[218:219], v244 offset:26880
    s_waitcnt vmcnt(22) lgkmcnt(12)
    v_mfma_f32_32x32x16_bf16 v[128:143], v[192:195], v[76:79], v[128:143]
    ds_read_b64_tr_b16 v[220:221], v245 offset:24832
    ds_read_b64_tr_b16 v[222:223], v245 offset:26880
    s_waitcnt lgkmcnt(12)
    v_mfma_f32_32x32x16_bf16 v[144:159], v[196:199], v[76:79], v[144:159]
    s_waitcnt vmcnt(16) lgkmcnt(0)
    s_barrier
    s_add_u32 m0, s67, 131072
    s_add_u32 s71, s70, 3670016
    buffer_load_dwordx4 v247, s[56:59], s71 offen  lds
    s_add_u32 m0, s67, 139264
    s_add_u32 s71, s70, 3801088
    buffer_load_dwordx4 v247, s[56:59], s71 offen  lds
    s_add_u32 m0, s67, 147456
    s_add_u32 s71, s70, 3932160
    buffer_load_dwordx4 v247, s[56:59], s71 offen  lds
    s_add_u32 m0, s67, 155648
    s_add_u32 s71, s70, 4063232
    buffer_load_dwordx4 v247, s[56:59], s71 offen  lds
    buffer_load_dwordx4 v[112:115], v248, s[44:47], s68 offen offset:896
    buffer_load_dwordx4 v[116:119], v248, s[44:47], s68 offen offset:928
    buffer_load_dwordx4 v[120:123], v248, s[44:47], s68 offen offset:960
    buffer_load_dwordx4 v[124:127], v248, s[44:47], s68 offen offset:992
    ds_read_b64_tr_b16 v[192:193], v238 offset:0
    ds_read_b64_tr_b16 v[194:195], v238 offset:2048
    v_mfma_f32_32x32x16_bf16 v[160:175], v[200:203], v[76:79], v[160:175]
    ds_read_b64_tr_b16 v[196:197], v239 offset:0
    ds_read_b64_tr_b16 v[198:199], v239 offset:2048
    v_mfma_f32_32x32x16_bf16 v[176:191], v[204:207], v[76:79], v[176:191]
    ds_read_b64_tr_b16 v[200:201], v240 offset:0
    ds_read_b64_tr_b16 v[202:203], v240 offset:2048
    v_mfma_f32_32x32x16_bf16 v[0:15], v[208:211], v[76:79], v[0:15]
    ds_read_b64_tr_b16 v[204:205], v241 offset:0
    ds_read_b64_tr_b16 v[206:207], v241 offset:2048
    v_mfma_f32_32x32x16_bf16 v[16:31], v[212:215], v[76:79], v[16:31]
    ds_read_b64_tr_b16 v[208:209], v238 offset:256
    ds_read_b64_tr_b16 v[210:211], v238 offset:2304
    v_mfma_f32_32x32x16_bf16 v[32:47], v[216:219], v[76:79], v[32:47]
    ds_read_b64_tr_b16 v[212:213], v239 offset:256
    ds_read_b64_tr_b16 v[214:215], v239 offset:2304
    v_mfma_f32_32x32x16_bf16 v[48:63], v[220:223], v[76:79], v[48:63]
    ds_read_b64_tr_b16 v[216:217], v240 offset:256
    ds_read_b64_tr_b16 v[218:219], v240 offset:2304
    s_waitcnt vmcnt(23) lgkmcnt(12)
    v_mfma_f32_32x32x16_bf16 v[128:143], v[192:195], v[80:83], v[128:143]
    ds_read_b64_tr_b16 v[220:221], v241 offset:256
    ds_read_b64_tr_b16 v[222:223], v241 offset:2304
    s_waitcnt lgkmcnt(12)
    v_mfma_f32_32x32x16_bf16 v[144:159], v[196:199], v[80:83], v[144:159]
    ds_read_b64_tr_b16 v[192:193], v238 offset:8192
    ds_read_b64_tr_b16 v[194:195], v238 offset:10240
    s_waitcnt lgkmcnt(12)
    v_mfma_f32_32x32x16_bf16 v[160:175], v[200:203], v[80:83], v[160:175]
    ds_read_b64_tr_b16 v[196:197], v239 offset:8192
    ds_read_b64_tr_b16 v[198:199], v239 offset:10240
    s_waitcnt lgkmcnt(12)
    v_mfma_f32_32x32x16_bf16 v[176:191], v[204:207], v[80:83], v[176:191]
    ds_read_b64_tr_b16 v[200:201], v240 offset:8192
    ds_read_b64_tr_b16 v[202:203], v240 offset:10240
    s_waitcnt lgkmcnt(12)
    v_mfma_f32_32x32x16_bf16 v[0:15], v[208:211], v[80:83], v[0:15]
    ds_read_b64_tr_b16 v[204:205], v241 offset:8192
    ds_read_b64_tr_b16 v[206:207], v241 offset:10240
    s_waitcnt lgkmcnt(12)
    v_mfma_f32_32x32x16_bf16 v[16:31], v[212:215], v[80:83], v[16:31]
    ds_read_b64_tr_b16 v[208:209], v238 offset:8448
    ds_read_b64_tr_b16 v[210:211], v238 offset:10496
    s_waitcnt lgkmcnt(12)
    v_mfma_f32_32x32x16_bf16 v[32:47], v[216:219], v[80:83], v[32:47]
    ds_read_b64_tr_b16 v[212:213], v239 offset:8448
    ds_read_b64_tr_b16 v[214:215], v239 offset:10496
    s_waitcnt lgkmcnt(12)
    v_mfma_f32_32x32x16_bf16 v[48:63], v[220:223], v[80:83], v[48:63]
    ds_read_b64_tr_b16 v[216:217], v240 offset:8448
    ds_read_b64_tr_b16 v[218:219], v240 offset:10496
    s_waitcnt vmcnt(22) lgkmcnt(12)
    v_mfma_f32_32x32x16_bf16 v[128:143], v[192:195], v[84:87], v[128:143]
    ds_read_b64_tr_b16 v[220:221], v241 offset:8448
    ds_read_b64_tr_b16 v[222:223], v241 offset:10496
    s_waitcnt lgkmcnt(12)
    v_mfma_f32_32x32x16_bf16 v[144:159], v[196:199], v[84:87], v[144:159]
    ds_read_b64_tr_b16 v[192:193], v238 offset:16384
    ds_read_b64_tr_b16 v[194:195], v238 offset:18432
    s_waitcnt lgkmcnt(12)
    v_mfma_f32_32x32x16_bf16 v[160:175], v[200:203], v[84:87], v[160:175]
    ds_read_b64_tr_b16 v[196:197], v239 offset:16384
    ds_read_b64_tr_b16 v[198:199], v239 offset:18432
    s_waitcnt lgkmcnt(12)
    v_mfma_f32_32x32x16_bf16 v[176:191], v[204:207], v[84:87], v[176:191]
    ds_read_b64_tr_b16 v[200:201], v240 offset:16384
    ds_read_b64_tr_b16 v[202:203], v240 offset:18432
    s_waitcnt lgkmcnt(12)
    v_mfma_f32_32x32x16_bf16 v[0:15], v[208:211], v[84:87], v[0:15]
    ds_read_b64_tr_b16 v[204:205], v241 offset:16384
    ds_read_b64_tr_b16 v[206:207], v241 offset:18432
    s_waitcnt lgkmcnt(12)
    v_mfma_f32_32x32x16_bf16 v[16:31], v[212:215], v[84:87], v[16:31]
    ds_read_b64_tr_b16 v[208:209], v238 offset:16640
    ds_read_b64_tr_b16 v[210:211], v238 offset:18688
    s_waitcnt lgkmcnt(12)
    v_mfma_f32_32x32x16_bf16 v[32:47], v[216:219], v[84:87], v[32:47]
    ds_read_b64_tr_b16 v[212:213], v239 offset:16640
    ds_read_b64_tr_b16 v[214:215], v239 offset:18688
    s_waitcnt lgkmcnt(12)
    v_mfma_f32_32x32x16_bf16 v[48:63], v[220:223], v[84:87], v[48:63]
    ds_read_b64_tr_b16 v[216:217], v240 offset:16640
    ds_read_b64_tr_b16 v[218:219], v240 offset:18688
    s_waitcnt vmcnt(21) lgkmcnt(12)
    v_mfma_f32_32x32x16_bf16 v[128:143], v[192:195], v[88:91], v[128:143]
    ds_read_b64_tr_b16 v[220:221], v241 offset:16640
    ds_read_b64_tr_b16 v[222:223], v241 offset:18688
    s_waitcnt lgkmcnt(12)
    v_mfma_f32_32x32x16_bf16 v[144:159], v[196:199], v[88:91], v[144:159]
    ds_read_b64_tr_b16 v[192:193], v238 offset:24576
    ds_read_b64_tr_b16 v[194:195], v238 offset:26624
    s_waitcnt lgkmcnt(12)
    v_mfma_f32_32x32x16_bf16 v[160:175], v[200:203], v[88:91], v[160:175]
    ds_read_b64_tr_b16 v[196:197], v239 offset:24576
    ds_read_b64_tr_b16 v[198:199], v239 offset:26624
    s_waitcnt lgkmcnt(12)
    v_mfma_f32_32x32x16_bf16 v[176:191], v[204:207], v[88:91], v[176:191]
    ds_read_b64_tr_b16 v[200:201], v240 offset:24576
    ds_read_b64_tr_b16 v[202:203], v240 offset:26624
    s_waitcnt lgkmcnt(12)
    v_mfma_f32_32x32x16_bf16 v[0:15], v[208:211], v[88:91], v[0:15]
    ds_read_b64_tr_b16 v[204:205], v241 offset:24576
    ds_read_b64_tr_b16 v[206:207], v241 offset:26624
    s_waitcnt lgkmcnt(12)
    v_mfma_f32_32x32x16_bf16 v[16:31], v[212:215], v[88:91], v[16:31]
    ds_read_b64_tr_b16 v[208:209], v238 offset:24832
    ds_read_b64_tr_b16 v[210:211], v238 offset:26880
    s_waitcnt lgkmcnt(12)
    v_mfma_f32_32x32x16_bf16 v[32:47], v[216:219], v[88:91], v[32:47]
    ds_read_b64_tr_b16 v[212:213], v239 offset:24832
    ds_read_b64_tr_b16 v[214:215], v239 offset:26880
    s_waitcnt lgkmcnt(12)
    v_mfma_f32_32x32x16_bf16 v[48:63], v[220:223], v[88:91], v[48:63]
    ds_read_b64_tr_b16 v[216:217], v240 offset:24832
    ds_read_b64_tr_b16 v[218:219], v240 offset:26880
    s_waitcnt vmcnt(20) lgkmcnt(12)
    v_mfma_f32_32x32x16_bf16 v[128:143], v[192:195], v[92:95], v[128:143]
    ds_read_b64_tr_b16 v[220:221], v241 offset:24832
    ds_read_b64_tr_b16 v[222:223], v241 offset:26880
    s_waitcnt lgkmcnt(12)
    v_mfma_f32_32x32x16_bf16 v[144:159], v[196:199], v[92:95], v[144:159]
    s_waitcnt vmcnt(14) lgkmcnt(0)
    s_barrier
    s_add_u32 m0, s67, 65536
    s_add_u32 s71, s69, 0
    buffer_load_dwordx4 v237, s[52:55], s71 offen sc1 nt lds
    s_add_u32 m0, s67, 73728
    s_add_u32 s71, s69, 8192
    buffer_load_dwordx4 v237, s[52:55], s71 offen sc1 nt lds
    s_add_u32 m0, s67, 81920
    s_add_u32 s71, s69, 16384
    buffer_load_dwordx4 v237, s[52:55], s71 offen sc1 nt lds
    s_add_u32 m0, s67, 90112
    s_add_u32 s71, s69, 24576
    buffer_load_dwordx4 v237, s[52:55], s71 offen sc1 nt lds
    ds_read_b64_tr_b16 v[192:193], v238 offset:32768
    ds_read_b64_tr_b16 v[194:195], v238 offset:34816
    v_mfma_f32_32x32x16_bf16 v[160:175], v[200:203], v[92:95], v[160:175]
    ds_read_b64_tr_b16 v[196:197], v239 offset:32768
    ds_read_b64_tr_b16 v[198:199], v239 offset:34816
    v_mfma_f32_32x32x16_bf16 v[176:191], v[204:207], v[92:95], v[176:191]
    ds_read_b64_tr_b16 v[200:201], v240 offset:32768
    ds_read_b64_tr_b16 v[202:203], v240 offset:34816
    v_mfma_f32_32x32x16_bf16 v[0:15], v[208:211], v[92:95], v[0:15]
    ds_read_b64_tr_b16 v[204:205], v241 offset:32768
    ds_read_b64_tr_b16 v[206:207], v241 offset:34816
    v_mfma_f32_32x32x16_bf16 v[16:31], v[212:215], v[92:95], v[16:31]
    ds_read_b64_tr_b16 v[208:209], v238 offset:33024
    ds_read_b64_tr_b16 v[210:211], v238 offset:35072
    v_mfma_f32_32x32x16_bf16 v[32:47], v[216:219], v[92:95], v[32:47]
    ds_read_b64_tr_b16 v[212:213], v239 offset:33024
    ds_read_b64_tr_b16 v[214:215], v239 offset:35072
    v_mfma_f32_32x32x16_bf16 v[48:63], v[220:223], v[92:95], v[48:63]
    ds_read_b64_tr_b16 v[216:217], v240 offset:33024
    ds_read_b64_tr_b16 v[218:219], v240 offset:35072
    s_waitcnt vmcnt(17) lgkmcnt(12)
    v_mfma_f32_32x32x16_bf16 v[128:143], v[192:195], v[96:99], v[128:143]
    ds_read_b64_tr_b16 v[220:221], v241 offset:33024
    ds_read_b64_tr_b16 v[222:223], v241 offset:35072
    s_waitcnt lgkmcnt(12)
    v_mfma_f32_32x32x16_bf16 v[144:159], v[196:199], v[96:99], v[144:159]
    ds_read_b64_tr_b16 v[192:193], v238 offset:40960
    ds_read_b64_tr_b16 v[194:195], v238 offset:43008
    s_waitcnt lgkmcnt(12)
    v_mfma_f32_32x32x16_bf16 v[160:175], v[200:203], v[96:99], v[160:175]
    ds_read_b64_tr_b16 v[196:197], v239 offset:40960
    ds_read_b64_tr_b16 v[198:199], v239 offset:43008
    s_waitcnt lgkmcnt(12)
    v_mfma_f32_32x32x16_bf16 v[176:191], v[204:207], v[96:99], v[176:191]
    ds_read_b64_tr_b16 v[200:201], v240 offset:40960
    ds_read_b64_tr_b16 v[202:203], v240 offset:43008
    s_waitcnt lgkmcnt(12)
    v_mfma_f32_32x32x16_bf16 v[0:15], v[208:211], v[96:99], v[0:15]
    ds_read_b64_tr_b16 v[204:205], v241 offset:40960
    ds_read_b64_tr_b16 v[206:207], v241 offset:43008
    s_waitcnt lgkmcnt(12)
    v_mfma_f32_32x32x16_bf16 v[16:31], v[212:215], v[96:99], v[16:31]
    ds_read_b64_tr_b16 v[208:209], v238 offset:41216
    ds_read_b64_tr_b16 v[210:211], v238 offset:43264
    s_waitcnt lgkmcnt(12)
    v_mfma_f32_32x32x16_bf16 v[32:47], v[216:219], v[96:99], v[32:47]
    ds_read_b64_tr_b16 v[212:213], v239 offset:41216
    ds_read_b64_tr_b16 v[214:215], v239 offset:43264
    s_waitcnt lgkmcnt(12)
    v_mfma_f32_32x32x16_bf16 v[48:63], v[220:223], v[96:99], v[48:63]
    ds_read_b64_tr_b16 v[216:217], v240 offset:41216
    ds_read_b64_tr_b16 v[218:219], v240 offset:43264
    s_waitcnt vmcnt(16) lgkmcnt(12)
    v_mfma_f32_32x32x16_bf16 v[128:143], v[192:195], v[100:103], v[128:143]
    ds_read_b64_tr_b16 v[220:221], v241 offset:41216
    ds_read_b64_tr_b16 v[222:223], v241 offset:43264
    s_waitcnt lgkmcnt(12)
    v_mfma_f32_32x32x16_bf16 v[144:159], v[196:199], v[100:103], v[144:159]
    ds_read_b64_tr_b16 v[192:193], v238 offset:49152
    ds_read_b64_tr_b16 v[194:195], v238 offset:51200
    s_waitcnt lgkmcnt(12)
    v_mfma_f32_32x32x16_bf16 v[160:175], v[200:203], v[100:103], v[160:175]
    ds_read_b64_tr_b16 v[196:197], v239 offset:49152
    ds_read_b64_tr_b16 v[198:199], v239 offset:51200
    s_waitcnt lgkmcnt(12)
    v_mfma_f32_32x32x16_bf16 v[176:191], v[204:207], v[100:103], v[176:191]
    ds_read_b64_tr_b16 v[200:201], v240 offset:49152
    ds_read_b64_tr_b16 v[202:203], v240 offset:51200
    s_waitcnt lgkmcnt(12)
    v_mfma_f32_32x32x16_bf16 v[0:15], v[208:211], v[100:103], v[0:15]
    ds_read_b64_tr_b16 v[204:205], v241 offset:49152
    ds_read_b64_tr_b16 v[206:207], v241 offset:51200
    s_waitcnt lgkmcnt(12)
    v_mfma_f32_32x32x16_bf16 v[16:31], v[212:215], v[100:103], v[16:31]
    ds_read_b64_tr_b16 v[208:209], v238 offset:49408
    ds_read_b64_tr_b16 v[210:211], v238 offset:51456
    s_waitcnt lgkmcnt(12)
    v_mfma_f32_32x32x16_bf16 v[32:47], v[216:219], v[100:103], v[32:47]
    ds_read_b64_tr_b16 v[212:213], v239 offset:49408
    ds_read_b64_tr_b16 v[214:215], v239 offset:51456
    s_waitcnt lgkmcnt(12)
    v_mfma_f32_32x32x16_bf16 v[48:63], v[220:223], v[100:103], v[48:63]
    ds_read_b64_tr_b16 v[216:217], v240 offset:49408
    ds_read_b64_tr_b16 v[218:219], v240 offset:51456
    s_waitcnt vmcnt(15) lgkmcnt(12)
    v_mfma_f32_32x32x16_bf16 v[128:143], v[192:195], v[104:107], v[128:143]
    ds_read_b64_tr_b16 v[220:221], v241 offset:49408
    ds_read_b64_tr_b16 v[222:223], v241 offset:51456
    s_waitcnt lgkmcnt(12)
    v_mfma_f32_32x32x16_bf16 v[144:159], v[196:199], v[104:107], v[144:159]
    ds_read_b64_tr_b16 v[192:193], v238 offset:57344
    ds_read_b64_tr_b16 v[194:195], v238 offset:59392
    s_waitcnt lgkmcnt(12)
    v_mfma_f32_32x32x16_bf16 v[160:175], v[200:203], v[104:107], v[160:175]
    ds_read_b64_tr_b16 v[196:197], v239 offset:57344
    ds_read_b64_tr_b16 v[198:199], v239 offset:59392
    s_waitcnt lgkmcnt(12)
    v_mfma_f32_32x32x16_bf16 v[176:191], v[204:207], v[104:107], v[176:191]
    ds_read_b64_tr_b16 v[200:201], v240 offset:57344
    ds_read_b64_tr_b16 v[202:203], v240 offset:59392
    s_waitcnt lgkmcnt(12)
    v_mfma_f32_32x32x16_bf16 v[0:15], v[208:211], v[104:107], v[0:15]
    ds_read_b64_tr_b16 v[204:205], v241 offset:57344
    ds_read_b64_tr_b16 v[206:207], v241 offset:59392
    s_waitcnt lgkmcnt(12)
    v_mfma_f32_32x32x16_bf16 v[16:31], v[212:215], v[104:107], v[16:31]
    ds_read_b64_tr_b16 v[208:209], v238 offset:57600
    ds_read_b64_tr_b16 v[210:211], v238 offset:59648
    s_waitcnt lgkmcnt(12)
    v_mfma_f32_32x32x16_bf16 v[32:47], v[216:219], v[104:107], v[32:47]
    ds_read_b64_tr_b16 v[212:213], v239 offset:57600
    ds_read_b64_tr_b16 v[214:215], v239 offset:59648
    s_waitcnt lgkmcnt(12)
    v_mfma_f32_32x32x16_bf16 v[48:63], v[220:223], v[104:107], v[48:63]
    ds_read_b64_tr_b16 v[216:217], v240 offset:57600
    ds_read_b64_tr_b16 v[218:219], v240 offset:59648
    s_waitcnt vmcnt(14) lgkmcnt(12)
    v_mfma_f32_32x32x16_bf16 v[128:143], v[192:195], v[108:111], v[128:143]
    ds_read_b64_tr_b16 v[220:221], v241 offset:57600
    ds_read_b64_tr_b16 v[222:223], v241 offset:59648
    s_waitcnt lgkmcnt(12)
    v_mfma_f32_32x32x16_bf16 v[144:159], v[196:199], v[108:111], v[144:159]
    s_waitcnt vmcnt(8) lgkmcnt(0)
    s_barrier
    s_add_u32 m0, s67, 98304
    s_add_u32 s71, s69, 32768
    buffer_load_dwordx4 v237, s[52:55], s71 offen sc1 nt lds
    s_add_u32 m0, s67, 106496
    s_add_u32 s71, s69, 40960
    buffer_load_dwordx4 v237, s[52:55], s71 offen sc1 nt lds
    s_add_u32 m0, s67, 114688
    s_add_u32 s71, s69, 49152
    buffer_load_dwordx4 v237, s[52:55], s71 offen sc1 nt lds
    s_add_u32 m0, s67, 122880
    s_add_u32 s71, s69, 57344
    buffer_load_dwordx4 v237, s[52:55], s71 offen sc1 nt lds
    ds_read_b64_tr_b16 v[192:193], v242 offset:0
    ds_read_b64_tr_b16 v[194:195], v242 offset:2048
    v_mfma_f32_32x32x16_bf16 v[160:175], v[200:203], v[108:111], v[160:175]
    ds_read_b64_tr_b16 v[196:197], v243 offset:0
    ds_read_b64_tr_b16 v[198:199], v243 offset:2048
    v_mfma_f32_32x32x16_bf16 v[176:191], v[204:207], v[108:111], v[176:191]
    ds_read_b64_tr_b16 v[200:201], v244 offset:0
    ds_read_b64_tr_b16 v[202:203], v244 offset:2048
    v_mfma_f32_32x32x16_bf16 v[0:15], v[208:211], v[108:111], v[0:15]
    ds_read_b64_tr_b16 v[204:205], v245 offset:0
    ds_read_b64_tr_b16 v[206:207], v245 offset:2048
    v_mfma_f32_32x32x16_bf16 v[16:31], v[212:215], v[108:111], v[16:31]
    ds_read_b64_tr_b16 v[208:209], v242 offset:256
    ds_read_b64_tr_b16 v[210:211], v242 offset:2304
    v_mfma_f32_32x32x16_bf16 v[32:47], v[216:219], v[108:111], v[32:47]
    ds_read_b64_tr_b16 v[212:213], v243 offset:256
    ds_read_b64_tr_b16 v[214:215], v243 offset:2304
    v_mfma_f32_32x32x16_bf16 v[48:63], v[220:223], v[108:111], v[48:63]
    ds_read_b64_tr_b16 v[216:217], v244 offset:256
    ds_read_b64_tr_b16 v[218:219], v244 offset:2304
    s_waitcnt vmcnt(11) lgkmcnt(12)
    v_mfma_f32_32x32x16_bf16 v[128:143], v[192:195], v[112:115], v[128:143]
    ds_read_b64_tr_b16 v[220:221], v245 offset:256
    ds_read_b64_tr_b16 v[222:223], v245 offset:2304
    s_waitcnt lgkmcnt(12)
    v_mfma_f32_32x32x16_bf16 v[144:159], v[196:199], v[112:115], v[144:159]
    ds_read_b64_tr_b16 v[192:193], v242 offset:8192
    ds_read_b64_tr_b16 v[194:195], v242 offset:10240
    s_waitcnt lgkmcnt(12)
    v_mfma_f32_32x32x16_bf16 v[160:175], v[200:203], v[112:115], v[160:175]
    ds_read_b64_tr_b16 v[196:197], v243 offset:8192
    ds_read_b64_tr_b16 v[198:199], v243 offset:10240
    s_waitcnt lgkmcnt(12)
    v_mfma_f32_32x32x16_bf16 v[176:191], v[204:207], v[112:115], v[176:191]
    ds_read_b64_tr_b16 v[200:201], v244 offset:8192
    ds_read_b64_tr_b16 v[202:203], v244 offset:10240
    s_waitcnt lgkmcnt(12)
    v_mfma_f32_32x32x16_bf16 v[0:15], v[208:211], v[112:115], v[0:15]
    ds_read_b64_tr_b16 v[204:205], v245 offset:8192
    ds_read_b64_tr_b16 v[206:207], v245 offset:10240
    s_waitcnt lgkmcnt(12)
    v_mfma_f32_32x32x16_bf16 v[16:31], v[212:215], v[112:115], v[16:31]
    ds_read_b64_tr_b16 v[208:209], v242 offset:8448
    ds_read_b64_tr_b16 v[210:211], v242 offset:10496
    s_waitcnt lgkmcnt(12)
    v_mfma_f32_32x32x16_bf16 v[32:47], v[216:219], v[112:115], v[32:47]
    ds_read_b64_tr_b16 v[212:213], v243 offset:8448
    ds_read_b64_tr_b16 v[214:215], v243 offset:10496
    s_waitcnt lgkmcnt(12)
    v_mfma_f32_32x32x16_bf16 v[48:63], v[220:223], v[112:115], v[48:63]
    ds_read_b64_tr_b16 v[216:217], v244 offset:8448
    ds_read_b64_tr_b16 v[218:219], v244 offset:10496
    s_waitcnt vmcnt(10) lgkmcnt(12)
    v_mfma_f32_32x32x16_bf16 v[128:143], v[192:195], v[116:119], v[128:143]
    ds_read_b64_tr_b16 v[220:221], v245 offset:8448
    ds_read_b64_tr_b16 v[222:223], v245 offset:10496
    s_waitcnt lgkmcnt(12)
    v_mfma_f32_32x32x16_bf16 v[144:159], v[196:199], v[116:119], v[144:159]
    ds_read_b64_tr_b16 v[192:193], v242 offset:16384
    ds_read_b64_tr_b16 v[194:195], v242 offset:18432
    s_waitcnt lgkmcnt(12)
    v_mfma_f32_32x32x16_bf16 v[160:175], v[200:203], v[116:119], v[160:175]
    ds_read_b64_tr_b16 v[196:197], v243 offset:16384
    ds_read_b64_tr_b16 v[198:199], v243 offset:18432
    s_waitcnt lgkmcnt(12)
    v_mfma_f32_32x32x16_bf16 v[176:191], v[204:207], v[116:119], v[176:191]
    ds_read_b64_tr_b16 v[200:201], v244 offset:16384
    ds_read_b64_tr_b16 v[202:203], v244 offset:18432
    s_waitcnt lgkmcnt(12)
    v_mfma_f32_32x32x16_bf16 v[0:15], v[208:211], v[116:119], v[0:15]
    ds_read_b64_tr_b16 v[204:205], v245 offset:16384
    ds_read_b64_tr_b16 v[206:207], v245 offset:18432
    s_waitcnt lgkmcnt(12)
    v_mfma_f32_32x32x16_bf16 v[16:31], v[212:215], v[116:119], v[16:31]
    ds_read_b64_tr_b16 v[208:209], v242 offset:16640
    ds_read_b64_tr_b16 v[210:211], v242 offset:18688
    s_waitcnt lgkmcnt(12)
    v_mfma_f32_32x32x16_bf16 v[32:47], v[216:219], v[116:119], v[32:47]
    ds_read_b64_tr_b16 v[212:213], v243 offset:16640
    ds_read_b64_tr_b16 v[214:215], v243 offset:18688
    s_waitcnt lgkmcnt(12)
    v_mfma_f32_32x32x16_bf16 v[48:63], v[220:223], v[116:119], v[48:63]
    ds_read_b64_tr_b16 v[216:217], v244 offset:16640
    ds_read_b64_tr_b16 v[218:219], v244 offset:18688
    s_waitcnt vmcnt(9) lgkmcnt(12)
    v_mfma_f32_32x32x16_bf16 v[128:143], v[192:195], v[120:123], v[128:143]
    ds_read_b64_tr_b16 v[220:221], v245 offset:16640
    ds_read_b64_tr_b16 v[222:223], v245 offset:18688
    s_waitcnt lgkmcnt(12)
    v_mfma_f32_32x32x16_bf16 v[144:159], v[196:199], v[120:123], v[144:159]
    ds_read_b64_tr_b16 v[192:193], v242 offset:24576
    ds_read_b64_tr_b16 v[194:195], v242 offset:26624
    s_waitcnt lgkmcnt(12)
    v_mfma_f32_32x32x16_bf16 v[160:175], v[200:203], v[120:123], v[160:175]
    ds_read_b64_tr_b16 v[196:197], v243 offset:24576
    ds_read_b64_tr_b16 v[198:199], v243 offset:26624
    s_waitcnt lgkmcnt(12)
    v_mfma_f32_32x32x16_bf16 v[176:191], v[204:207], v[120:123], v[176:191]
    ds_read_b64_tr_b16 v[200:201], v244 offset:24576
    ds_read_b64_tr_b16 v[202:203], v244 offset:26624
    s_waitcnt lgkmcnt(12)
    v_mfma_f32_32x32x16_bf16 v[0:15], v[208:211], v[120:123], v[0:15]
    ds_read_b64_tr_b16 v[204:205], v245 offset:24576
    ds_read_b64_tr_b16 v[206:207], v245 offset:26624
    s_waitcnt lgkmcnt(12)
    v_mfma_f32_32x32x16_bf16 v[16:31], v[212:215], v[120:123], v[16:31]
    ds_read_b64_tr_b16 v[208:209], v242 offset:24832
    ds_read_b64_tr_b16 v[210:211], v242 offset:26880
    s_waitcnt lgkmcnt(12)
    v_mfma_f32_32x32x16_bf16 v[32:47], v[216:219], v[120:123], v[32:47]
    ds_read_b64_tr_b16 v[212:213], v243 offset:24832
    ds_read_b64_tr_b16 v[214:215], v243 offset:26880
    s_waitcnt lgkmcnt(12)
    v_mfma_f32_32x32x16_bf16 v[48:63], v[220:223], v[120:123], v[48:63]
    ds_read_b64_tr_b16 v[216:217], v244 offset:24832
    ds_read_b64_tr_b16 v[218:219], v244 offset:26880
    s_waitcnt vmcnt(8) lgkmcnt(12)
    v_mfma_f32_32x32x16_bf16 v[128:143], v[192:195], v[124:127], v[128:143]
    ds_read_b64_tr_b16 v[220:221], v245 offset:24832
    ds_read_b64_tr_b16 v[222:223], v245 offset:26880
    s_waitcnt lgkmcnt(12)
    v_mfma_f32_32x32x16_bf16 v[144:159], v[196:199], v[124:127], v[144:159]
    s_waitcnt lgkmcnt(0)
    s_barrier
    v_mov_b32 v247, v249
    ds_read_b128 v[192:195], v224 offset:0
    v_mfma_f32_32x32x16_bf16 v[160:175], v[200:203], v[124:127], v[160:175]
    ds_read_b128 v[196:199], v225 offset:0
    v_mfma_f32_32x32x16_bf16 v[176:191], v[204:207], v[124:127], v[176:191]
    ds_read_b128 v[200:203], v226 offset:0
    v_mfma_f32_32x32x16_bf16 v[0:15], v[208:211], v[124:127], v[0:15]
    ds_read_b128 v[204:207], v227 offset:0
    v_cvt_pk_bf16_f32 v64, v128, v129
    v_cvt_pk_bf16_f32 v65, v130, v131
    v_cvt_pk_bf16_f32 v66, v132, v133
    v_cvt_pk_bf16_f32 v67, v134, v135
    v_cvt_pk_bf16_f32 v68, v136, v137
    v_cvt_pk_bf16_f32 v69, v138, v139
    v_cvt_pk_bf16_f32 v70, v140, v141
    v_cvt_pk_bf16_f32 v71, v142, v143
    v_mfma_f32_32x32x16_bf16 v[16:31], v[212:215], v[124:127], v[16:31]
    ds_read_b128 v[208:211], v228 offset:0
    v_cvt_pk_bf16_f32 v72, v144, v145
    v_cvt_pk_bf16_f32 v73, v146, v147
    v_cvt_pk_bf16_f32 v74, v148, v149
    v_cvt_pk_bf16_f32 v75, v150, v151
    v_cvt_pk_bf16_f32 v76, v152, v153
    v_cvt_pk_bf16_f32 v77, v154, v155
    v_cvt_pk_bf16_f32 v78, v156, v157
    v_cvt_pk_bf16_f32 v79, v158, v159
    v_mfma_f32_32x32x16_bf16 v[32:47], v[216:219], v[124:127], v[32:47]
    ds_read_b128 v[212:215], v229 offset:0
    v_cvt_pk_bf16_f32 v80, v160, v161
    v_cvt_pk_bf16_f32 v81, v162, v163
    v_cvt_pk_bf16_f32 v82, v164, v165
    v_cvt_pk_bf16_f32 v83, v166, v167
    v_cvt_pk_bf16_f32 v84, v168, v169
    v_cvt_pk_bf16_f32 v85, v170, v171
    v_cvt_pk_bf16_f32 v86, v172, v173
    v_cvt_pk_bf16_f32 v87, v174, v175
    v_mfma_f32_32x32x16_bf16 v[48:63], v[220:223], v[124:127], v[48:63]
    ds_read_b128 v[216:219], v230 offset:0
    v_cvt_pk_bf16_f32 v88, v176, v177
    v_cvt_pk_bf16_f32 v89, v178, v179
    v_cvt_pk_bf16_f32 v90, v180, v181
    v_cvt_pk_bf16_f32 v91, v182, v183
    v_cvt_pk_bf16_f32 v92, v184, v185
    v_cvt_pk_bf16_f32 v93, v186, v187
    v_cvt_pk_bf16_f32 v94, v188, v189
    v_cvt_pk_bf16_f32 v95, v190, v191
    v_cvt_pk_bf16_f32 v96, v0, v1
    v_cvt_pk_bf16_f32 v97, v2, v3
    s_waitcnt lgkmcnt(6)
    v_mfma_f32_32x32x16_bf16 v[128:143], v[192:195], v[64:67], 0
    ds_read_b128 v[220:223], v231 offset:0
    v_cvt_pk_bf16_f32 v98, v4, v5
    v_cvt_pk_bf16_f32 v99, v6, v7
    s_waitcnt lgkmcnt(6)
    v_mfma_f32_32x32x16_bf16 v[128:143], v[196:199], v[68:71], v[128:143]
    ds_read_b128 v[192:195], v224 offset:8192
    v_cvt_pk_bf16_f32 v100, v8, v9
    v_cvt_pk_bf16_f32 v101, v10, v11
    s_waitcnt lgkmcnt(6)
    v_mfma_f32_32x32x16_bf16 v[128:143], v[200:203], v[72:75], v[128:143]
    ds_read_b128 v[196:199], v225 offset:8192
    v_cvt_pk_bf16_f32 v102, v12, v13
    v_cvt_pk_bf16_f32 v103, v14, v15
    s_waitcnt lgkmcnt(6)
    v_mfma_f32_32x32x16_bf16 v[128:143], v[204:207], v[76:79], v[128:143]
    ds_read_b128 v[200:203], v226 offset:8192
    v_cvt_pk_bf16_f32 v104, v16, v17
    v_cvt_pk_bf16_f32 v105, v18, v19
    s_waitcnt lgkmcnt(6)
    v_mfma_f32_32x32x16_bf16 v[128:143], v[208:211], v[80:83], v[128:143]
    ds_read_b128 v[204:207], v227 offset:8192
    v_cvt_pk_bf16_f32 v106, v20, v21
    v_cvt_pk_bf16_f32 v107, v22, v23
    s_waitcnt lgkmcnt(6)
    v_mfma_f32_32x32x16_bf16 v[128:143], v[212:215], v[84:87], v[128:143]
    ds_read_b128 v[208:211], v228 offset:8192
    v_cvt_pk_bf16_f32 v108, v24, v25
    v_cvt_pk_bf16_f32 v109, v26, v27
    s_waitcnt lgkmcnt(6)
    v_mfma_f32_32x32x16_bf16 v[128:143], v[216:219], v[88:91], v[128:143]
    ds_read_b128 v[212:215], v229 offset:8192
    v_cvt_pk_bf16_f32 v110, v28, v29
    v_cvt_pk_bf16_f32 v111, v30, v31
    s_waitcnt lgkmcnt(6)
    v_mfma_f32_32x32x16_bf16 v[128:143], v[220:223], v[92:95], v[128:143]
    ds_read_b128 v[216:219], v230 offset:8192
    v_cvt_pk_bf16_f32 v112, v32, v33
    v_cvt_pk_bf16_f32 v113, v34, v35
    s_waitcnt lgkmcnt(6)
    v_mfma_f32_32x32x16_bf16 v[144:159], v[192:195], v[64:67], 0
    ds_read_b128 v[220:223], v231 offset:8192
    v_cvt_pk_bf16_f32 v114, v36, v37
    v_cvt_pk_bf16_f32 v115, v38, v39
    s_waitcnt lgkmcnt(6)
    v_mfma_f32_32x32x16_bf16 v[144:159], v[196:199], v[68:71], v[144:159]
    s_waitcnt lgkmcnt(0)
    s_barrier
    s_add_u32 m0, s67, 0
    s_add_u32 s71, s69, 65536
    buffer_load_dwordx4 v236, s[48:51], s71 offen sc1 nt lds
    s_add_u32 m0, s67, 8192
    s_add_u32 s71, s69, 73728
    buffer_load_dwordx4 v236, s[48:51], s71 offen sc1 nt lds
    ds_read_b128 v[192:195], v224 offset:16384
    v_cvt_pk_bf16_f32 v116, v40, v41
    v_cvt_pk_bf16_f32 v117, v42, v43
    v_mfma_f32_32x32x16_bf16 v[144:159], v[200:203], v[72:75], v[144:159]
    ds_read_b128 v[196:199], v225 offset:16384
    v_cvt_pk_bf16_f32 v118, v44, v45
    v_cvt_pk_bf16_f32 v119, v46, v47
    v_mfma_f32_32x32x16_bf16 v[144:159], v[204:207], v[76:79], v[144:159]
    ds_read_b128 v[200:203], v226 offset:16384
    v_cvt_pk_bf16_f32 v120, v48, v49
    v_cvt_pk_bf16_f32 v121, v50, v51
    v_mfma_f32_32x32x16_bf16 v[144:159], v[208:211], v[80:83], v[144:159]
    ds_read_b128 v[204:207], v227 offset:16384
    v_cvt_pk_bf16_f32 v122, v52, v53
    v_cvt_pk_bf16_f32 v123, v54, v55
    v_mfma_f32_32x32x16_bf16 v[144:159], v[212:215], v[84:87], v[144:159]
    ds_read_b128 v[208:211], v228 offset:16384
    v_cvt_pk_bf16_f32 v124, v56, v57
    v_cvt_pk_bf16_f32 v125, v58, v59
    v_mfma_f32_32x32x16_bf16 v[144:159], v[216:219], v[88:91], v[144:159]
    ds_read_b128 v[212:215], v229 offset:16384
    v_cvt_pk_bf16_f32 v126, v60, v61
    v_cvt_pk_bf16_f32 v127, v62, v63
    v_mfma_f32_32x32x16_bf16 v[144:159], v[220:223], v[92:95], v[144:159]
    ds_read_b128 v[216:219], v230 offset:16384
    v_max3_f32 v244, v128, v129, v130
    v_max3_f32 v244, v244, v131, v132
    v_max3_f32 v244, v244, v133, v134
    v_max3_f32 v244, v244, v135, v136
    v_max3_f32 v244, v244, v137, v138
    v_max3_f32 v244, v244, v139, v140
    v_max3_f32 v244, v244, v141, v142
    s_nop 3
    v_max3_f32 v245, v144, v145, v146
    v_max3_f32 v245, v245, v147, v148
    s_waitcnt lgkmcnt(6)
    v_mfma_f32_32x32x16_bf16 v[160:175], v[192:195], v[64:67], 0
    ds_read_b128 v[220:223], v231 offset:16384
    v_max3_f32 v245, v245, v149, v150
    v_max3_f32 v245, v245, v151, v152
    v_max3_f32 v245, v245, v153, v154
    v_max3_f32 v245, v245, v155, v156
    v_max3_f32 v245, v245, v157, v158
    v_max3_f32 v238, v244, v143, v159
    v_max_f32 v238, v238, v245
    v_mov_b32 v239, v238
    s_nop 1
    v_permlane32_swap_b32 v238, v239
    s_waitcnt lgkmcnt(6)
    v_mfma_f32_32x32x16_bf16 v[160:175], v[196:199], v[68:71], v[160:175]
    ds_read_b128 v[192:195], v224 offset:24576
    v_max_f32 v238, v238, v239
    v_mul_f32 v240, s73, v238
    v_mov_b32 v241, 0
    v_mov_b32 v242, 0
    v_fma_f32 v128, v128, s73, -v240
    v_fma_f32 v129, v129, s73, -v240
    v_fma_f32 v130, v130, s73, -v240
    v_fma_f32 v131, v131, s73, -v240
    v_fma_f32 v132, v132, s73, -v240
    s_waitcnt lgkmcnt(6)
    v_mfma_f32_32x32x16_bf16 v[160:175], v[200:203], v[72:75], v[160:175]
    ds_read_b128 v[196:199], v225 offset:24576
    v_fma_f32 v133, v133, s73, -v240
    v_fma_f32 v134, v134, s73, -v240
    v_fma_f32 v135, v135, s73, -v240
    v_exp_f32 v128, v128
    v_exp_f32 v129, v129
    v_exp_f32 v130, v130
    v_exp_f32 v131, v131
    v_exp_f32 v132, v132
    v_exp_f32 v133, v133
    s_waitcnt lgkmcnt(6)
    v_mfma_f32_32x32x16_bf16 v[160:175], v[204:207], v[76:79], v[160:175]
    ds_read_b128 v[200:203], v226 offset:24576
    v_exp_f32 v134, v134
    v_exp_f32 v135, v135
    v_add_f32 v241, v241, v128
    v_add_f32 v242, v242, v129
    v_add_f32 v241, v241, v130
    v_add_f32 v242, v242, v131
    v_add_f32 v241, v241, v132
    v_add_f32 v242, v242, v133
    v_add_f32 v241, v241, v134
    s_waitcnt lgkmcnt(6)
    v_mfma_f32_32x32x16_bf16 v[160:175], v[208:211], v[80:83], v[160:175]
    ds_read_b128 v[204:207], v227 offset:24576
    v_add_f32 v242, v242, v135
    v_cvt_pk_bf16_f32 v128, v128, v129
    v_cvt_pk_bf16_f32 v129, v130, v131
    v_cvt_pk_bf16_f32 v130, v132, v133
    v_cvt_pk_bf16_f32 v131, v134, v135
    v_fma_f32 v136, v136, s73, -v240
    v_fma_f32 v137, v137, s73, -v240
    v_fma_f32 v138, v138, s73, -v240
    v_fma_f32 v139, v139, s73, -v240
    s_waitcnt lgkmcnt(6)
    v_mfma_f32_32x32x16_bf16 v[160:175], v[212:215], v[84:87], v[160:175]
    ds_read_b128 v[208:211], v228 offset:24576
    v_fma_f32 v140, v140, s73, -v240
    v_fma_f32 v141, v141, s73, -v240
    v_fma_f32 v142, v142, s73, -v240
    v_fma_f32 v143, v143, s73, -v240
    v_exp_f32 v136, v136
    v_exp_f32 v137, v137
    v_exp_f32 v138, v138
    v_exp_f32 v139, v139
    v_exp_f32 v140, v140
    s_waitcnt lgkmcnt(6)
    v_mfma_f32_32x32x16_bf16 v[160:175], v[216:219], v[88:91], v[160:175]
    ds_read_b128 v[212:215], v229 offset:24576
    v_exp_f32 v141, v141
    v_exp_f32 v142, v142
    v_exp_f32 v143, v143
    v_add_f32 v241, v241, v136
    v_add_f32 v242, v242, v137
    v_add_f32 v241, v241, v138
    v_add_f32 v242, v242, v139
    v_add_f32 v241, v241, v140
    v_add_f32 v242, v242, v141
    s_waitcnt lgkmcnt(6)
    v_mfma_f32_32x32x16_bf16 v[160:175], v[220:223], v[92:95], v[160:175]
    ds_read_b128 v[216:219], v230 offset:24576
    v_add_f32 v241, v241, v142
    v_add_f32 v242, v242, v143
    v_cvt_pk_bf16_f32 v136, v136, v137
    v_cvt_pk_bf16_f32 v137, v138, v139
    v_cvt_pk_bf16_f32 v138, v140, v141
    v_cvt_pk_bf16_f32 v139, v142, v143
    v_fma_f32 v144, v144, s73, -v240
    v_fma_f32 v145, v145, s73, -v240
    v_fma_f32 v146, v146, s73, -v240
    s_waitcnt lgkmcnt(6)
    v_mfma_f32_32x32x16_bf16 v[176:191], v[192:195], v[64:67], 0
    ds_read_b128 v[220:223], v231 offset:24576
    v_fma_f32 v147, v147, s73, -v240
    v_fma_f32 v148, v148, s73, -v240
    v_fma_f32 v149, v149, s73, -v240
    v_fma_f32 v150, v150, s73, -v240
    v_fma_f32 v151, v151, s73, -v240
    v_exp_f32 v144, v144
    v_exp_f32 v145, v145
    v_exp_f32 v146, v146
    v_exp_f32 v147, v147
    s_waitcnt lgkmcnt(6)
    v_mfma_f32_32x32x16_bf16 v[176:191], v[196:199], v[68:71], v[176:191]
    s_waitcnt vmcnt(8) lgkmcnt(0)
    s_barrier
    s_add_u32 m0, s67, 16384
    s_add_u32 s71, s69, 81920
    buffer_load_dwordx4 v236, s[48:51], s71 offen sc1 nt lds
    s_add_u32 m0, s67, 24576
    s_add_u32 s71, s69, 90112
    buffer_load_dwordx4 v236, s[48:51], s71 offen sc1 nt lds
    ds_read_b64_tr_b16 v[192:193], v232 offset:0
    ds_read_b64_tr_b16 v[194:195], v232 offset:2048
    v_exp_f32 v148, v148
    v_exp_f32 v149, v149
    v_exp_f32 v150, v150
    v_exp_f32 v151, v151
    v_add_f32 v241, v241, v144
    v_add_f32 v242, v242, v145
    v_add_f32 v241, v241, v146
    v_add_f32 v242, v242, v147
    v_add_f32 v241, v241, v148
    v_mfma_f32_32x32x16_bf16 v[176:191], v[200:203], v[72:75], v[176:191]
    ds_read_b64_tr_b16 v[196:197], v233 offset:0
    ds_read_b64_tr_b16 v[198:199], v233 offset:2048
    v_add_f32 v242, v242, v149
    v_add_f32 v241, v241, v150
    v_add_f32 v242, v242, v151
    v_cvt_pk_bf16_f32 v144, v144, v145
    v_cvt_pk_bf16_f32 v145, v146, v147
    v_cvt_pk_bf16_f32 v146, v148, v149
    v_cvt_pk_bf16_f32 v147, v150, v151
    v_fma_f32 v152, v152, s73, -v240
    v_fma_f32 v153, v153, s73, -v240
    v_mfma_f32_32x32x16_bf16 v[176:191], v[204:207], v[76:79], v[176:191]
    ds_read_b64_tr_b16 v[200:201], v234 offset:0
    ds_read_b64_tr_b16 v[202:203], v234 offset:2048
    v_fma_f32 v154, v154, s73, -v240
    v_fma_f32 v155, v155, s73, -v240
    v_fma_f32 v156, v156, s73, -v240
    v_fma_f32 v157, v157, s73, -v240
    v_fma_f32 v158, v158, s73, -v240
    v_fma_f32 v159, v159, s73, -v240
    v_exp_f32 v152, v152
    v_exp_f32 v153, v153
    v_exp_f32 v154, v154
    v_mfma_f32_32x32x16_bf16 v[176:191], v[208:211], v[80:83], v[176:191]
    ds_read_b64_tr_b16 v[204:205], v235 offset:0
    ds_read_b64_tr_b16 v[206:207], v235 offset:2048
    v_exp_f32 v155, v155
    v_exp_f32 v156, v156
    v_exp_f32 v157, v157
    v_exp_f32 v158, v158
    v_exp_f32 v159, v159
    v_add_f32 v241, v241, v152
    v_add_f32 v242, v242, v153
    v_add_f32 v241, v241, v154
    v_add_f32 v242, v242, v155
    v_mfma_f32_32x32x16_bf16 v[176:191], v[212:215], v[84:87], v[176:191]
    ds_read_b64_tr_b16 v[208:209], v232 offset:4096
    ds_read_b64_tr_b16 v[210:211], v232 offset:6144
    v_add_f32 v241, v241, v156
    v_add_f32 v242, v242, v157
    v_add_f32 v241, v241, v158
    v_add_f32 v242, v242, v159
    v_cvt_pk_bf16_f32 v152, v152, v153
    v_cvt_pk_bf16_f32 v153, v154, v155
    v_cvt_pk_bf16_f32 v154, v156, v157
    v_cvt_pk_bf16_f32 v155, v158, v159
    v_mfma_f32_32x32x16_bf16 v[176:191], v[216:219], v[88:91], v[176:191]
    ds_read_b64_tr_b16 v[212:213], v233 offset:4096
    ds_read_b64_tr_b16 v[214:215], v233 offset:6144
    v_mfma_f32_32x32x16_bf16 v[176:191], v[220:223], v[92:95], v[176:191]
    ds_read_b64_tr_b16 v[216:217], v234 offset:4096
    ds_read_b64_tr_b16 v[218:219], v234 offset:6144
    v_max3_f32 v244, v160, v161, v162
    v_max3_f32 v244, v244, v163, v164
    v_max3_f32 v244, v244, v165, v166
    v_max3_f32 v244, v244, v167, v168
    v_max3_f32 v244, v244, v169, v170
    s_waitcnt lgkmcnt(12)
    v_mfma_f32_32x32x16_bf16 v[0:15], v[192:195], v[128:131], 0
    ds_read_b64_tr_b16 v[220:221], v235 offset:4096
    ds_read_b64_tr_b16 v[222:223], v235 offset:6144
    v_max3_f32 v244, v244, v171, v172
    v_max3_f32 v244, v244, v173, v174
    v_max3_f32 v245, v176, v177, v178
    v_max3_f32 v245, v245, v179, v180
    v_max3_f32 v245, v245, v181, v182
    s_waitcnt lgkmcnt(12)
    v_mfma_f32_32x32x16_bf16 v[16:31], v[196:199], v[128:131], 0
    ds_read_b64_tr_b16 v[192:193], v232 offset:8192
    ds_read_b64_tr_b16 v[194:195], v232 offset:10240
    v_max3_f32 v245, v245, v183, v184
    v_max3_f32 v245, v245, v185, v186
    v_max3_f32 v245, v245, v187, v188
    v_max3_f32 v245, v245, v189, v190
    v_max3_f32 v238, v244, v175, v191
    s_waitcnt lgkmcnt(12)
    v_mfma_f32_32x32x16_bf16 v[32:47], v[200:203], v[128:131], 0
    ds_read_b64_tr_b16 v[196:197], v233 offset:8192
    ds_read_b64_tr_b16 v[198:199], v233 offset:10240
    v_max_f32 v238, v238, v245
    v_mov_b32 v239, v238
    s_nop 1
    v_permlane32_swap_b32 v238, v239
    v_max_f32 v238, v238, v239
    v_fma_f32 v239, v238, s73, -v240
    s_waitcnt lgkmcnt(12)
    v_mfma_f32_32x32x16_bf16 v[48:63], v[204:207], v[128:131], 0
    ds_read_b64_tr_b16 v[200:201], v234 offset:8192
    ds_read_b64_tr_b16 v[202:203], v234 offset:10240
    v_cmp_lt_f32 vcc, s74, v239
    s_cbranch_vccnz L_rare1_1
L_back1_1:
    v_fma_f32 v160, v160, s73, -v240
    v_fma_f32 v161, v161, s73, -v240
    s_waitcnt lgkmcnt(12)
    v_mfma_f32_32x32x16_bf16 v[0:15], v[208:211], v[136:139], v[0:15]
    ds_read_b64_tr_b16 v[204:205], v235 offset:8192
    ds_read_b64_tr_b16 v[206:207], v235 offset:10240
    v_fma_f32 v162, v162, s73, -v240
    v_fma_f32 v163, v163, s73, -v240
    v_fma_f32 v164, v164, s73, -v240
    v_fma_f32 v165, v165, s73, -v240
    v_fma_f32 v166, v166, s73, -v240
    s_waitcnt lgkmcnt(12)
    v_mfma_f32_32x32x16_bf16 v[16:31], v[212:215], v[136:139], v[16:31]
    ds_read_b64_tr_b16 v[208:209], v232 offset:12288
    ds_read_b64_tr_b16 v[210:211], v232 offset:14336
    v_fma_f32 v167, v167, s73, -v240
    v_exp_f32 v160, v160
    v_exp_f32 v161, v161
    v_exp_f32 v162, v162
    v_exp_f32 v163, v163
    s_waitcnt lgkmcnt(12)
    v_mfma_f32_32x32x16_bf16 v[32:47], v[216:219], v[136:139], v[32:47]
    ds_read_b64_tr_b16 v[212:213], v233 offset:12288
    ds_read_b64_tr_b16 v[214:215], v233 offset:14336
    v_exp_f32 v164, v164
    v_exp_f32 v165, v165
    v_exp_f32 v166, v166
    v_exp_f32 v167, v167
    v_add_f32 v241, v241, v160
    s_waitcnt lgkmcnt(12)
    v_mfma_f32_32x32x16_bf16 v[48:63], v[220:223], v[136:139], v[48:63]
    ds_read_b64_tr_b16 v[216:217], v234 offset:12288
    ds_read_b64_tr_b16 v[218:219], v234 offset:14336
    v_add_f32 v242, v242, v161
    v_add_f32 v241, v241, v162
    v_add_f32 v242, v242, v163
    v_add_f32 v241, v241, v164
    v_add_f32 v242, v242, v165
    s_waitcnt lgkmcnt(12)
    v_mfma_f32_32x32x16_bf16 v[0:15], v[192:195], v[144:147], v[0:15]
    ds_read_b64_tr_b16 v[220:221], v235 offset:12288
    ds_read_b64_tr_b16 v[222:223], v235 offset:14336
    v_add_f32 v241, v241, v166
    v_add_f32 v242, v242, v167
    v_cvt_pk_bf16_f32 v160, v160, v161
    v_cvt_pk_bf16_f32 v161, v162, v163
    v_cvt_pk_bf16_f32 v162, v164, v165
    s_waitcnt lgkmcnt(12)
    v_mfma_f32_32x32x16_bf16 v[16:31], v[196:199], v[144:147], v[16:31]
    ds_read_b128 v[192:195], v224 offset:32768
    v_cvt_pk_bf16_f32 v163, v166, v167
    v_fma_f32 v168, v168, s73, -v240
    v_fma_f32 v169, v169, s73, -v240
    v_fma_f32 v170, v170, s73, -v240
    v_fma_f32 v171, v171, s73, -v240
    s_waitcnt lgkmcnt(11)
    v_mfma_f32_32x32x16_bf16 v[32:47], v[200:203], v[144:147], v[32:47]
    ds_read_b128 v[196:199], v225 offset:32768
    v_fma_f32 v172, v172, s73, -v240
    v_fma_f32 v173, v173, s73, -v240
    v_fma_f32 v174, v174, s73, -v240
    v_fma_f32 v175, v175, s73, -v240
    v_exp_f32 v168, v168
    s_waitcnt lgkmcnt(10)
    v_mfma_f32_32x32x16_bf16 v[48:63], v[204:207], v[144:147], v[48:63]
    ds_read_b128 v[200:203], v226 offset:32768
    v_exp_f32 v169, v169
    v_exp_f32 v170, v170
    v_exp_f32 v171, v171
    v_exp_f32 v172, v172
    v_exp_f32 v173, v173
    s_waitcnt lgkmcnt(9)
    v_mfma_f32_32x32x16_bf16 v[0:15], v[208:211], v[152:155], v[0:15]
    ds_read_b128 v[204:207], v227 offset:32768
    v_exp_f32 v174, v174
    v_exp_f32 v175, v175
    v_add_f32 v241, v241, v168
    v_add_f32 v242, v242, v169
    v_add_f32 v241, v241, v170
    s_waitcnt lgkmcnt(8)
    v_mfma_f32_32x32x16_bf16 v[16:31], v[212:215], v[152:155], v[16:31]
    ds_read_b128 v[208:211], v228 offset:32768
    v_add_f32 v242, v242, v171
    v_add_f32 v241, v241, v172
    v_add_f32 v242, v242, v173
    v_add_f32 v241, v241, v174
    v_add_f32 v242, v242, v175
    s_waitcnt lgkmcnt(7)
    v_mfma_f32_32x32x16_bf16 v[32:47], v[216:219], v[152:155], v[32:47]
    ds_read_b128 v[212:215], v229 offset:32768
    v_cvt_pk_bf16_f32 v168, v168, v169
    v_cvt_pk_bf16_f32 v169, v170, v171
    v_cvt_pk_bf16_f32 v170, v172, v173
    v_cvt_pk_bf16_f32 v171, v174, v175
    v_fma_f32 v176, v176, s73, -v240
    s_waitcnt lgkmcnt(6)
    v_mfma_f32_32x32x16_bf16 v[48:63], v[220:223], v[152:155], v[48:63]
    ds_read_b128 v[216:219], v230 offset:32768
    s_cmp_lg_u32 s72, 0
    s_cbranch_scc1 L_rare2_1
L_back2_1:
    v_fma_f32 v177, v177, s73, -v240
    v_fma_f32 v178, v178, s73, -v240
    v_fma_f32 v179, v179, s73, -v240
    v_fma_f32 v180, v180, s73, -v240
    v_fma_f32 v181, v181, s73, -v240
    s_waitcnt lgkmcnt(6)
    v_mfma_f32_32x32x16_bf16 v[128:143], v[192:195], v[64:67], 0
    ds_read_b128 v[220:223], v231 offset:32768
    v_fma_f32 v182, v182, s73, -v240
    v_fma_f32 v183, v183, s73, -v240
    v_exp_f32 v176, v176
    v_exp_f32 v177, v177
    v_exp_f32 v178, v178
    s_waitcnt lgkmcnt(6)
    v_mfma_f32_32x32x16_bf16 v[128:143], v[196:199], v[68:71], v[128:143]
    ds_read_b128 v[192:195], v224 offset:40960
    v_exp_f32 v179, v179
    v_exp_f32 v180, v180
    v_exp_f32 v181, v181
    v_exp_f32 v182, v182
    v_exp_f32 v183, v183
    s_waitcnt lgkmcnt(6)
    v_mfma_f32_32x32x16_bf16 v[128:143], v[200:203], v[72:75], v[128:143]
    ds_read_b128 v[196:199], v225 offset:40960
    v_add_f32 v241, v241, v176
    v_add_f32 v242, v242, v177
    v_add_f32 v241, v241, v178
    v_add_f32 v242, v242, v179
    v_add_f32 v241, v241, v180
    s_waitcnt lgkmcnt(6)
    v_mfma_f32_32x32x16_bf16 v[128:143], v[204:207], v[76:79], v[128:143]
    ds_read_b128 v[200:203], v226 offset:40960
    v_add_f32 v242, v242, v181
    v_add_f32 v241, v241, v182
    v_add_f32 v242, v242, v183
    v_cvt_pk_bf16_f32 v176, v176, v177
    v_cvt_pk_bf16_f32 v177, v178, v179
    s_waitcnt lgkmcnt(6)
    v_mfma_f32_32x32x16_bf16 v[128:143], v[208:211], v[80:83], v[128:143]
    ds_read_b128 v[204:207], v227 offset:40960
    v_cvt_pk_bf16_f32 v178, v180, v181
    v_cvt_pk_bf16_f32 v179, v182, v183
    v_fma_f32 v184, v184, s73, -v240
    v_fma_f32 v185, v185, s73, -v240
    v_fma_f32 v186, v186, s73, -v240
    s_waitcnt lgkmcnt(6)
    v_mfma_f32_32x32x16_bf16 v[128:143], v[212:215], v[84:87], v[128:143]
    ds_read_b128 v[208:211], v228 offset:40960
    v_fma_f32 v187, v187, s73, -v240
    v_fma_f32 v188, v188, s73, -v240
    v_fma_f32 v189, v189, s73, -v240
    v_fma_f32 v190, v190, s73, -v240
    v_fma_f32 v191, v191, s73, -v240
    s_waitcnt lgkmcnt(6)
    v_mfma_f32_32x32x16_bf16 v[128:143], v[216:219], v[88:91], v[128:143]
    ds_read_b128 v[212:215], v229 offset:40960
    v_exp_f32 v184, v184
    v_exp_f32 v185, v185
    v_exp_f32 v186, v186
    v_exp_f32 v187, v187
    v_exp_f32 v188, v188
    s_waitcnt lgkmcnt(6)
    v_mfma_f32_32x32x16_bf16 v[128:143], v[220:223], v[92:95], v[128:143]
    ds_read_b128 v[216:219], v230 offset:40960
    v_exp_f32 v189, v189
    v_exp_f32 v190, v190
    v_exp_f32 v191, v191
    v_add_f32 v241, v241, v184
    v_add_f32 v242, v242, v185
    s_waitcnt lgkmcnt(6)
    v_mfma_f32_32x32x16_bf16 v[144:159], v[192:195], v[64:67], 0
    ds_read_b128 v[220:223], v231 offset:40960
    v_add_f32 v241, v241, v186
    v_add_f32 v242, v242, v187
    v_add_f32 v241, v241, v188
    v_add_f32 v242, v242, v189
    v_add_f32 v241, v241, v190
    s_waitcnt lgkmcnt(6)
    v_mfma_f32_32x32x16_bf16 v[144:159], v[196:199], v[68:71], v[144:159]
    s_waitcnt vmcnt(8) lgkmcnt(0)
    s_barrier
    s_add_u32 m0, s67, 32768
    s_add_u32 s71, s69, 98304
    buffer_load_dwordx4 v236, s[48:51], s71 offen sc1 nt lds
    s_add_u32 m0, s67, 40960
    s_add_u32 s71, s69, 106496
    buffer_load_dwordx4 v236, s[48:51], s71 offen sc1 nt lds
    s_add_u32 m0, s67, 65536
    s_add_u32 s71, s69, 65536
    buffer_load_dwordx4 v237, s[52:55], s71 offen sc1 nt lds
    s_add_u32 m0, s67, 73728
    s_add_u32 s71, s69, 73728
    buffer_load_dwordx4 v237, s[52:55], s71 offen sc1 nt lds
    ds_read_b64_tr_b16 v[192:193], v232 offset:16384
    ds_read_b64_tr_b16 v[194:195], v232 offset:18432
    v_add_f32 v242, v242, v191
    v_cvt_pk_bf16_f32 v184, v184, v185
    v_cvt_pk_bf16_f32 v185, v186, v187
    v_cvt_pk_bf16_f32 v186, v188, v189
    v_cvt_pk_bf16_f32 v187, v190, v191
    v_mfma_f32_32x32x16_bf16 v[144:159], v[200:203], v[72:75], v[144:159]
    ds_read_b64_tr_b16 v[196:197], v233 offset:16384
    ds_read_b64_tr_b16 v[198:199], v233 offset:18432
    v_mfma_f32_32x32x16_bf16 v[144:159], v[204:207], v[76:79], v[144:159]
    ds_read_b64_tr_b16 v[200:201], v234 offset:16384
    ds_read_b64_tr_b16 v[202:203], v234 offset:18432
    v_mfma_f32_32x32x16_bf16 v[144:159], v[208:211], v[80:83], v[144:159]
    ds_read_b64_tr_b16 v[204:205], v235 offset:16384
    ds_read_b64_tr_b16 v[206:207], v235 offset:18432
    v_mfma_f32_32x32x16_bf16 v[144:159], v[212:215], v[84:87], v[144:159]
    ds_read_b64_tr_b16 v[208:209], v232 offset:20480
    ds_read_b64_tr_b16 v[210:211], v232 offset:22528
    v_mfma_f32_32x32x16_bf16 v[144:159], v[216:219], v[88:91], v[144:159]
    ds_read_b64_tr_b16 v[212:213], v233 offset:20480
    ds_read_b64_tr_b16 v[214:215], v233 offset:22528
    v_mfma_f32_32x32x16_bf16 v[144:159], v[220:223], v[92:95], v[144:159]
    ds_read_b64_tr_b16 v[216:217], v234 offset:20480
    ds_read_b64_tr_b16 v[218:219], v234 offset:22528
    v_max3_f32 v244, v128, v129, v130
    v_max3_f32 v244, v244, v131, v132
    v_max3_f32 v244, v244, v133, v134
    v_max3_f32 v244, v244, v135, v136
    v_max3_f32 v244, v244, v137, v138
    s_waitcnt lgkmcnt(12)
    v_mfma_f32_32x32x16_bf16 v[0:15], v[192:195], v[160:163], v[0:15]
    ds_read_b64_tr_b16 v[220:221], v235 offset:20480
    ds_read_b64_tr_b16 v[222:223], v235 offset:22528
    v_max3_f32 v244, v244, v139, v140
    v_max3_f32 v244, v244, v141, v142
    v_max3_f32 v245, v144, v145, v146
    v_max3_f32 v245, v245, v147, v148
    v_max3_f32 v245, v245, v149, v150
    s_waitcnt lgkmcnt(12)
    v_mfma_f32_32x32x16_bf16 v[16:31], v[196:199], v[160:163], v[16:31]
    ds_read_b64_tr_b16 v[192:193], v232 offset:24576
    ds_read_b64_tr_b16 v[194:195], v232 offset:26624
    v_max3_f32 v245, v245, v151, v152
    v_max3_f32 v245, v245, v153, v154
    v_max3_f32 v245, v245, v155, v156
    v_max3_f32 v245, v245, v157, v158
    v_max3_f32 v238, v244, v143, v159
    s_waitcnt lgkmcnt(12)
    v_mfma_f32_32x32x16_bf16 v[32:47], v[200:203], v[160:163], v[32:47]
    ds_read_b64_tr_b16 v[196:197], v233 offset:24576
    ds_read_b64_tr_b16 v[198:199], v233 offset:26624
    v_max_f32 v238, v238, v245
    v_mov_b32 v239, v238
    s_nop 1
    v_permlane32_swap_b32 v238, v239
    v_max_f32 v238, v238, v239
    v_fma_f32 v239, v238, s73, -v240
    s_waitcnt lgkmcnt(12)
    v_mfma_f32_32x32x16_bf16 v[48:63], v[204:207], v[160:163], v[48:63]
    ds_read_b64_tr_b16 v[200:201], v234 offset:24576
    ds_read_b64_tr_b16 v[202:203], v234 offset:26624
    v_cmp_lt_f32 vcc, s74, v239
    s_cbranch_vccnz L_rare1_2
L_back1_2:
    v_fma_f32 v128, v128, s73, -v240
    v_fma_f32 v129, v129, s73, -v240
    s_waitcnt lgkmcnt(12)
    v_mfma_f32_32x32x16_bf16 v[0:15], v[208:211], v[168:171], v[0:15]
    ds_read_b64_tr_b16 v[204:205], v235 offset:24576
    ds_read_b64_tr_b16 v[206:207], v235 offset:26624
    v_fma_f32 v130, v130, s73, -v240
    v_fma_f32 v131, v131, s73, -v240
    v_fma_f32 v132, v132, s73, -v240
    v_fma_f32 v133, v133, s73, -v240
    v_fma_f32 v134, v134, s73, -v240
    s_waitcnt lgkmcnt(12)
    v_mfma_f32_32x32x16_bf16 v[16:31], v[212:215], v[168:171], v[16:31]
    ds_read_b64_tr_b16 v[208:209], v232 offset:28672
    ds_read_b64_tr_b16 v[210:211], v232 offset:30720
    v_fma_f32 v135, v135, s73, -v240
    v_exp_f32 v128, v128
    v_exp_f32 v129, v129
    v_exp_f32 v130, v130
    v_exp_f32 v131, v131
    s_waitcnt lgkmcnt(12)
    v_mfma_f32_32x32x16_bf16 v[32:47], v[216:219], v[168:171], v[32:47]
    ds_read_b64_tr_b16 v[212:213], v233 offset:28672
    ds_read_b64_tr_b16 v[214:215], v233 offset:30720
    v_exp_f32 v132, v132
    v_exp_f32 v133, v133
    v_exp_f32 v134, v134
    v_exp_f32 v135, v135
    v_add_f32 v241, v241, v128
    s_waitcnt lgkmcnt(12)
    v_mfma_f32_32x32x16_bf16 v[48:63], v[220:223], v[168:171], v[48:63]
    ds_read_b64_tr_b16 v[216:217], v234 offset:28672
    ds_read_b64_tr_b16 v[218:219], v234 offset:30720
    v_add_f32 v242, v242, v129
    v_add_f32 v241, v241, v130
    v_add_f32 v242, v242, v131
    v_add_f32 v241, v241, v132
    v_add_f32 v242, v242, v133
    s_waitcnt lgkmcnt(12)
    v_mfma_f32_32x32x16_bf16 v[0:15], v[192:195], v[176:179], v[0:15]
    ds_read_b64_tr_b16 v[220:221], v235 offset:28672
    ds_read_b64_tr_b16 v[222:223], v235 offset:30720
    v_add_f32 v241, v241, v134
    v_add_f32 v242, v242, v135
    v_cvt_pk_bf16_f32 v128, v128, v129
    v_cvt_pk_bf16_f32 v129, v130, v131
    v_cvt_pk_bf16_f32 v130, v132, v133
    s_waitcnt lgkmcnt(12)
    v_mfma_f32_32x32x16_bf16 v[16:31], v[196:199], v[176:179], v[16:31]
    ds_read_b128 v[192:195], v224 offset:49152
    v_cvt_pk_bf16_f32 v131, v134, v135
    v_fma_f32 v136, v136, s73, -v240
    v_fma_f32 v137, v137, s73, -v240
    v_fma_f32 v138, v138, s73, -v240
    v_fma_f32 v139, v139, s73, -v240
    s_waitcnt lgkmcnt(11)
    v_mfma_f32_32x32x16_bf16 v[32:47], v[200:203], v[176:179], v[32:47]
    ds_read_b128 v[196:199], v225 offset:49152
    v_fma_f32 v140, v140, s73, -v240
    v_fma_f32 v141, v141, s73, -v240
    v_fma_f32 v142, v142, s73, -v240
    v_fma_f32 v143, v143, s73, -v240
    v_exp_f32 v136, v136
    s_waitcnt lgkmcnt(10)
    v_mfma_f32_32x32x16_bf16 v[48:63], v[204:207], v[176:179], v[48:63]
    ds_read_b128 v[200:203], v226 offset:49152
    v_exp_f32 v137, v137
    v_exp_f32 v138, v138
    v_exp_f32 v139, v139
    v_exp_f32 v140, v140
    v_exp_f32 v141, v141
    s_waitcnt lgkmcnt(9)
    v_mfma_f32_32x32x16_bf16 v[0:15], v[208:211], v[184:187], v[0:15]
    ds_read_b128 v[204:207], v227 offset:49152
    v_exp_f32 v142, v142
    v_exp_f32 v143, v143
    v_add_f32 v241, v241, v136
    v_add_f32 v242, v242, v137
    v_add_f32 v241, v241, v138
    s_waitcnt lgkmcnt(8)
    v_mfma_f32_32x32x16_bf16 v[16:31], v[212:215], v[184:187], v[16:31]
    ds_read_b128 v[208:211], v228 offset:49152
    v_add_f32 v242, v242, v139
    v_add_f32 v241, v241, v140
    v_add_f32 v242, v242, v141
    v_add_f32 v241, v241, v142
    v_add_f32 v242, v242, v143
    s_waitcnt lgkmcnt(7)
    v_mfma_f32_32x32x16_bf16 v[32:47], v[216:219], v[184:187], v[32:47]
    ds_read_b128 v[212:215], v229 offset:49152
    v_cvt_pk_bf16_f32 v136, v136, v137
    v_cvt_pk_bf16_f32 v137, v138, v139
    v_cvt_pk_bf16_f32 v138, v140, v141
    v_cvt_pk_bf16_f32 v139, v142, v143
    v_fma_f32 v144, v144, s73, -v240
    s_waitcnt lgkmcnt(6)
    v_mfma_f32_32x32x16_bf16 v[48:63], v[220:223], v[184:187], v[48:63]
    ds_read_b128 v[216:219], v230 offset:49152
    s_cmp_lg_u32 s72, 0
    s_cbranch_scc1 L_rare2_2
L_back2_2:
    v_fma_f32 v145, v145, s73, -v240
    v_fma_f32 v146, v146, s73, -v240
    v_fma_f32 v147, v147, s73, -v240
    v_fma_f32 v148, v148, s73, -v240
    v_fma_f32 v149, v149, s73, -v240
    s_waitcnt lgkmcnt(6)
    v_mfma_f32_32x32x16_bf16 v[160:175], v[192:195], v[64:67], 0
    ds_read_b128 v[220:223], v231 offset:49152
    v_fma_f32 v150, v150, s73, -v240
    v_fma_f32 v151, v151, s73, -v240
    v_exp_f32 v144, v144
    v_exp_f32 v145, v145
    v_exp_f32 v146, v146
    s_waitcnt lgkmcnt(6)
    v_mfma_f32_32x32x16_bf16 v[160:175], v[196:199], v[68:71], v[160:175]
    ds_read_b128 v[192:195], v224 offset:57344
    v_exp_f32 v147, v147
    v_exp_f32 v148, v148
    v_exp_f32 v149, v149
    v_exp_f32 v150, v150
    v_exp_f32 v151, v151
    s_waitcnt lgkmcnt(6)
    v_mfma_f32_32x32x16_bf16 v[160:175], v[200:203], v[72:75], v[160:175]
    ds_read_b128 v[196:199], v225 offset:57344
    v_add_f32 v241, v241, v144
    v_add_f32 v242, v242, v145
    v_add_f32 v241, v241, v146
    v_add_f32 v242, v242, v147
    v_add_f32 v241, v241, v148
    s_waitcnt lgkmcnt(6)
    v_mfma_f32_32x32x16_bf16 v[160:175], v[204:207], v[76:79], v[160:175]
    ds_read_b128 v[200:203], v226 offset:57344
    v_add_f32 v242, v242, v149
    v_add_f32 v241, v241, v150
    v_add_f32 v242, v242, v151
    v_cvt_pk_bf16_f32 v144, v144, v145
    v_cvt_pk_bf16_f32 v145, v146, v147
    s_waitcnt lgkmcnt(6)
    v_mfma_f32_32x32x16_bf16 v[160:175], v[208:211], v[80:83], v[160:175]
    ds_read_b128 v[204:207], v227 offset:57344
    v_cvt_pk_bf16_f32 v146, v148, v149
    v_cvt_pk_bf16_f32 v147, v150, v151
    v_fma_f32 v152, v152, s73, -v240
    v_fma_f32 v153, v153, s73, -v240
    v_fma_f32 v154, v154, s73, -v240
    s_waitcnt lgkmcnt(6)
    v_mfma_f32_32x32x16_bf16 v[160:175], v[212:215], v[84:87], v[160:175]
    ds_read_b128 v[208:211], v228 offset:57344
    v_fma_f32 v155, v155, s73, -v240
    v_fma_f32 v156, v156, s73, -v240
    v_fma_f32 v157, v157, s73, -v240
    v_fma_f32 v158, v158, s73, -v240
    v_fma_f32 v159, v159, s73, -v240
    s_waitcnt lgkmcnt(6)
    v_mfma_f32_32x32x16_bf16 v[160:175], v[216:219], v[88:91], v[160:175]
    ds_read_b128 v[212:215], v229 offset:57344
    v_exp_f32 v152, v152
    v_exp_f32 v153, v153
    v_exp_f32 v154, v154
    v_exp_f32 v155, v155
    v_exp_f32 v156, v156
    s_waitcnt lgkmcnt(6)
    v_mfma_f32_32x32x16_bf16 v[160:175], v[220:223], v[92:95], v[160:175]
    ds_read_b128 v[216:219], v230 offset:57344
    v_exp_f32 v157, v157
    v_exp_f32 v158, v158
    v_exp_f32 v159, v159
    v_add_f32 v241, v241, v152
    v_add_f32 v242, v242, v153
    s_waitcnt lgkmcnt(6)
    v_mfma_f32_32x32x16_bf16 v[176:191], v[192:195], v[64:67], 0
    ds_read_b128 v[220:223], v231 offset:57344
    v_add_f32 v241, v241, v154
    v_add_f32 v242, v242, v155
    v_add_f32 v241, v241, v156
    v_add_f32 v242, v242, v157
    v_add_f32 v241, v241, v158
    s_waitcnt lgkmcnt(6)
    v_mfma_f32_32x32x16_bf16 v[176:191], v[196:199], v[68:71], v[176:191]
    s_waitcnt vmcnt(6) lgkmcnt(0)
    s_barrier
    s_add_u32 m0, s67, 49152
    s_add_u32 s71, s69, 114688
    buffer_load_dwordx4 v236, s[48:51], s71 offen sc1 nt lds
    s_add_u32 m0, s67, 57344
    s_add_u32 s71, s69, 122880
    buffer_load_dwordx4 v236, s[48:51], s71 offen sc1 nt lds
    s_add_u32 m0, s67, 81920
    s_add_u32 s71, s69, 81920
    buffer_load_dwordx4 v237, s[52:55], s71 offen sc1 nt lds
    s_add_u32 m0, s67, 90112
    s_add_u32 s71, s69, 90112
    buffer_load_dwordx4 v237, s[52:55], s71 offen sc1 nt lds
    ds_read_b64_tr_b16 v[192:193], v232 offset:32768
    ds_read_b64_tr_b16 v[194:195], v232 offset:34816
    v_add_f32 v242, v242, v159
    v_cvt_pk_bf16_f32 v152, v152, v153
    v_cvt_pk_bf16_f32 v153, v154, v155
    v_cvt_pk_bf16_f32 v154, v156, v157
    v_cvt_pk_bf16_f32 v155, v158, v159
    v_mfma_f32_32x32x16_bf16 v[176:191], v[200:203], v[72:75], v[176:191]
    ds_read_b64_tr_b16 v[196:197], v233 offset:32768
    ds_read_b64_tr_b16 v[198:199], v233 offset:34816
    v_mfma_f32_32x32x16_bf16 v[176:191], v[204:207], v[76:79], v[176:191]
    ds_read_b64_tr_b16 v[200:201], v234 offset:32768
    ds_read_b64_tr_b16 v[202:203], v234 offset:34816
    v_mfma_f32_32x32x16_bf16 v[176:191], v[208:211], v[80:83], v[176:191]
    ds_read_b64_tr_b16 v[204:205], v235 offset:32768
    ds_read_b64_tr_b16 v[206:207], v235 offset:34816
    v_mfma_f32_32x32x16_bf16 v[176:191], v[212:215], v[84:87], v[176:191]
    ds_read_b64_tr_b16 v[208:209], v232 offset:36864
    ds_read_b64_tr_b16 v[210:211], v232 offset:38912
    v_mfma_f32_32x32x16_bf16 v[176:191], v[216:219], v[88:91], v[176:191]
    ds_read_b64_tr_b16 v[212:213], v233 offset:36864
    ds_read_b64_tr_b16 v[214:215], v233 offset:38912
    v_mfma_f32_32x32x16_bf16 v[176:191], v[220:223], v[92:95], v[176:191]
    ds_read_b64_tr_b16 v[216:217], v234 offset:36864
    ds_read_b64_tr_b16 v[218:219], v234 offset:38912
    v_max3_f32 v244, v160, v161, v162
    v_max3_f32 v244, v244, v163, v164
    v_max3_f32 v244, v244, v165, v166
    v_max3_f32 v244, v244, v167, v168
    v_max3_f32 v244, v244, v169, v170
    s_waitcnt lgkmcnt(12)
    v_mfma_f32_32x32x16_bf16 v[0:15], v[192:195], v[128:131], v[0:15]
    ds_read_b64_tr_b16 v[220:221], v235 offset:36864
    ds_read_b64_tr_b16 v[222:223], v235 offset:38912
    v_max3_f32 v244, v244, v171, v172
    v_max3_f32 v244, v244, v173, v174
    v_max3_f32 v245, v176, v177, v178
    v_max3_f32 v245, v245, v179, v180
    v_max3_f32 v245, v245, v181, v182
    s_waitcnt lgkmcnt(12)
    v_mfma_f32_32x32x16_bf16 v[16:31], v[196:199], v[128:131], v[16:31]
    ds_read_b64_tr_b16 v[192:193], v232 offset:40960
    ds_read_b64_tr_b16 v[194:195], v232 offset:43008
    v_max3_f32 v245, v245, v183, v184
    v_max3_f32 v245, v245, v185, v186
    v_max3_f32 v245, v245, v187, v188
    v_max3_f32 v245, v245, v189, v190
    v_max3_f32 v238, v244, v175, v191
    s_waitcnt lgkmcnt(12)
    v_mfma_f32_32x32x16_bf16 v[32:47], v[200:203], v[128:131], v[32:47]
    ds_read_b64_tr_b16 v[196:197], v233 offset:40960
    ds_read_b64_tr_b16 v[198:199], v233 offset:43008
    v_max_f32 v238, v238, v245
    v_mov_b32 v239, v238
    s_nop 1
    v_permlane32_swap_b32 v238, v239
    v_max_f32 v238, v238, v239
    v_fma_f32 v239, v238, s73, -v240
    s_waitcnt lgkmcnt(12)
    v_mfma_f32_32x32x16_bf16 v[48:63], v[204:207], v[128:131], v[48:63]
    ds_read_b64_tr_b16 v[200:201], v234 offset:40960
    ds_read_b64_tr_b16 v[202:203], v234 offset:43008
    v_cmp_lt_f32 vcc, s74, v239
    s_cbranch_vccnz L_rare1_3
L_back1_3:
    v_fma_f32 v160, v160, s73, -v240
    v_fma_f32 v161, v161, s73, -v240
    s_waitcnt lgkmcnt(12)
    v_mfma_f32_32x32x16_bf16 v[0:15], v[208:211], v[136:139], v[0:15]
    ds_read_b64_tr_b16 v[204:205], v235 offset:40960
    ds_read_b64_tr_b16 v[206:207], v235 offset:43008
    v_fma_f32 v162, v162, s73, -v240
    v_fma_f32 v163, v163, s73, -v240
    v_fma_f32 v164, v164, s73, -v240
    v_fma_f32 v165, v165, s73, -v240
    v_fma_f32 v166, v166, s73, -v240
    s_waitcnt lgkmcnt(12)
    v_mfma_f32_32x32x16_bf16 v[16:31], v[212:215], v[136:139], v[16:31]
    ds_read_b64_tr_b16 v[208:209], v232 offset:45056
    ds_read_b64_tr_b16 v[210:211], v232 offset:47104
    v_fma_f32 v167, v167, s73, -v240
    v_exp_f32 v160, v160
    v_exp_f32 v161, v161
    v_exp_f32 v162, v162
    v_exp_f32 v163, v163
    s_waitcnt lgkmcnt(12)
    v_mfma_f32_32x32x16_bf16 v[32:47], v[216:219], v[136:139], v[32:47]
    ds_read_b64_tr_b16 v[212:213], v233 offset:45056
    ds_read_b64_tr_b16 v[214:215], v233 offset:47104
    v_exp_f32 v164, v164
    v_exp_f32 v165, v165
    v_exp_f32 v166, v166
    v_exp_f32 v167, v167
    v_add_f32 v241, v241, v160
    s_waitcnt lgkmcnt(12)
    v_mfma_f32_32x32x16_bf16 v[48:63], v[220:223], v[136:139], v[48:63]
    ds_read_b64_tr_b16 v[216:217], v234 offset:45056
    ds_read_b64_tr_b16 v[218:219], v234 offset:47104
    v_add_f32 v242, v242, v161
    v_add_f32 v241, v241, v162
    v_add_f32 v242, v242, v163
    v_add_f32 v241, v241, v164
    v_add_f32 v242, v242, v165
    s_waitcnt lgkmcnt(12)
    v_mfma_f32_32x32x16_bf16 v[0:15], v[192:195], v[144:147], v[0:15]
    ds_read_b64_tr_b16 v[220:221], v235 offset:45056
    ds_read_b64_tr_b16 v[222:223], v235 offset:47104
    v_add_f32 v241, v241, v166
    v_add_f32 v242, v242, v167
    v_cvt_pk_bf16_f32 v160, v160, v161
    v_cvt_pk_bf16_f32 v161, v162, v163
    v_cvt_pk_bf16_f32 v162, v164, v165
    s_waitcnt lgkmcnt(12)
    v_mfma_f32_32x32x16_bf16 v[16:31], v[196:199], v[144:147], v[16:31]
    ds_read_b128 v[192:195], v224 offset:0
    v_cvt_pk_bf16_f32 v163, v166, v167
    v_fma_f32 v168, v168, s73, -v240
    v_fma_f32 v169, v169, s73, -v240
    v_fma_f32 v170, v170, s73, -v240
    v_fma_f32 v171, v171, s73, -v240
    s_waitcnt lgkmcnt(11)
    v_mfma_f32_32x32x16_bf16 v[32:47], v[200:203], v[144:147], v[32:47]
    ds_read_b128 v[196:199], v225 offset:0
    v_fma_f32 v172, v172, s73, -v240
    v_fma_f32 v173, v173, s73, -v240
    v_fma_f32 v174, v174, s73, -v240
    v_fma_f32 v175, v175, s73, -v240
    v_exp_f32 v168, v168
    s_waitcnt lgkmcnt(10)
    v_mfma_f32_32x32x16_bf16 v[48:63], v[204:207], v[144:147], v[48:63]
    ds_read_b128 v[200:203], v226 offset:0
    v_exp_f32 v169, v169
    v_exp_f32 v170, v170
    v_exp_f32 v171, v171
    v_exp_f32 v172, v172
    v_exp_f32 v173, v173
    s_waitcnt lgkmcnt(9)
    v_mfma_f32_32x32x16_bf16 v[0:15], v[208:211], v[152:155], v[0:15]
    ds_read_b128 v[204:207], v227 offset:0
    v_exp_f32 v174, v174
    v_exp_f32 v175, v175
    v_add_f32 v241, v241, v168
    v_add_f32 v242, v242, v169
    v_add_f32 v241, v241, v170
    s_waitcnt lgkmcnt(8)
    v_mfma_f32_32x32x16_bf16 v[16:31], v[212:215], v[152:155], v[16:31]
    ds_read_b128 v[208:211], v228 offset:0
    v_add_f32 v242, v242, v171
    v_add_f32 v241, v241, v172
    v_add_f32 v242, v242, v173
    v_add_f32 v241, v241, v174
    v_add_f32 v242, v242, v175
    s_waitcnt lgkmcnt(7)
    v_mfma_f32_32x32x16_bf16 v[32:47], v[216:219], v[152:155], v[32:47]
    ds_read_b128 v[212:215], v229 offset:0
    v_cvt_pk_bf16_f32 v168, v168, v169
    v_cvt_pk_bf16_f32 v169, v170, v171
    v_cvt_pk_bf16_f32 v170, v172, v173
    v_cvt_pk_bf16_f32 v171, v174, v175
    v_fma_f32 v176, v176, s73, -v240
    s_waitcnt lgkmcnt(6)
    v_mfma_f32_32x32x16_bf16 v[48:63], v[220:223], v[152:155], v[48:63]
    ds_read_b128 v[216:219], v230 offset:0
    s_cmp_lg_u32 s72, 0
    s_cbranch_scc1 L_rare2_3
L_back2_3:
    v_fma_f32 v177, v177, s73, -v240
    v_fma_f32 v178, v178, s73, -v240
    v_fma_f32 v179, v179, s73, -v240
    v_fma_f32 v180, v180, s73, -v240
    v_fma_f32 v181, v181, s73, -v240
    s_waitcnt lgkmcnt(6)
    v_mfma_f32_32x32x16_bf16 v[128:143], v[192:195], v[64:67], 0
    ds_read_b128 v[220:223], v231 offset:0
    v_fma_f32 v182, v182, s73, -v240
    v_fma_f32 v183, v183, s73, -v240
    v_exp_f32 v176, v176
    v_exp_f32 v177, v177
    v_exp_f32 v178, v178
    s_waitcnt lgkmcnt(6)
    v_mfma_f32_32x32x16_bf16 v[128:143], v[196:199], v[68:71], v[128:143]
    ds_read_b128 v[192:195], v224 offset:8192
    v_exp_f32 v179, v179
    v_exp_f32 v180, v180
    v_exp_f32 v181, v181
    v_exp_f32 v182, v182
    v_exp_f32 v183, v183
    s_waitcnt lgkmcnt(6)
    v_mfma_f32_32x32x16_bf16 v[128:143], v[200:203], v[72:75], v[128:143]
    ds_read_b128 v[196:199], v225 offset:8192
    v_add_f32 v241, v241, v176
    v_add_f32 v242, v242, v177
    v_add_f32 v241, v241, v178
    v_add_f32 v242, v242, v179
    v_add_f32 v241, v241, v180
    s_waitcnt lgkmcnt(6)
    v_mfma_f32_32x32x16_bf16 v[128:143], v[204:207], v[76:79], v[128:143]
    ds_read_b128 v[200:203], v226 offset:8192
    v_add_f32 v242, v242, v181
    v_add_f32 v241, v241, v182
    v_add_f32 v242, v242, v183
    v_cvt_pk_bf16_f32 v176, v176, v177
    v_cvt_pk_bf16_f32 v177, v178, v179
    s_waitcnt lgkmcnt(6)
    v_mfma_f32_32x32x16_bf16 v[128:143], v[208:211], v[80:83], v[128:143]
    ds_read_b128 v[204:207], v227 offset:8192
    v_cvt_pk_bf16_f32 v178, v180, v181
    v_cvt_pk_bf16_f32 v179, v182, v183
    v_fma_f32 v184, v184, s73, -v240
    v_fma_f32 v185, v185, s73, -v240
    v_fma_f32 v186, v186, s73, -v240
    s_waitcnt lgkmcnt(6)
    v_mfma_f32_32x32x16_bf16 v[128:143], v[212:215], v[84:87], v[128:143]
    ds_read_b128 v[208:211], v228 offset:8192
    v_fma_f32 v187, v187, s73, -v240
    v_fma_f32 v188, v188, s73, -v240
    v_fma_f32 v189, v189, s73, -v240
    v_fma_f32 v190, v190, s73, -v240
    v_fma_f32 v191, v191, s73, -v240
    s_waitcnt lgkmcnt(6)
    v_mfma_f32_32x32x16_bf16 v[128:143], v[216:219], v[88:91], v[128:143]
    ds_read_b128 v[212:215], v229 offset:8192
    v_exp_f32 v184, v184
    v_exp_f32 v185, v185
    v_exp_f32 v186, v186
    v_exp_f32 v187, v187
    v_exp_f32 v188, v188
    s_waitcnt lgkmcnt(6)
    v_mfma_f32_32x32x16_bf16 v[128:143], v[220:223], v[92:95], v[128:143]
    ds_read_b128 v[216:219], v230 offset:8192
    v_exp_f32 v189, v189
    v_exp_f32 v190, v190
    v_exp_f32 v191, v191
    v_add_f32 v241, v241, v184
    v_add_f32 v242, v242, v185
    s_waitcnt lgkmcnt(6)
    v_mfma_f32_32x32x16_bf16 v[144:159], v[192:195], v[64:67], 0
    ds_read_b128 v[220:223], v231 offset:8192
    v_add_f32 v241, v241, v186
    v_add_f32 v242, v242, v187
    v_add_f32 v241, v241, v188
    v_add_f32 v242, v242, v189
    v_add_f32 v241, v241, v190
    s_waitcnt lgkmcnt(6)
    v_mfma_f32_32x32x16_bf16 v[144:159], v[196:199], v[68:71], v[144:159]
    s_waitcnt vmcnt(8) lgkmcnt(0)
    s_barrier
    s_add_u32 m0, s67, 0
    s_add_u32 s71, s69, 131072
    buffer_load_dwordx4 v236, s[48:51], s71 offen sc1 nt lds
    s_add_u32 m0, s67, 8192
    s_add_u32 s71, s69, 139264
    buffer_load_dwordx4 v236, s[48:51], s71 offen sc1 nt lds
    s_add_u32 m0, s67, 98304
    s_add_u32 s71, s69, 98304
    buffer_load_dwordx4 v237, s[52:55], s71 offen sc1 nt lds
    s_add_u32 m0, s67, 106496
    s_add_u32 s71, s69, 106496
    buffer_load_dwordx4 v237, s[52:55], s71 offen sc1 nt lds
    ds_read_b64_tr_b16 v[192:193], v232 offset:49152
    ds_read_b64_tr_b16 v[194:195], v232 offset:51200
    v_add_f32 v242, v242, v191
    v_cvt_pk_bf16_f32 v184, v184, v185
    v_cvt_pk_bf16_f32 v185, v186, v187
    v_cvt_pk_bf16_f32 v186, v188, v189
    v_cvt_pk_bf16_f32 v187, v190, v191
    v_mfma_f32_32x32x16_bf16 v[144:159], v[200:203], v[72:75], v[144:159]
    ds_read_b64_tr_b16 v[196:197], v233 offset:49152
    ds_read_b64_tr_b16 v[198:199], v233 offset:51200
    v_mfma_f32_32x32x16_bf16 v[144:159], v[204:207], v[76:79], v[144:159]
    ds_read_b64_tr_b16 v[200:201], v234 offset:49152
    ds_read_b64_tr_b16 v[202:203], v234 offset:51200
    v_mfma_f32_32x32x16_bf16 v[144:159], v[208:211], v[80:83], v[144:159]
    ds_read_b64_tr_b16 v[204:205], v235 offset:49152
    ds_read_b64_tr_b16 v[206:207], v235 offset:51200
    v_mfma_f32_32x32x16_bf16 v[144:159], v[212:215], v[84:87], v[144:159]
    ds_read_b64_tr_b16 v[208:209], v232 offset:53248
    ds_read_b64_tr_b16 v[210:211], v232 offset:55296
    v_mfma_f32_32x32x16_bf16 v[144:159], v[216:219], v[88:91], v[144:159]
    ds_read_b64_tr_b16 v[212:213], v233 offset:53248
    ds_read_b64_tr_b16 v[214:215], v233 offset:55296
    v_mfma_f32_32x32x16_bf16 v[144:159], v[220:223], v[92:95], v[144:159]
    ds_read_b64_tr_b16 v[216:217], v234 offset:53248
    ds_read_b64_tr_b16 v[218:219], v234 offset:55296
    v_max3_f32 v244, v128, v129, v130
    v_max3_f32 v244, v244, v131, v132
    v_max3_f32 v244, v244, v133, v134
    v_max3_f32 v244, v244, v135, v136
    v_max3_f32 v244, v244, v137, v138
    s_waitcnt lgkmcnt(12)
    v_mfma_f32_32x32x16_bf16 v[0:15], v[192:195], v[160:163], v[0:15]
    ds_read_b64_tr_b16 v[220:221], v235 offset:53248
    ds_read_b64_tr_b16 v[222:223], v235 offset:55296
    v_max3_f32 v244, v244, v139, v140
    v_max3_f32 v244, v244, v141, v142
    v_max3_f32 v245, v144, v145, v146
    v_max3_f32 v245, v245, v147, v148
    v_max3_f32 v245, v245, v149, v150
    s_waitcnt lgkmcnt(12)
    v_mfma_f32_32x32x16_bf16 v[16:31], v[196:199], v[160:163], v[16:31]
    ds_read_b64_tr_b16 v[192:193], v232 offset:57344
    ds_read_b64_tr_b16 v[194:195], v232 offset:59392
    v_max3_f32 v245, v245, v151, v152
    v_max3_f32 v245, v245, v153, v154
    v_max3_f32 v245, v245, v155, v156
    v_max3_f32 v245, v245, v157, v158
    v_max3_f32 v238, v244, v143, v159
    s_waitcnt lgkmcnt(12)
    v_mfma_f32_32x32x16_bf16 v[32:47], v[200:203], v[160:163], v[32:47]
    ds_read_b64_tr_b16 v[196:197], v233 offset:57344
    ds_read_b64_tr_b16 v[198:199], v233 offset:59392
    v_max_f32 v238, v238, v245
    v_mov_b32 v239, v238
    s_nop 1
    v_permlane32_swap_b32 v238, v239
    v_max_f32 v238, v238, v239
    v_fma_f32 v239, v238, s73, -v240
    s_waitcnt lgkmcnt(12)
    v_mfma_f32_32x32x16_bf16 v[48:63], v[204:207], v[160:163], v[48:63]
    ds_read_b64_tr_b16 v[200:201], v234 offset:57344
    ds_read_b64_tr_b16 v[202:203], v234 offset:59392
    v_cmp_lt_f32 vcc, s74, v239
    s_cbranch_vccnz L_rare1_4
L_back1_4:
    v_fma_f32 v128, v128, s73, -v240
    v_fma_f32 v129, v129, s73, -v240
    s_waitcnt lgkmcnt(12)
    v_mfma_f32_32x32x16_bf16 v[0:15], v[208:211], v[168:171], v[0:15]
    ds_read_b64_tr_b16 v[204:205], v235 offset:57344
    ds_read_b64_tr_b16 v[206:207], v235 offset:59392
    v_fma_f32 v130, v130, s73, -v240
    v_fma_f32 v131, v131, s73, -v240
    v_fma_f32 v132, v132, s73, -v240
    v_fma_f32 v133, v133, s73, -v240
    v_fma_f32 v134, v134, s73, -v240
    s_waitcnt lgkmcnt(12)
    v_mfma_f32_32x32x16_bf16 v[16:31], v[212:215], v[168:171], v[16:31]
    ds_read_b64_tr_b16 v[208:209], v232 offset:61440
    ds_read_b64_tr_b16 v[210:211], v232 offset:63488
    v_fma_f32 v135, v135, s73, -v240
    v_exp_f32 v128, v128
    v_exp_f32 v129, v129
    v_exp_f32 v130, v130
    v_exp_f32 v131, v131
    s_waitcnt lgkmcnt(12)
    v_mfma_f32_32x32x16_bf16 v[32:47], v[216:219], v[168:171], v[32:47]
    ds_read_b64_tr_b16 v[212:213], v233 offset:61440
    ds_read_b64_tr_b16 v[214:215], v233 offset:63488
    v_exp_f32 v132, v132
    v_exp_f32 v133, v133
    v_exp_f32 v134, v134
    v_exp_f32 v135, v135
    v_add_f32 v241, v241, v128
    s_waitcnt lgkmcnt(12)
    v_mfma_f32_32x32x16_bf16 v[48:63], v[220:223], v[168:171], v[48:63]
    ds_read_b64_tr_b16 v[216:217], v234 offset:61440
    ds_read_b64_tr_b16 v[218:219], v234 offset:63488
    v_add_f32 v242, v242, v129
    v_add_f32 v241, v241, v130
    v_add_f32 v242, v242, v131
    v_add_f32 v241, v241, v132
    v_add_f32 v242, v242, v133
    s_waitcnt lgkmcnt(12)
    v_mfma_f32_32x32x16_bf16 v[0:15], v[192:195], v[176:179], v[0:15]
    ds_read_b64_tr_b16 v[220:221], v235 offset:61440
    ds_read_b64_tr_b16 v[222:223], v235 offset:63488
    v_add_f32 v241, v241, v134
    v_add_f32 v242, v242, v135
    v_cvt_pk_bf16_f32 v128, v128, v129
    v_cvt_pk_bf16_f32 v129, v130, v131
    v_cvt_pk_bf16_f32 v130, v132, v133
    s_waitcnt lgkmcnt(12)
    v_mfma_f32_32x32x16_bf16 v[16:31], v[196:199], v[176:179], v[16:31]
    ds_read_b128 v[192:195], v224 offset:16384
    v_cvt_pk_bf16_f32 v131, v134, v135
    v_fma_f32 v136, v136, s73, -v240
    v_fma_f32 v137, v137, s73, -v240
    v_fma_f32 v138, v138, s73, -v240
    v_fma_f32 v139, v139, s73, -v240
    s_waitcnt lgkmcnt(11)
    v_mfma_f32_32x32x16_bf16 v[32:47], v[200:203], v[176:179], v[32:47]
    ds_read_b128 v[196:199], v225 offset:16384
    v_fma_f32 v140, v140, s73, -v240
    v_fma_f32 v141, v141, s73, -v240
    v_fma_f32 v142, v142, s73, -v240
    v_fma_f32 v143, v143, s73, -v240
    v_exp_f32 v136, v136
    s_waitcnt lgkmcnt(10)
    v_mfma_f32_32x32x16_bf16 v[48:63], v[204:207], v[176:179], v[48:63]
    ds_read_b128 v[200:203], v226 offset:16384
    v_exp_f32 v137, v137
    v_exp_f32 v138, v138
    v_exp_f32 v139, v139
    v_exp_f32 v140, v140
    v_exp_f32 v141, v141
    s_waitcnt lgkmcnt(9)
    v_mfma_f32_32x32x16_bf16 v[0:15], v[208:211], v[184:187], v[0:15]
    ds_read_b128 v[204:207], v227 offset:16384
    v_exp_f32 v142, v142
    v_exp_f32 v143, v143
    v_add_f32 v241, v241, v136
    v_add_f32 v242, v242, v137
    v_add_f32 v241, v241, v138
    s_waitcnt lgkmcnt(8)
    v_mfma_f32_32x32x16_bf16 v[16:31], v[212:215], v[184:187], v[16:31]
    ds_read_b128 v[208:211], v228 offset:16384
    v_add_f32 v242, v242, v139
    v_add_f32 v241, v241, v140
    v_add_f32 v242, v242, v141
    v_add_f32 v241, v241, v142
    v_add_f32 v242, v242, v143
    s_waitcnt lgkmcnt(7)
    v_mfma_f32_32x32x16_bf16 v[32:47], v[216:219], v[184:187], v[32:47]
    ds_read_b128 v[212:215], v229 offset:16384
    v_cvt_pk_bf16_f32 v136, v136, v137
    v_cvt_pk_bf16_f32 v137, v138, v139
    v_cvt_pk_bf16_f32 v138, v140, v141
    v_cvt_pk_bf16_f32 v139, v142, v143
    v_fma_f32 v144, v144, s73, -v240
    s_waitcnt lgkmcnt(6)
    v_mfma_f32_32x32x16_bf16 v[48:63], v[220:223], v[184:187], v[48:63]
    ds_read_b128 v[216:219], v230 offset:16384
    s_cmp_lg_u32 s72, 0
    s_cbranch_scc1 L_rare2_4
L_back2_4:
    v_fma_f32 v145, v145, s73, -v240
    v_fma_f32 v146, v146, s73, -v240
    v_fma_f32 v147, v147, s73, -v240
    v_fma_f32 v148, v148, s73, -v240
    v_fma_f32 v149, v149, s73, -v240
    s_waitcnt lgkmcnt(6)
    v_mfma_f32_32x32x16_bf16 v[160:175], v[192:195], v[64:67], 0
    ds_read_b128 v[220:223], v231 offset:16384
    v_fma_f32 v150, v150, s73, -v240
    v_fma_f32 v151, v151, s73, -v240
    v_exp_f32 v144, v144
    v_exp_f32 v145, v145
    v_exp_f32 v146, v146
    s_waitcnt lgkmcnt(6)
    v_mfma_f32_32x32x16_bf16 v[160:175], v[196:199], v[68:71], v[160:175]
    ds_read_b128 v[192:195], v224 offset:24576
    v_exp_f32 v147, v147
    v_exp_f32 v148, v148
    v_exp_f32 v149, v149
    v_exp_f32 v150, v150
    v_exp_f32 v151, v151
    s_waitcnt lgkmcnt(6)
    v_mfma_f32_32x32x16_bf16 v[160:175], v[200:203], v[72:75], v[160:175]
    ds_read_b128 v[196:199], v225 offset:24576
    v_add_f32 v241, v241, v144
    v_add_f32 v242, v242, v145
    v_add_f32 v241, v241, v146
    v_add_f32 v242, v242, v147
    v_add_f32 v241, v241, v148
    s_waitcnt lgkmcnt(6)
    v_mfma_f32_32x32x16_bf16 v[160:175], v[204:207], v[76:79], v[160:175]
    ds_read_b128 v[200:203], v226 offset:24576
    v_add_f32 v242, v242, v149
    v_add_f32 v241, v241, v150
    v_add_f32 v242, v242, v151
    v_cvt_pk_bf16_f32 v144, v144, v145
    v_cvt_pk_bf16_f32 v145, v146, v147
    s_waitcnt lgkmcnt(6)
    v_mfma_f32_32x32x16_bf16 v[160:175], v[208:211], v[80:83], v[160:175]
    ds_read_b128 v[204:207], v227 offset:24576
    v_cvt_pk_bf16_f32 v146, v148, v149
    v_cvt_pk_bf16_f32 v147, v150, v151
    v_fma_f32 v152, v152, s73, -v240
    v_fma_f32 v153, v153, s73, -v240
    v_fma_f32 v154, v154, s73, -v240
    s_waitcnt lgkmcnt(6)
    v_mfma_f32_32x32x16_bf16 v[160:175], v[212:215], v[84:87], v[160:175]
    ds_read_b128 v[208:211], v228 offset:24576
    v_fma_f32 v155, v155, s73, -v240
    v_fma_f32 v156, v156, s73, -v240
    v_fma_f32 v157, v157, s73, -v240
    v_fma_f32 v158, v158, s73, -v240
    v_fma_f32 v159, v159, s73, -v240
    s_waitcnt lgkmcnt(6)
    v_mfma_f32_32x32x16_bf16 v[160:175], v[216:219], v[88:91], v[160:175]
    ds_read_b128 v[212:215], v229 offset:24576
    v_exp_f32 v152, v152
    v_exp_f32 v153, v153
    v_exp_f32 v154, v154
    v_exp_f32 v155, v155
    v_exp_f32 v156, v156
    s_waitcnt lgkmcnt(6)
    v_mfma_f32_32x32x16_bf16 v[160:175], v[220:223], v[92:95], v[160:175]
    ds_read_b128 v[216:219], v230 offset:24576
    v_exp_f32 v157, v157
    v_exp_f32 v158, v158
    v_exp_f32 v159, v159
    v_add_f32 v241, v241, v152
    v_add_f32 v242, v242, v153
    s_waitcnt lgkmcnt(6)
    v_mfma_f32_32x32x16_bf16 v[176:191], v[192:195], v[64:67], 0
    ds_read_b128 v[220:223], v231 offset:24576
    v_add_f32 v241, v241, v154
    v_add_f32 v242, v242, v155
    v_add_f32 v241, v241, v156
    v_add_f32 v242, v242, v157
    v_add_f32 v241, v241, v158
    s_waitcnt lgkmcnt(6)
    v_mfma_f32_32x32x16_bf16 v[176:191], v[196:199], v[68:71], v[176:191]
    s_waitcnt vmcnt(8) lgkmcnt(0)
    s_barrier
    s_add_u32 m0, s67, 16384
    s_add_u32 s71, s69, 147456
    buffer_load_dwordx4 v236, s[48:51], s71 offen sc1 nt lds
    s_add_u32 m0, s67, 24576
    s_add_u32 s71, s69, 155648
    buffer_load_dwordx4 v236, s[48:51], s71 offen sc1 nt lds
    s_add_u32 m0, s67, 114688
    s_add_u32 s71, s69, 114688
    buffer_load_dwordx4 v237, s[52:55], s71 offen sc1 nt lds
    s_add_u32 m0, s67, 122880
    s_add_u32 s71, s69, 122880
    buffer_load_dwordx4 v237, s[52:55], s71 offen sc1 nt lds
    ds_read_b64_tr_b16 v[192:193], v232 offset:0
    ds_read_b64_tr_b16 v[194:195], v232 offset:2048
    v_add_f32 v242, v242, v159
    v_cvt_pk_bf16_f32 v152, v152, v153
    v_cvt_pk_bf16_f32 v153, v154, v155
    v_cvt_pk_bf16_f32 v154, v156, v157
    v_cvt_pk_bf16_f32 v155, v158, v159
    v_mfma_f32_32x32x16_bf16 v[176:191], v[200:203], v[72:75], v[176:191]
    ds_read_b64_tr_b16 v[196:197], v233 offset:0
    ds_read_b64_tr_b16 v[198:199], v233 offset:2048
    v_mfma_f32_32x32x16_bf16 v[176:191], v[204:207], v[76:79], v[176:191]
    ds_read_b64_tr_b16 v[200:201], v234 offset:0
    ds_read_b64_tr_b16 v[202:203], v234 offset:2048
    v_mfma_f32_32x32x16_bf16 v[176:191], v[208:211], v[80:83], v[176:191]
    ds_read_b64_tr_b16 v[204:205], v235 offset:0
    ds_read_b64_tr_b16 v[206:207], v235 offset:2048
    v_mfma_f32_32x32x16_bf16 v[176:191], v[212:215], v[84:87], v[176:191]
    ds_read_b64_tr_b16 v[208:209], v232 offset:4096
    ds_read_b64_tr_b16 v[210:211], v232 offset:6144
    v_mfma_f32_32x32x16_bf16 v[176:191], v[216:219], v[88:91], v[176:191]
    ds_read_b64_tr_b16 v[212:213], v233 offset:4096
    ds_read_b64_tr_b16 v[214:215], v233 offset:6144
    v_mfma_f32_32x32x16_bf16 v[176:191], v[220:223], v[92:95], v[176:191]
    ds_read_b64_tr_b16 v[216:217], v234 offset:4096
    ds_read_b64_tr_b16 v[218:219], v234 offset:6144
    v_max3_f32 v244, v160, v161, v162
    v_max3_f32 v244, v244, v163, v164
    v_max3_f32 v244, v244, v165, v166
    v_max3_f32 v244, v244, v167, v168
    v_max3_f32 v244, v244, v169, v170
    s_waitcnt lgkmcnt(12)
    v_mfma_f32_32x32x16_bf16 v[0:15], v[192:195], v[128:131], v[0:15]
    ds_read_b64_tr_b16 v[220:221], v235 offset:4096
    ds_read_b64_tr_b16 v[222:223], v235 offset:6144
    v_max3_f32 v244, v244, v171, v172
    v_max3_f32 v244, v244, v173, v174
    v_max3_f32 v245, v176, v177, v178
    v_max3_f32 v245, v245, v179, v180
    v_max3_f32 v245, v245, v181, v182
    s_waitcnt lgkmcnt(12)
    v_mfma_f32_32x32x16_bf16 v[16:31], v[196:199], v[128:131], v[16:31]
    ds_read_b64_tr_b16 v[192:193], v232 offset:8192
    ds_read_b64_tr_b16 v[194:195], v232 offset:10240
    v_max3_f32 v245, v245, v183, v184
    v_max3_f32 v245, v245, v185, v186
    v_max3_f32 v245, v245, v187, v188
    v_max3_f32 v245, v245, v189, v190
    v_max3_f32 v238, v244, v175, v191
    s_waitcnt lgkmcnt(12)
    v_mfma_f32_32x32x16_bf16 v[32:47], v[200:203], v[128:131], v[32:47]
    ds_read_b64_tr_b16 v[196:197], v233 offset:8192
    ds_read_b64_tr_b16 v[198:199], v233 offset:10240
    v_max_f32 v238, v238, v245
    v_mov_b32 v239, v238
    s_nop 1
    v_permlane32_swap_b32 v238, v239
    v_max_f32 v238, v238, v239
    v_fma_f32 v239, v238, s73, -v240
    s_waitcnt lgkmcnt(12)
    v_mfma_f32_32x32x16_bf16 v[48:63], v[204:207], v[128:131], v[48:63]
    ds_read_b64_tr_b16 v[200:201], v234 offset:8192
    ds_read_b64_tr_b16 v[202:203], v234 offset:10240
    v_cmp_lt_f32 vcc, s74, v239
    s_cbranch_vccnz L_rare1_5
L_back1_5:
    v_fma_f32 v160, v160, s73, -v240
    v_fma_f32 v161, v161, s73, -v240
    s_waitcnt lgkmcnt(12)
    v_mfma_f32_32x32x16_bf16 v[0:15], v[208:211], v[136:139], v[0:15]
    ds_read_b64_tr_b16 v[204:205], v235 offset:8192
    ds_read_b64_tr_b16 v[206:207], v235 offset:10240
    v_fma_f32 v162, v162, s73, -v240
    v_fma_f32 v163, v163, s73, -v240
    v_fma_f32 v164, v164, s73, -v240
    v_fma_f32 v165, v165, s73, -v240
    v_fma_f32 v166, v166, s73, -v240
    s_waitcnt lgkmcnt(12)
    v_mfma_f32_32x32x16_bf16 v[16:31], v[212:215], v[136:139], v[16:31]
    ds_read_b64_tr_b16 v[208:209], v232 offset:12288
    ds_read_b64_tr_b16 v[210:211], v232 offset:14336
    v_fma_f32 v167, v167, s73, -v240
    v_exp_f32 v160, v160
    v_exp_f32 v161, v161
    v_exp_f32 v162, v162
    v_exp_f32 v163, v163
    s_waitcnt lgkmcnt(12)
    v_mfma_f32_32x32x16_bf16 v[32:47], v[216:219], v[136:139], v[32:47]
    ds_read_b64_tr_b16 v[212:213], v233 offset:12288
    ds_read_b64_tr_b16 v[214:215], v233 offset:14336
    v_exp_f32 v164, v164
    v_exp_f32 v165, v165
    v_exp_f32 v166, v166
    v_exp_f32 v167, v167
    v_add_f32 v241, v241, v160
    s_waitcnt lgkmcnt(12)
    v_mfma_f32_32x32x16_bf16 v[48:63], v[220:223], v[136:139], v[48:63]
    ds_read_b64_tr_b16 v[216:217], v234 offset:12288
    ds_read_b64_tr_b16 v[218:219], v234 offset:14336
    v_add_f32 v242, v242, v161
    v_add_f32 v241, v241, v162
    v_add_f32 v242, v242, v163
    v_add_f32 v241, v241, v164
    v_add_f32 v242, v242, v165
    s_waitcnt lgkmcnt(12)
    v_mfma_f32_32x32x16_bf16 v[0:15], v[192:195], v[144:147], v[0:15]
    ds_read_b64_tr_b16 v[220:221], v235 offset:12288
    ds_read_b64_tr_b16 v[222:223], v235 offset:14336
    v_add_f32 v241, v241, v166
    v_add_f32 v242, v242, v167
    v_cvt_pk_bf16_f32 v160, v160, v161
    v_cvt_pk_bf16_f32 v161, v162, v163
    v_cvt_pk_bf16_f32 v162, v164, v165
    s_waitcnt lgkmcnt(12)
    v_mfma_f32_32x32x16_bf16 v[16:31], v[196:199], v[144:147], v[16:31]
    ds_read_b128 v[192:195], v224 offset:32768
    v_cvt_pk_bf16_f32 v163, v166, v167
    v_fma_f32 v168, v168, s73, -v240
    v_fma_f32 v169, v169, s73, -v240
    v_fma_f32 v170, v170, s73, -v240
    v_fma_f32 v171, v171, s73, -v240
    s_waitcnt lgkmcnt(11)
    v_mfma_f32_32x32x16_bf16 v[32:47], v[200:203], v[144:147], v[32:47]
    ds_read_b128 v[196:199], v225 offset:32768
    v_fma_f32 v172, v172, s73, -v240
    v_fma_f32 v173, v173, s73, -v240
    v_fma_f32 v174, v174, s73, -v240
    v_fma_f32 v175, v175, s73, -v240
    v_exp_f32 v168, v168
    s_waitcnt lgkmcnt(10)
    v_mfma_f32_32x32x16_bf16 v[48:63], v[204:207], v[144:147], v[48:63]
    ds_read_b128 v[200:203], v226 offset:32768
    v_exp_f32 v169, v169
    v_exp_f32 v170, v170
    v_exp_f32 v171, v171
    v_exp_f32 v172, v172
    v_exp_f32 v173, v173
    s_waitcnt lgkmcnt(9)
    v_mfma_f32_32x32x16_bf16 v[0:15], v[208:211], v[152:155], v[0:15]
    ds_read_b128 v[204:207], v227 offset:32768
    v_exp_f32 v174, v174
    v_exp_f32 v175, v175
    v_add_f32 v241, v241, v168
    v_add_f32 v242, v242, v169
    v_add_f32 v241, v241, v170
    s_waitcnt lgkmcnt(8)
    v_mfma_f32_32x32x16_bf16 v[16:31], v[212:215], v[152:155], v[16:31]
    ds_read_b128 v[208:211], v228 offset:32768
    v_add_f32 v242, v242, v171
    v_add_f32 v241, v241, v172
    v_add_f32 v242, v242, v173
    v_add_f32 v241, v241, v174
    v_add_f32 v242, v242, v175
    s_waitcnt lgkmcnt(7)
    v_mfma_f32_32x32x16_bf16 v[32:47], v[216:219], v[152:155], v[32:47]
    ds_read_b128 v[212:215], v229 offset:32768
    v_cvt_pk_bf16_f32 v168, v168, v169
    v_cvt_pk_bf16_f32 v169, v170, v171
    v_cvt_pk_bf16_f32 v170, v172, v173
    v_cvt_pk_bf16_f32 v171, v174, v175
    v_fma_f32 v176, v176, s73, -v240
    s_waitcnt lgkmcnt(6)
    v_mfma_f32_32x32x16_bf16 v[48:63], v[220:223], v[152:155], v[48:63]
    ds_read_b128 v[216:219], v230 offset:32768
    s_cmp_lg_u32 s72, 0
    s_cbranch_scc1 L_rare2_5
L_back2_5:
    v_fma_f32 v177, v177, s73, -v240
    v_fma_f32 v178, v178, s73, -v240
    v_fma_f32 v179, v179, s73, -v240
    v_fma_f32 v180, v180, s73, -v240
    v_fma_f32 v181, v181, s73, -v240
    s_waitcnt lgkmcnt(6)
    v_mfma_f32_32x32x16_bf16 v[128:143], v[192:195], v[64:67], 0
    ds_read_b128 v[220:223], v231 offset:32768
    v_fma_f32 v182, v182, s73, -v240
    v_fma_f32 v183, v183, s73, -v240
    v_exp_f32 v176, v176
    v_exp_f32 v177, v177
    v_exp_f32 v178, v178
    s_waitcnt lgkmcnt(6)
    v_mfma_f32_32x32x16_bf16 v[128:143], v[196:199], v[68:71], v[128:143]
    ds_read_b128 v[192:195], v224 offset:40960
    v_exp_f32 v179, v179
    v_exp_f32 v180, v180
    v_exp_f32 v181, v181
    v_exp_f32 v182, v182
    v_exp_f32 v183, v183
    s_waitcnt lgkmcnt(6)
    v_mfma_f32_32x32x16_bf16 v[128:143], v[200:203], v[72:75], v[128:143]
    ds_read_b128 v[196:199], v225 offset:40960
    v_add_f32 v241, v241, v176
    v_add_f32 v242, v242, v177
    v_add_f32 v241, v241, v178
    v_add_f32 v242, v242, v179
    v_add_f32 v241, v241, v180
    s_waitcnt lgkmcnt(6)
    v_mfma_f32_32x32x16_bf16 v[128:143], v[204:207], v[76:79], v[128:143]
    ds_read_b128 v[200:203], v226 offset:40960
    v_add_f32 v242, v242, v181
    v_add_f32 v241, v241, v182
    v_add_f32 v242, v242, v183
    v_cvt_pk_bf16_f32 v176, v176, v177
    v_cvt_pk_bf16_f32 v177, v178, v179
    s_waitcnt lgkmcnt(6)
    v_mfma_f32_32x32x16_bf16 v[128:143], v[208:211], v[80:83], v[128:143]
    ds_read_b128 v[204:207], v227 offset:40960
    v_cvt_pk_bf16_f32 v178, v180, v181
    v_cvt_pk_bf16_f32 v179, v182, v183
    v_fma_f32 v184, v184, s73, -v240
    v_fma_f32 v185, v185, s73, -v240
    v_fma_f32 v186, v186, s73, -v240
    s_waitcnt lgkmcnt(6)
    v_mfma_f32_32x32x16_bf16 v[128:143], v[212:215], v[84:87], v[128:143]
    ds_read_b128 v[208:211], v228 offset:40960
    v_fma_f32 v187, v187, s73, -v240
    v_fma_f32 v188, v188, s73, -v240
    v_fma_f32 v189, v189, s73, -v240
    v_fma_f32 v190, v190, s73, -v240
    v_fma_f32 v191, v191, s73, -v240
    s_waitcnt lgkmcnt(6)
    v_mfma_f32_32x32x16_bf16 v[128:143], v[216:219], v[88:91], v[128:143]
    ds_read_b128 v[212:215], v229 offset:40960
    v_exp_f32 v184, v184
    v_exp_f32 v185, v185
    v_exp_f32 v186, v186
    v_exp_f32 v187, v187
    v_exp_f32 v188, v188
    s_waitcnt lgkmcnt(6)
    v_mfma_f32_32x32x16_bf16 v[128:143], v[220:223], v[92:95], v[128:143]
    ds_read_b128 v[216:219], v230 offset:40960
    v_exp_f32 v189, v189
    v_exp_f32 v190, v190
    v_exp_f32 v191, v191
    v_add_f32 v241, v241, v184
    v_add_f32 v242, v242, v185
    s_waitcnt lgkmcnt(6)
    v_mfma_f32_32x32x16_bf16 v[144:159], v[192:195], v[64:67], 0
    ds_read_b128 v[220:223], v231 offset:40960
    v_add_f32 v241, v241, v186
    v_add_f32 v242, v242, v187
    v_add_f32 v241, v241, v188
    v_add_f32 v242, v242, v189
    v_add_f32 v241, v241, v190
    s_waitcnt lgkmcnt(6)
    v_mfma_f32_32x32x16_bf16 v[144:159], v[196:199], v[68:71], v[144:159]
    s_waitcnt vmcnt(8) lgkmcnt(0)
    s_barrier
    s_add_u32 m0, s67, 32768
    s_add_u32 s71, s69, 163840
    buffer_load_dwordx4 v236, s[48:51], s71 offen sc1 nt lds
    s_add_u32 m0, s67, 40960
    s_add_u32 s71, s69, 172032
    buffer_load_dwordx4 v236, s[48:51], s71 offen sc1 nt lds
    s_add_u32 m0, s67, 65536
    s_add_u32 s71, s69, 131072
    buffer_load_dwordx4 v237, s[52:55], s71 offen sc1 nt lds
    s_add_u32 m0, s67, 73728
    s_add_u32 s71, s69, 139264
    buffer_load_dwordx4 v237, s[52:55], s71 offen sc1 nt lds
    ds_read_b64_tr_b16 v[192:193], v232 offset:16384
    ds_read_b64_tr_b16 v[194:195], v232 offset:18432
    v_add_f32 v242, v242, v191
    v_cvt_pk_bf16_f32 v184, v184, v185
    v_cvt_pk_bf16_f32 v185, v186, v187
    v_cvt_pk_bf16_f32 v186, v188, v189
    v_cvt_pk_bf16_f32 v187, v190, v191
    v_mfma_f32_32x32x16_bf16 v[144:159], v[200:203], v[72:75], v[144:159]
    ds_read_b64_tr_b16 v[196:197], v233 offset:16384
    ds_read_b64_tr_b16 v[198:199], v233 offset:18432
    v_mfma_f32_32x32x16_bf16 v[144:159], v[204:207], v[76:79], v[144:159]
    ds_read_b64_tr_b16 v[200:201], v234 offset:16384
    ds_read_b64_tr_b16 v[202:203], v234 offset:18432
    v_mfma_f32_32x32x16_bf16 v[144:159], v[208:211], v[80:83], v[144:159]
    ds_read_b64_tr_b16 v[204:205], v235 offset:16384
    ds_read_b64_tr_b16 v[206:207], v235 offset:18432
    v_mfma_f32_32x32x16_bf16 v[144:159], v[212:215], v[84:87], v[144:159]
    ds_read_b64_tr_b16 v[208:209], v232 offset:20480
    ds_read_b64_tr_b16 v[210:211], v232 offset:22528
    v_mfma_f32_32x32x16_bf16 v[144:159], v[216:219], v[88:91], v[144:159]
    ds_read_b64_tr_b16 v[212:213], v233 offset:20480
    ds_read_b64_tr_b16 v[214:215], v233 offset:22528
    v_mfma_f32_32x32x16_bf16 v[144:159], v[220:223], v[92:95], v[144:159]
    ds_read_b64_tr_b16 v[216:217], v234 offset:20480
    ds_read_b64_tr_b16 v[218:219], v234 offset:22528
    v_max3_f32 v244, v128, v129, v130
    v_max3_f32 v244, v244, v131, v132
    v_max3_f32 v244, v244, v133, v134
    v_max3_f32 v244, v244, v135, v136
    v_max3_f32 v244, v244, v137, v138
    s_waitcnt lgkmcnt(12)
    v_mfma_f32_32x32x16_bf16 v[0:15], v[192:195], v[160:163], v[0:15]
    ds_read_b64_tr_b16 v[220:221], v235 offset:20480
    ds_read_b64_tr_b16 v[222:223], v235 offset:22528
    v_max3_f32 v244, v244, v139, v140
    v_max3_f32 v244, v244, v141, v142
    v_max3_f32 v245, v144, v145, v146
    v_max3_f32 v245, v245, v147, v148
    v_max3_f32 v245, v245, v149, v150
    s_waitcnt lgkmcnt(12)
    v_mfma_f32_32x32x16_bf16 v[16:31], v[196:199], v[160:163], v[16:31]
    ds_read_b64_tr_b16 v[192:193], v232 offset:24576
    ds_read_b64_tr_b16 v[194:195], v232 offset:26624
    v_max3_f32 v245, v245, v151, v152
    v_max3_f32 v245, v245, v153, v154
    v_max3_f32 v245, v245, v155, v156
    v_max3_f32 v245, v245, v157, v158
    v_max3_f32 v238, v244, v143, v159
    s_waitcnt lgkmcnt(12)
    v_mfma_f32_32x32x16_bf16 v[32:47], v[200:203], v[160:163], v[32:47]
    ds_read_b64_tr_b16 v[196:197], v233 offset:24576
    ds_read_b64_tr_b16 v[198:199], v233 offset:26624
    v_max_f32 v238, v238, v245
    v_mov_b32 v239, v238
    s_nop 1
    v_permlane32_swap_b32 v238, v239
    v_max_f32 v238, v238, v239
    v_fma_f32 v239, v238, s73, -v240
    s_waitcnt lgkmcnt(12)
    v_mfma_f32_32x32x16_bf16 v[48:63], v[204:207], v[160:163], v[48:63]
    ds_read_b64_tr_b16 v[200:201], v234 offset:24576
    ds_read_b64_tr_b16 v[202:203], v234 offset:26624
    v_cmp_lt_f32 vcc, s74, v239
    s_cbranch_vccnz L_rare1_6
L_back1_6:
    v_fma_f32 v128, v128, s73, -v240
    v_fma_f32 v129, v129, s73, -v240
    s_waitcnt lgkmcnt(12)
    v_mfma_f32_32x32x16_bf16 v[0:15], v[208:211], v[168:171], v[0:15]
    ds_read_b64_tr_b16 v[204:205], v235 offset:24576
    ds_read_b64_tr_b16 v[206:207], v235 offset:26624
    v_fma_f32 v130, v130, s73, -v240
    v_fma_f32 v131, v131, s73, -v240
    v_fma_f32 v132, v132, s73, -v240
    v_fma_f32 v133, v133, s73, -v240
    v_fma_f32 v134, v134, s73, -v240
    s_waitcnt lgkmcnt(12)
    v_mfma_f32_32x32x16_bf16 v[16:31], v[212:215], v[168:171], v[16:31]
    ds_read_b64_tr_b16 v[208:209], v232 offset:28672
    ds_read_b64_tr_b16 v[210:211], v232 offset:30720
    v_fma_f32 v135, v135, s73, -v240
    v_exp_f32 v128, v128
    v_exp_f32 v129, v129
    v_exp_f32 v130, v130
    v_exp_f32 v131, v131
    s_waitcnt lgkmcnt(12)
    v_mfma_f32_32x32x16_bf16 v[32:47], v[216:219], v[168:171], v[32:47]
    ds_read_b64_tr_b16 v[212:213], v233 offset:28672
    ds_read_b64_tr_b16 v[214:215], v233 offset:30720
    v_exp_f32 v132, v132
    v_exp_f32 v133, v133
    v_exp_f32 v134, v134
    v_exp_f32 v135, v135
    v_add_f32 v241, v241, v128
    s_waitcnt lgkmcnt(12)
    v_mfma_f32_32x32x16_bf16 v[48:63], v[220:223], v[168:171], v[48:63]
    ds_read_b64_tr_b16 v[216:217], v234 offset:28672
    ds_read_b64_tr_b16 v[218:219], v234 offset:30720
    v_add_f32 v242, v242, v129
    v_add_f32 v241, v241, v130
    v_add_f32 v242, v242, v131
    v_add_f32 v241, v241, v132
    v_add_f32 v242, v242, v133
    s_waitcnt lgkmcnt(12)
    v_mfma_f32_32x32x16_bf16 v[0:15], v[192:195], v[176:179], v[0:15]
    ds_read_b64_tr_b16 v[220:221], v235 offset:28672
    ds_read_b64_tr_b16 v[222:223], v235 offset:30720
    v_add_f32 v241, v241, v134
    v_add_f32 v242, v242, v135
    v_cvt_pk_bf16_f32 v128, v128, v129
    v_cvt_pk_bf16_f32 v129, v130, v131
    v_cvt_pk_bf16_f32 v130, v132, v133
    s_waitcnt lgkmcnt(12)
    v_mfma_f32_32x32x16_bf16 v[16:31], v[196:199], v[176:179], v[16:31]
    ds_read_b128 v[192:195], v224 offset:49152
    v_cvt_pk_bf16_f32 v131, v134, v135
    v_fma_f32 v136, v136, s73, -v240
    v_fma_f32 v137, v137, s73, -v240
    v_fma_f32 v138, v138, s73, -v240
    v_fma_f32 v139, v139, s73, -v240
    s_waitcnt lgkmcnt(11)
    v_mfma_f32_32x32x16_bf16 v[32:47], v[200:203], v[176:179], v[32:47]
    ds_read_b128 v[196:199], v225 offset:49152
    v_fma_f32 v140, v140, s73, -v240
    v_fma_f32 v141, v141, s73, -v240
    v_fma_f32 v142, v142, s73, -v240
    v_fma_f32 v143, v143, s73, -v240
    v_exp_f32 v136, v136
    s_waitcnt lgkmcnt(10)
    v_mfma_f32_32x32x16_bf16 v[48:63], v[204:207], v[176:179], v[48:63]
    ds_read_b128 v[200:203], v226 offset:49152
    v_exp_f32 v137, v137
    v_exp_f32 v138, v138
    v_exp_f32 v139, v139
    v_exp_f32 v140, v140
    v_exp_f32 v141, v141
    s_waitcnt lgkmcnt(9)
    v_mfma_f32_32x32x16_bf16 v[0:15], v[208:211], v[184:187], v[0:15]
    ds_read_b128 v[204:207], v227 offset:49152
    v_exp_f32 v142, v142
    v_exp_f32 v143, v143
    v_add_f32 v241, v241, v136
    v_add_f32 v242, v242, v137
    v_add_f32 v241, v241, v138
    s_waitcnt lgkmcnt(8)
    v_mfma_f32_32x32x16_bf16 v[16:31], v[212:215], v[184:187], v[16:31]
    ds_read_b128 v[208:211], v228 offset:49152
    v_add_f32 v242, v242, v139
    v_add_f32 v241, v241, v140
    v_add_f32 v242, v242, v141
    v_add_f32 v241, v241, v142
    v_add_f32 v242, v242, v143
    s_waitcnt lgkmcnt(7)
    v_mfma_f32_32x32x16_bf16 v[32:47], v[216:219], v[184:187], v[32:47]
    ds_read_b128 v[212:215], v229 offset:49152
    v_cvt_pk_bf16_f32 v136, v136, v137
    v_cvt_pk_bf16_f32 v137, v138, v139
    v_cvt_pk_bf16_f32 v138, v140, v141
    v_cvt_pk_bf16_f32 v139, v142, v143
    v_fma_f32 v144, v144, s73, -v240
    s_waitcnt lgkmcnt(6)
    v_mfma_f32_32x32x16_bf16 v[48:63], v[220:223], v[184:187], v[48:63]
    ds_read_b128 v[216:219], v230 offset:49152
    s_cmp_lg_u32 s72, 0
    s_cbranch_scc1 L_rare2_6
L_back2_6:
    v_fma_f32 v145, v145, s73, -v240
    v_fma_f32 v146, v146, s73, -v240
    v_fma_f32 v147, v147, s73, -v240
    v_fma_f32 v148, v148, s73, -v240
    v_fma_f32 v149, v149, s73, -v240
    s_waitcnt lgkmcnt(6)
    v_mfma_f32_32x32x16_bf16 v[160:175], v[192:195], v[64:67], 0
    ds_read_b128 v[220:223], v231 offset:49152
    v_fma_f32 v150, v150, s73, -v240
    v_fma_f32 v151, v151, s73, -v240
    v_exp_f32 v144, v144
    v_exp_f32 v145, v145
    v_exp_f32 v146, v146
    s_waitcnt lgkmcnt(6)
    v_mfma_f32_32x32x16_bf16 v[160:175], v[196:199], v[68:71], v[160:175]
    ds_read_b128 v[192:195], v224 offset:57344
    v_exp_f32 v147, v147
    v_exp_f32 v148, v148
    v_exp_f32 v149, v149
    v_exp_f32 v150, v150
    v_exp_f32 v151, v151
    s_waitcnt lgkmcnt(6)
    v_mfma_f32_32x32x16_bf16 v[160:175], v[200:203], v[72:75], v[160:175]
    ds_read_b128 v[196:199], v225 offset:57344
    v_add_f32 v241, v241, v144
    v_add_f32 v242, v242, v145
    v_add_f32 v241, v241, v146
    v_add_f32 v242, v242, v147
    v_add_f32 v241, v241, v148
    s_waitcnt lgkmcnt(6)
    v_mfma_f32_32x32x16_bf16 v[160:175], v[204:207], v[76:79], v[160:175]
    ds_read_b128 v[200:203], v226 offset:57344
    v_add_f32 v242, v242, v149
    v_add_f32 v241, v241, v150
    v_add_f32 v242, v242, v151
    v_cvt_pk_bf16_f32 v144, v144, v145
    v_cvt_pk_bf16_f32 v145, v146, v147
    s_waitcnt lgkmcnt(6)
    v_mfma_f32_32x32x16_bf16 v[160:175], v[208:211], v[80:83], v[160:175]
    ds_read_b128 v[204:207], v227 offset:57344
    v_cvt_pk_bf16_f32 v146, v148, v149
    v_cvt_pk_bf16_f32 v147, v150, v151
    v_fma_f32 v152, v152, s73, -v240
    v_fma_f32 v153, v153, s73, -v240
    v_fma_f32 v154, v154, s73, -v240
    s_waitcnt lgkmcnt(6)
    v_mfma_f32_32x32x16_bf16 v[160:175], v[212:215], v[84:87], v[160:175]
    ds_read_b128 v[208:211], v228 offset:57344
    v_fma_f32 v155, v155, s73, -v240
    v_fma_f32 v156, v156, s73, -v240
    v_fma_f32 v157, v157, s73, -v240
    v_fma_f32 v158, v158, s73, -v240
    v_fma_f32 v159, v159, s73, -v240
    s_waitcnt lgkmcnt(6)
    v_mfma_f32_32x32x16_bf16 v[160:175], v[216:219], v[88:91], v[160:175]
    ds_read_b128 v[212:215], v229 offset:57344
    v_exp_f32 v152, v152
    v_exp_f32 v153, v153
    v_exp_f32 v154, v154
    v_exp_f32 v155, v155
    v_exp_f32 v156, v156
    s_waitcnt lgkmcnt(6)
    v_mfma_f32_32x32x16_bf16 v[160:175], v[220:223], v[92:95], v[160:175]
    ds_read_b128 v[216:219], v230 offset:57344
    v_exp_f32 v157, v157
    v_exp_f32 v158, v158
    v_exp_f32 v159, v159
    v_add_f32 v241, v241, v152
    v_add_f32 v242, v242, v153
    s_waitcnt lgkmcnt(6)
    v_mfma_f32_32x32x16_bf16 v[176:191], v[192:195], v[64:67], 0
    ds_read_b128 v[220:223], v231 offset:57344
    v_add_f32 v241, v241, v154
    v_add_f32 v242, v242, v155
    v_add_f32 v241, v241, v156
    v_add_f32 v242, v242, v157
    v_add_f32 v241, v241, v158
    s_waitcnt lgkmcnt(6)
    v_mfma_f32_32x32x16_bf16 v[176:191], v[196:199], v[68:71], v[176:191]
    s_waitcnt vmcnt(8) lgkmcnt(0)
    s_barrier
    s_add_u32 m0, s67, 49152
    s_add_u32 s71, s69, 180224
    buffer_load_dwordx4 v236, s[48:51], s71 offen sc1 nt lds
    s_add_u32 m0, s67, 57344
    s_add_u32 s71, s69, 188416
    buffer_load_dwordx4 v236, s[48:51], s71 offen sc1 nt lds
    s_add_u32 m0, s67, 81920
    s_add_u32 s71, s69, 147456
    buffer_load_dwordx4 v237, s[52:55], s71 offen sc1 nt lds
    s_add_u32 m0, s67, 90112
    s_add_u32 s71, s69, 155648
    buffer_load_dwordx4 v237, s[52:55], s71 offen sc1 nt lds
    ds_read_b64_tr_b16 v[192:193], v232 offset:32768
    ds_read_b64_tr_b16 v[194:195], v232 offset:34816
    v_add_f32 v242, v242, v159
    v_cvt_pk_bf16_f32 v152, v152, v153
    v_cvt_pk_bf16_f32 v153, v154, v155
    v_cvt_pk_bf16_f32 v154, v156, v157
    v_cvt_pk_bf16_f32 v155, v158, v159
    v_mfma_f32_32x32x16_bf16 v[176:191], v[200:203], v[72:75], v[176:191]
    ds_read_b64_tr_b16 v[196:197], v233 offset:32768
    ds_read_b64_tr_b16 v[198:199], v233 offset:34816
    v_mfma_f32_32x32x16_bf16 v[176:191], v[204:207], v[76:79], v[176:191]
    ds_read_b64_tr_b16 v[200:201], v234 offset:32768
    ds_read_b64_tr_b16 v[202:203], v234 offset:34816
    v_mfma_f32_32x32x16_bf16 v[176:191], v[208:211], v[80:83], v[176:191]
    ds_read_b64_tr_b16 v[204:205], v235 offset:32768
    ds_read_b64_tr_b16 v[206:207], v235 offset:34816
    v_mfma_f32_32x32x16_bf16 v[176:191], v[212:215], v[84:87], v[176:191]
    ds_read_b64_tr_b16 v[208:209], v232 offset:36864
    ds_read_b64_tr_b16 v[210:211], v232 offset:38912
    v_mfma_f32_32x32x16_bf16 v[176:191], v[216:219], v[88:91], v[176:191]
    ds_read_b64_tr_b16 v[212:213], v233 offset:36864
    ds_read_b64_tr_b16 v[214:215], v233 offset:38912
    v_mfma_f32_32x32x16_bf16 v[176:191], v[220:223], v[92:95], v[176:191]
    ds_read_b64_tr_b16 v[216:217], v234 offset:36864
    ds_read_b64_tr_b16 v[218:219], v234 offset:38912
    v_max3_f32 v244, v160, v161, v162
    v_max3_f32 v244, v244, v163, v164
    v_max3_f32 v244, v244, v165, v166
    v_max3_f32 v244, v244, v167, v168
    v_max3_f32 v244, v244, v169, v170
    s_waitcnt lgkmcnt(12)
    v_mfma_f32_32x32x16_bf16 v[0:15], v[192:195], v[128:131], v[0:15]
    ds_read_b64_tr_b16 v[220:221], v235 offset:36864
    ds_read_b64_tr_b16 v[222:223], v235 offset:38912
    v_max3_f32 v244, v244, v171, v172
    v_max3_f32 v244, v244, v173, v174
    v_max3_f32 v245, v176, v177, v178
    v_max3_f32 v245, v245, v179, v180
    v_max3_f32 v245, v245, v181, v182
    s_waitcnt lgkmcnt(12)
    v_mfma_f32_32x32x16_bf16 v[16:31], v[196:199], v[128:131], v[16:31]
    ds_read_b64_tr_b16 v[192:193], v232 offset:40960
    ds_read_b64_tr_b16 v[194:195], v232 offset:43008
    v_max3_f32 v245, v245, v183, v184
    v_max3_f32 v245, v245, v185, v186
    v_max3_f32 v245, v245, v187, v188
    v_max3_f32 v245, v245, v189, v190
    v_max3_f32 v238, v244, v175, v191
    s_waitcnt lgkmcnt(12)
    v_mfma_f32_32x32x16_bf16 v[32:47], v[200:203], v[128:131], v[32:47]
    ds_read_b64_tr_b16 v[196:197], v233 offset:40960
    ds_read_b64_tr_b16 v[198:199], v233 offset:43008
    v_max_f32 v238, v238, v245
    v_mov_b32 v239, v238
    s_nop 1
    v_permlane32_swap_b32 v238, v239
    v_max_f32 v238, v238, v239
    v_fma_f32 v239, v238, s73, -v240
    s_waitcnt lgkmcnt(12)
    v_mfma_f32_32x32x16_bf16 v[48:63], v[204:207], v[128:131], v[48:63]
    ds_read_b64_tr_b16 v[200:201], v234 offset:40960
    ds_read_b64_tr_b16 v[202:203], v234 offset:43008
    v_cmp_lt_f32 vcc, s74, v239
    s_cbranch_vccnz L_rare1_7
L_back1_7:
    v_fma_f32 v160, v160, s73, -v240
    v_fma_f32 v161, v161, s73, -v240
    s_waitcnt lgkmcnt(12)
    v_mfma_f32_32x32x16_bf16 v[0:15], v[208:211], v[136:139], v[0:15]
    ds_read_b64_tr_b16 v[204:205], v235 offset:40960
    ds_read_b64_tr_b16 v[206:207], v235 offset:43008
    v_fma_f32 v162, v162, s73, -v240
    v_fma_f32 v163, v163, s73, -v240
    v_fma_f32 v164, v164, s73, -v240
    v_fma_f32 v165, v165, s73, -v240
    v_fma_f32 v166, v166, s73, -v240
    s_waitcnt lgkmcnt(12)
    v_mfma_f32_32x32x16_bf16 v[16:31], v[212:215], v[136:139], v[16:31]
    ds_read_b64_tr_b16 v[208:209], v232 offset:45056
    ds_read_b64_tr_b16 v[210:211], v232 offset:47104
    v_fma_f32 v167, v167, s73, -v240
    v_exp_f32 v160, v160
    v_exp_f32 v161, v161
    v_exp_f32 v162, v162
    v_exp_f32 v163, v163
    s_waitcnt lgkmcnt(12)
    v_mfma_f32_32x32x16_bf16 v[32:47], v[216:219], v[136:139], v[32:47]
    ds_read_b64_tr_b16 v[212:213], v233 offset:45056
    ds_read_b64_tr_b16 v[214:215], v233 offset:47104
    v_exp_f32 v164, v164
    v_exp_f32 v165, v165
    v_exp_f32 v166, v166
    v_exp_f32 v167, v167
    v_add_f32 v241, v241, v160
    s_waitcnt lgkmcnt(12)
    v_mfma_f32_32x32x16_bf16 v[48:63], v[220:223], v[136:139], v[48:63]
    ds_read_b64_tr_b16 v[216:217], v234 offset:45056
    ds_read_b64_tr_b16 v[218:219], v234 offset:47104
    v_add_f32 v242, v242, v161
    v_add_f32 v241, v241, v162
    v_add_f32 v242, v242, v163
    v_add_f32 v241, v241, v164
    v_add_f32 v242, v242, v165
    s_waitcnt lgkmcnt(12)
    v_mfma_f32_32x32x16_bf16 v[0:15], v[192:195], v[144:147], v[0:15]
    ds_read_b64_tr_b16 v[220:221], v235 offset:45056
    ds_read_b64_tr_b16 v[222:223], v235 offset:47104
    v_add_f32 v241, v241, v166
    v_add_f32 v242, v242, v167
    v_cvt_pk_bf16_f32 v160, v160, v161
    v_cvt_pk_bf16_f32 v161, v162, v163
    v_cvt_pk_bf16_f32 v162, v164, v165
    s_waitcnt lgkmcnt(12)
    v_mfma_f32_32x32x16_bf16 v[16:31], v[196:199], v[144:147], v[16:31]
    ds_read_b128 v[192:195], v224 offset:0
    v_cvt_pk_bf16_f32 v163, v166, v167
    v_fma_f32 v168, v168, s73, -v240
    v_fma_f32 v169, v169, s73, -v240
    v_fma_f32 v170, v170, s73, -v240
    v_fma_f32 v171, v171, s73, -v240
    s_waitcnt lgkmcnt(11)
    v_mfma_f32_32x32x16_bf16 v[32:47], v[200:203], v[144:147], v[32:47]
    ds_read_b128 v[196:199], v225 offset:0
    v_fma_f32 v172, v172, s73, -v240
    v_fma_f32 v173, v173, s73, -v240
    v_fma_f32 v174, v174, s73, -v240
    v_fma_f32 v175, v175, s73, -v240
    v_exp_f32 v168, v168
    s_waitcnt lgkmcnt(10)
    v_mfma_f32_32x32x16_bf16 v[48:63], v[204:207], v[144:147], v[48:63]
    ds_read_b128 v[200:203], v226 offset:0
    v_exp_f32 v169, v169
    v_exp_f32 v170, v170
    v_exp_f32 v171, v171
    v_exp_f32 v172, v172
    v_exp_f32 v173, v173
    s_waitcnt lgkmcnt(9)
    v_mfma_f32_32x32x16_bf16 v[0:15], v[208:211], v[152:155], v[0:15]
    ds_read_b128 v[204:207], v227 offset:0
    v_exp_f32 v174, v174
    v_exp_f32 v175, v175
    v_add_f32 v241, v241, v168
    v_add_f32 v242, v242, v169
    v_add_f32 v241, v241, v170
    s_waitcnt lgkmcnt(8)
    v_mfma_f32_32x32x16_bf16 v[16:31], v[212:215], v[152:155], v[16:31]
    ds_read_b128 v[208:211], v228 offset:0
    v_add_f32 v242, v242, v171
    v_add_f32 v241, v241, v172
    v_add_f32 v242, v242, v173
    v_add_f32 v241, v241, v174
    v_add_f32 v242, v242, v175
    s_waitcnt lgkmcnt(7)
    v_mfma_f32_32x32x16_bf16 v[32:47], v[216:219], v[152:155], v[32:47]
    ds_read_b128 v[212:215], v229 offset:0
    v_cvt_pk_bf16_f32 v168, v168, v169
    v_cvt_pk_bf16_f32 v169, v170, v171
    v_cvt_pk_bf16_f32 v170, v172, v173
    v_cvt_pk_bf16_f32 v171, v174, v175
    v_fma_f32 v176, v176, s73, -v240
    s_waitcnt lgkmcnt(6)
    v_mfma_f32_32x32x16_bf16 v[48:63], v[220:223], v[152:155], v[48:63]
    ds_read_b128 v[216:219], v230 offset:0
    s_cmp_lg_u32 s72, 0
    s_cbranch_scc1 L_rare2_7
L_back2_7:
    v_fma_f32 v177, v177, s73, -v240
    v_fma_f32 v178, v178, s73, -v240
    v_fma_f32 v179, v179, s73, -v240
    v_fma_f32 v180, v180, s73, -v240
    v_fma_f32 v181, v181, s73, -v240
    s_waitcnt lgkmcnt(6)
    v_mfma_f32_32x32x16_bf16 v[128:143], v[192:195], v[96:99], 0
    ds_read_b128 v[220:223], v231 offset:0
    v_fma_f32 v182, v182, s73, -v240
    v_fma_f32 v183, v183, s73, -v240
    v_exp_f32 v176, v176
    v_exp_f32 v177, v177
    v_exp_f32 v178, v178
    s_waitcnt lgkmcnt(6)
    v_mfma_f32_32x32x16_bf16 v[128:143], v[196:199], v[100:103], v[128:143]
    ds_read_b128 v[192:195], v224 offset:8192
    v_exp_f32 v179, v179
    v_exp_f32 v180, v180
    v_exp_f32 v181, v181
    v_exp_f32 v182, v182
    v_exp_f32 v183, v183
    s_waitcnt lgkmcnt(6)
    v_mfma_f32_32x32x16_bf16 v[128:143], v[200:203], v[104:107], v[128:143]
    ds_read_b128 v[196:199], v225 offset:8192
    v_add_f32 v241, v241, v176
    v_add_f32 v242, v242, v177
    v_add_f32 v241, v241, v178
    v_add_f32 v242, v242, v179
    v_add_f32 v241, v241, v180
    s_waitcnt lgkmcnt(6)
    v_mfma_f32_32x32x16_bf16 v[128:143], v[204:207], v[108:111], v[128:143]
    ds_read_b128 v[200:203], v226 offset:8192
    v_add_f32 v242, v242, v181
    v_add_f32 v241, v241, v182
    v_add_f32 v242, v242, v183
    v_cvt_pk_bf16_f32 v176, v176, v177
    v_cvt_pk_bf16_f32 v177, v178, v179
    s_waitcnt lgkmcnt(6)
    v_mfma_f32_32x32x16_bf16 v[128:143], v[208:211], v[112:115], v[128:143]
    ds_read_b128 v[204:207], v227 offset:8192
    v_cvt_pk_bf16_f32 v178, v180, v181
    v_cvt_pk_bf16_f32 v179, v182, v183
    v_fma_f32 v184, v184, s73, -v240
    v_fma_f32 v185, v185, s73, -v240
    v_fma_f32 v186, v186, s73, -v240
    s_waitcnt lgkmcnt(6)
    v_mfma_f32_32x32x16_bf16 v[128:143], v[212:215], v[116:119], v[128:143]
    ds_read_b128 v[208:211], v228 offset:8192
    v_fma_f32 v187, v187, s73, -v240
    v_fma_f32 v188, v188, s73, -v240
    v_fma_f32 v189, v189, s73, -v240
    v_fma_f32 v190, v190, s73, -v240
    v_fma_f32 v191, v191, s73, -v240
    s_waitcnt lgkmcnt(6)
    v_mfma_f32_32x32x16_bf16 v[128:143], v[216:219], v[120:123], v[128:143]
    ds_read_b128 v[212:215], v229 offset:8192
    v_exp_f32 v184, v184
    v_exp_f32 v185, v185
    v_exp_f32 v186, v186
    v_exp_f32 v187, v187
    v_exp_f32 v188, v188
    s_waitcnt lgkmcnt(6)
    v_mfma_f32_32x32x16_bf16 v[128:143], v[220:223], v[124:127], v[128:143]
    ds_read_b128 v[216:219], v230 offset:8192
    v_exp_f32 v189, v189
    v_exp_f32 v190, v190
    v_exp_f32 v191, v191
    v_add_f32 v241, v241, v184
    v_add_f32 v242, v242, v185
    s_waitcnt lgkmcnt(6)
    v_mfma_f32_32x32x16_bf16 v[144:159], v[192:195], v[96:99], 0
    ds_read_b128 v[220:223], v231 offset:8192
    v_add_f32 v241, v241, v186
    v_add_f32 v242, v242, v187
    v_add_f32 v241, v241, v188
    v_add_f32 v242, v242, v189
    v_add_f32 v241, v241, v190
    s_waitcnt lgkmcnt(6)
    v_mfma_f32_32x32x16_bf16 v[144:159], v[196:199], v[100:103], v[144:159]
    s_waitcnt vmcnt(8) lgkmcnt(0)
    s_barrier
    s_add_u32 m0, s67, 0
    s_add_u32 s71, s69, 196608
    buffer_load_dwordx4 v236, s[48:51], s71 offen sc1 nt lds
    s_add_u32 m0, s67, 8192
    s_add_u32 s71, s69, 204800
    buffer_load_dwordx4 v236, s[48:51], s71 offen sc1 nt lds
    s_add_u32 m0, s67, 98304
    s_add_u32 s71, s69, 163840
    buffer_load_dwordx4 v237, s[52:55], s71 offen sc1 nt lds
    s_add_u32 m0, s67, 106496
    s_add_u32 s71, s69, 172032
    buffer_load_dwordx4 v237, s[52:55], s71 offen sc1 nt lds
    ds_read_b64_tr_b16 v[192:193], v232 offset:49152
    ds_read_b64_tr_b16 v[194:195], v232 offset:51200
    v_add_f32 v242, v242, v191
    v_cvt_pk_bf16_f32 v184, v184, v185
    v_cvt_pk_bf16_f32 v185, v186, v187
    v_cvt_pk_bf16_f32 v186, v188, v189
    v_cvt_pk_bf16_f32 v187, v190, v191
    v_mfma_f32_32x32x16_bf16 v[144:159], v[200:203], v[104:107], v[144:159]
    ds_read_b64_tr_b16 v[196:197], v233 offset:49152
    ds_read_b64_tr_b16 v[198:199], v233 offset:51200
    v_add_f32 v250, v241, v242
    v_mov_b32 v251, v250
    s_nop 1
    v_permlane32_swap_b32 v250, v251
    v_add_f32 v250, v250, v251
    v_rcp_f32 v249, v250
    v_mfma_f32_32x32x16_bf16 v[144:159], v[204:207], v[108:111], v[144:159]
    ds_read_b64_tr_b16 v[200:201], v234 offset:49152
    ds_read_b64_tr_b16 v[202:203], v234 offset:51200
    v_mfma_f32_32x32x16_bf16 v[144:159], v[208:211], v[112:115], v[144:159]
    ds_read_b64_tr_b16 v[204:205], v235 offset:49152
    ds_read_b64_tr_b16 v[206:207], v235 offset:51200
    v_mfma_f32_32x32x16_bf16 v[144:159], v[212:215], v[116:119], v[144:159]
    ds_read_b64_tr_b16 v[208:209], v232 offset:53248
    ds_read_b64_tr_b16 v[210:211], v232 offset:55296
    v_mfma_f32_32x32x16_bf16 v[144:159], v[216:219], v[120:123], v[144:159]
    ds_read_b64_tr_b16 v[212:213], v233 offset:53248
    ds_read_b64_tr_b16 v[214:215], v233 offset:55296
    v_mfma_f32_32x32x16_bf16 v[144:159], v[220:223], v[124:127], v[144:159]
    ds_read_b64_tr_b16 v[216:217], v234 offset:53248
    ds_read_b64_tr_b16 v[218:219], v234 offset:55296
    v_max3_f32 v244, v128, v129, v130
    v_max3_f32 v244, v244, v131, v132
    v_max3_f32 v244, v244, v133, v134
    v_max3_f32 v244, v244, v135, v136
    v_max3_f32 v244, v244, v137, v138
    s_waitcnt lgkmcnt(12)
    v_mfma_f32_32x32x16_bf16 v[0:15], v[192:195], v[160:163], v[0:15]
    ds_read_b64_tr_b16 v[220:221], v235 offset:53248
    ds_read_b64_tr_b16 v[222:223], v235 offset:55296
    v_max3_f32 v244, v244, v139, v140
    v_max3_f32 v244, v244, v141, v142
    v_max3_f32 v245, v144, v145, v146
    v_max3_f32 v245, v245, v147, v148
    v_max3_f32 v245, v245, v149, v150
    s_waitcnt lgkmcnt(12)
    v_mfma_f32_32x32x16_bf16 v[16:31], v[196:199], v[160:163], v[16:31]
    ds_read_b64_tr_b16 v[192:193], v232 offset:57344
    ds_read_b64_tr_b16 v[194:195], v232 offset:59392
    v_max3_f32 v245, v245, v151, v152
    v_max3_f32 v245, v245, v153, v154
    v_max3_f32 v245, v245, v155, v156
    v_max3_f32 v245, v245, v157, v158
    v_max3_f32 v238, v244, v143, v159
    s_waitcnt lgkmcnt(12)
    v_mfma_f32_32x32x16_bf16 v[32:47], v[200:203], v[160:163], v[32:47]
    ds_read_b64_tr_b16 v[196:197], v233 offset:57344
    ds_read_b64_tr_b16 v[198:199], v233 offset:59392
    v_max_f32 v238, v238, v245
    v_mov_b32 v239, v238
    s_nop 1
    v_permlane32_swap_b32 v238, v239
    v_max_f32 v238, v238, v239
    v_mul_f32 v240, s73, v238
    s_waitcnt lgkmcnt(12)
    v_mfma_f32_32x32x16_bf16 v[48:63], v[204:207], v[160:163], v[48:63]
    ds_read_b64_tr_b16 v[200:201], v234 offset:57344
    ds_read_b64_tr_b16 v[202:203], v234 offset:59392
    v_mov_b32 v241, 0
    v_mov_b32 v242, 0
    v_fma_f32 v128, v128, s73, -v240
    v_fma_f32 v129, v129, s73, -v240
    v_fma_f32 v130, v130, s73, -v240
    s_waitcnt lgkmcnt(12)
    v_mfma_f32_32x32x16_bf16 v[0:15], v[208:211], v[168:171], v[0:15]
    ds_read_b64_tr_b16 v[204:205], v235 offset:57344
    ds_read_b64_tr_b16 v[206:207], v235 offset:59392
    v_fma_f32 v131, v131, s73, -v240
    v_fma_f32 v132, v132, s73, -v240
    v_fma_f32 v133, v133, s73, -v240
    v_fma_f32 v134, v134, s73, -v240
    v_fma_f32 v135, v135, s73, -v240
    s_waitcnt lgkmcnt(12)
    v_mfma_f32_32x32x16_bf16 v[16:31], v[212:215], v[168:171], v[16:31]
    ds_read_b64_tr_b16 v[208:209], v232 offset:61440
    ds_read_b64_tr_b16 v[210:211], v232 offset:63488
    v_exp_f32 v128, v128
    v_exp_f32 v129, v129
    v_exp_f32 v130, v130
    v_exp_f32 v131, v131
    v_exp_f32 v132, v132
    s_waitcnt lgkmcnt(12)
    v_mfma_f32_32x32x16_bf16 v[32:47], v[216:219], v[168:171], v[32:47]
    ds_read_b64_tr_b16 v[212:213], v233 offset:61440
    ds_read_b64_tr_b16 v[214:215], v233 offset:63488
    v_exp_f32 v133, v133
    v_exp_f32 v134, v134
    v_exp_f32 v135, v135
    v_add_f32 v241, v241, v128
    v_add_f32 v242, v242, v129
    s_waitcnt lgkmcnt(12)
    v_mfma_f32_32x32x16_bf16 v[48:63], v[220:223], v[168:171], v[48:63]
    ds_read_b64_tr_b16 v[216:217], v234 offset:61440
    ds_read_b64_tr_b16 v[218:219], v234 offset:63488
    v_add_f32 v241, v241, v130
    v_add_f32 v242, v242, v131
    v_add_f32 v241, v241, v132
    v_add_f32 v242, v242, v133
    v_add_f32 v241, v241, v134
    s_waitcnt lgkmcnt(12)
    v_mfma_f32_32x32x16_bf16 v[0:15], v[192:195], v[176:179], v[0:15]
    ds_read_b64_tr_b16 v[220:221], v235 offset:61440
    ds_read_b64_tr_b16 v[222:223], v235 offset:63488
    v_add_f32 v242, v242, v135
    v_cvt_pk_bf16_f32 v128, v128, v129
    v_cvt_pk_bf16_f32 v129, v130, v131
    v_cvt_pk_bf16_f32 v130, v132, v133
    v_cvt_pk_bf16_f32 v131, v134, v135
    s_waitcnt lgkmcnt(12)
    v_mfma_f32_32x32x16_bf16 v[16:31], v[196:199], v[176:179], v[16:31]
    ds_read_b128 v[192:195], v224 offset:16384
    v_fma_f32 v136, v136, s73, -v240
    v_fma_f32 v137, v137, s73, -v240
    v_fma_f32 v138, v138, s73, -v240
    v_fma_f32 v139, v139, s73, -v240
    v_fma_f32 v140, v140, s73, -v240
    s_waitcnt lgkmcnt(11)
    v_mfma_f32_32x32x16_bf16 v[32:47], v[200:203], v[176:179], v[32:47]
    ds_read_b128 v[196:199], v225 offset:16384
    v_fma_f32 v141, v141, s73, -v240
    v_fma_f32 v142, v142, s73, -v240
    v_fma_f32 v143, v143, s73, -v240
    v_exp_f32 v136, v136
    v_exp_f32 v137, v137
    s_waitcnt lgkmcnt(10)
    v_mfma_f32_32x32x16_bf16 v[48:63], v[204:207], v[176:179], v[48:63]
    ds_read_b128 v[200:203], v226 offset:16384
    v_exp_f32 v138, v138
    v_exp_f32 v139, v139
    v_exp_f32 v140, v140
    v_exp_f32 v141, v141
    v_exp_f32 v142, v142
    s_waitcnt lgkmcnt(9)
    v_mfma_f32_32x32x16_bf16 v[0:15], v[208:211], v[184:187], v[0:15]
    ds_read_b128 v[204:207], v227 offset:16384
    v_exp_f32 v143, v143
    v_add_f32 v241, v241, v136
    v_add_f32 v242, v242, v137
    v_add_f32 v241, v241, v138
    v_add_f32 v242, v242, v139
    s_waitcnt lgkmcnt(8)
    v_mfma_f32_32x32x16_bf16 v[16:31], v[212:215], v[184:187], v[16:31]
    ds_read_b128 v[208:211], v228 offset:16384
    v_add_f32 v241, v241, v140
    v_add_f32 v242, v242, v141
    v_add_f32 v241, v241, v142
    v_add_f32 v242, v242, v143
    v_cvt_pk_bf16_f32 v136, v136, v137
    s_waitcnt lgkmcnt(7)
    v_mfma_f32_32x32x16_bf16 v[32:47], v[216:219], v[184:187], v[32:47]
    ds_read_b128 v[212:215], v229 offset:16384
    v_cvt_pk_bf16_f32 v137, v138, v139
    v_cvt_pk_bf16_f32 v138, v140, v141
    v_cvt_pk_bf16_f32 v139, v142, v143
    v_fma_f32 v144, v144, s73, -v240
    v_fma_f32 v145, v145, s73, -v240
    s_waitcnt lgkmcnt(6)
    v_mfma_f32_32x32x16_bf16 v[48:63], v[220:223], v[184:187], v[48:63]
    ds_read_b128 v[216:219], v230 offset:16384
    v_fma_f32 v146, v146, s73, -v240
    v_fma_f32 v147, v147, s73, -v240
    v_fma_f32 v148, v148, s73, -v240
    v_fma_f32 v149, v149, s73, -v240
    v_fma_f32 v150, v150, s73, -v240
    v_mul_f32 v0, v0, v249
    v_mul_f32 v1, v1, v249
    v_mul_f32 v2, v2, v249
    v_mul_f32 v3, v3, v249
    v_mul_f32 v4, v4, v249
    v_mul_f32 v5, v5, v249
    s_waitcnt lgkmcnt(6)
    v_mfma_f32_32x32x16_bf16 v[160:175], v[192:195], v[96:99], 0
    ds_read_b128 v[220:223], v231 offset:16384
    v_fma_f32 v151, v151, s73, -v240
    v_exp_f32 v144, v144
    v_exp_f32 v145, v145
    v_exp_f32 v146, v146
    v_exp_f32 v147, v147
    v_mul_f32 v6, v6, v249
    v_mul_f32 v7, v7, v249
    v_cvt_pk_bf16_f32 v64, v0, v1
    v_cvt_pk_bf16_f32 v65, v2, v3
    v_cvt_pk_bf16_f32 v66, v4, v5
    v_cvt_pk_bf16_f32 v67, v6, v7
    s_waitcnt lgkmcnt(6)
    v_mfma_f32_32x32x16_bf16 v[160:175], v[196:199], v[100:103], v[160:175]
    ds_read_b128 v[192:195], v224 offset:24576
    v_exp_f32 v148, v148
    v_exp_f32 v149, v149
    v_exp_f32 v150, v150
    v_exp_f32 v151, v151
    v_add_f32 v241, v241, v144
    v_mul_f32 v8, v8, v249
    v_mul_f32 v9, v9, v249
    v_mul_f32 v10, v10, v249
    v_mul_f32 v11, v11, v249
    v_mul_f32 v12, v12, v249
    v_mul_f32 v13, v13, v249
    s_waitcnt lgkmcnt(6)
    v_mfma_f32_32x32x16_bf16 v[160:175], v[200:203], v[104:107], v[160:175]
    ds_read_b128 v[196:199], v225 offset:24576
    v_add_f32 v242, v242, v145
    v_add_f32 v241, v241, v146
    v_add_f32 v242, v242, v147
    v_add_f32 v241, v241, v148
    v_add_f32 v242, v242, v149
    v_mul_f32 v14, v14, v249
    v_mul_f32 v15, v15, v249
    v_cvt_pk_bf16_f32 v68, v8, v9
    v_cvt_pk_bf16_f32 v69, v10, v11
    v_cvt_pk_bf16_f32 v70, v12, v13
    v_cvt_pk_bf16_f32 v71, v14, v15
    s_waitcnt lgkmcnt(6)
    v_mfma_f32_32x32x16_bf16 v[160:175], v[204:207], v[108:111], v[160:175]
    ds_read_b128 v[200:203], v226 offset:24576
    v_add_f32 v241, v241, v150
    v_add_f32 v242, v242, v151
    v_cvt_pk_bf16_f32 v144, v144, v145
    v_cvt_pk_bf16_f32 v145, v146, v147
    v_cvt_pk_bf16_f32 v146, v148, v149
    v_mul_f32 v16, v16, v249
    v_mul_f32 v17, v17, v249
    v_mul_f32 v18, v18, v249
    v_mul_f32 v19, v19, v249
    v_mul_f32 v20, v20, v249
    v_mul_f32 v21, v21, v249
    s_waitcnt lgkmcnt(6)
    v_mfma_f32_32x32x16_bf16 v[160:175], v[208:211], v[112:115], v[160:175]
    ds_read_b128 v[204:207], v227 offset:24576
    v_cvt_pk_bf16_f32 v147, v150, v151
    v_fma_f32 v152, v152, s73, -v240
    v_fma_f32 v153, v153, s73, -v240
    v_fma_f32 v154, v154, s73, -v240
    v_fma_f32 v155, v155, s73, -v240
    v_mul_f32 v22, v22, v249
    v_mul_f32 v23, v23, v249
    v_cvt_pk_bf16_f32 v72, v16, v17
    v_cvt_pk_bf16_f32 v73, v18, v19
    v_cvt_pk_bf16_f32 v74, v20, v21
    v_cvt_pk_bf16_f32 v75, v22, v23
    s_waitcnt lgkmcnt(6)
    v_mfma_f32_32x32x16_bf16 v[160:175], v[212:215], v[116:119], v[160:175]
    ds_read_b128 v[208:211], v228 offset:24576
    v_fma_f32 v156, v156, s73, -v240
    v_fma_f32 v157, v157, s73, -v240
    v_fma_f32 v158, v158, s73, -v240
    v_fma_f32 v159, v159, s73, -v240
    v_exp_f32 v152, v152
    v_mul_f32 v24, v24, v249
    v_mul_f32 v25, v25, v249
    v_mul_f32 v26, v26, v249
    v_mul_f32 v27, v27, v249
    v_mul_f32 v28, v28, v249
    v_mul_f32 v29, v29, v249
    s_waitcnt lgkmcnt(6)
    v_mfma_f32_32x32x16_bf16 v[160:175], v[216:219], v[120:123], v[160:175]
    ds_read_b128 v[212:215], v229 offset:24576
    v_exp_f32 v153, v153
    v_exp_f32 v154, v154
    v_exp_f32 v155, v155
    v_exp_f32 v156, v156
    v_exp_f32 v157, v157
    v_mul_f32 v30, v30, v249
    v_mul_f32 v31, v31, v249
    v_cvt_pk_bf16_f32 v76, v24, v25
    v_cvt_pk_bf16_f32 v77, v26, v27
    v_cvt_pk_bf16_f32 v78, v28, v29
    v_cvt_pk_bf16_f32 v79, v30, v31
    s_waitcnt lgkmcnt(6)
    v_mfma_f32_32x32x16_bf16 v[160:175], v[220:223], v[124:127], v[160:175]
    ds_read_b128 v[216:219], v230 offset:24576
    v_exp_f32 v158, v158
    v_exp_f32 v159, v159
    v_add_f32 v241, v241, v152
    v_add_f32 v242, v242, v153
    v_add_f32 v241, v241, v154
    v_mul_f32 v32, v32, v249
    v_mul_f32 v33, v33, v249
    v_mul_f32 v34, v34, v249
    v_mul_f32 v35, v35, v249
    v_mul_f32 v36, v36, v249
    v_mul_f32 v37, v37, v249
    s_waitcnt lgkmcnt(6)
    v_mfma_f32_32x32x16_bf16 v[176:191], v[192:195], v[96:99], 0
    ds_read_b128 v[220:223], v231 offset:24576
    v_add_f32 v242, v242, v155
    v_add_f32 v241, v241, v156
    v_add_f32 v242, v242, v157
    v_add_f32 v241, v241, v158
    v_add_f32 v242, v242, v159
    v_mul_f32 v38, v38, v249
    v_mul_f32 v39, v39, v249
    v_cvt_pk_bf16_f32 v80, v32, v33
    v_cvt_pk_bf16_f32 v81, v34, v35
    v_cvt_pk_bf16_f32 v82, v36, v37
    v_cvt_pk_bf16_f32 v83, v38, v39
    s_waitcnt lgkmcnt(6)
    v_mfma_f32_32x32x16_bf16 v[176:191], v[196:199], v[100:103], v[176:191]
    s_waitcnt vmcnt(8) lgkmcnt(0)
    s_barrier
    s_add_u32 m0, s67, 16384
    s_add_u32 s71, s69, 212992
    buffer_load_dwordx4 v236, s[48:51], s71 offen sc1 nt lds
    s_add_u32 m0, s67, 24576
    s_add_u32 s71, s69, 221184
    buffer_load_dwordx4 v236, s[48:51], s71 offen sc1 nt lds
    s_add_u32 m0, s67, 114688
    s_add_u32 s71, s69, 180224
    buffer_load_dwordx4 v237, s[52:55], s71 offen sc1 nt lds
    s_add_u32 m0, s67, 122880
    s_add_u32 s71, s69, 188416
    buffer_load_dwordx4 v237, s[52:55], s71 offen sc1 nt lds
    s_add_u32 m0, s67, 131072
    s_add_u32 s71, s77, 0
    buffer_load_dwordx4 v247, s[88:91], s71 offen  lds
    s_add_u32 m0, s67, 139264
    s_add_u32 s71, s77, 32768
    buffer_load_dwordx4 v247, s[88:91], s71 offen  lds
    ds_read_b64_tr_b16 v[192:193], v232 offset:0
    ds_read_b64_tr_b16 v[194:195], v232 offset:2048
    v_cvt_pk_bf16_f32 v152, v152, v153
    v_cvt_pk_bf16_f32 v153, v154, v155
    v_cvt_pk_bf16_f32 v154, v156, v157
    v_cvt_pk_bf16_f32 v155, v158, v159
    v_mul_f32 v40, v40, v249
    v_mul_f32 v41, v41, v249
    v_mul_f32 v42, v42, v249
    v_mul_f32 v43, v43, v249
    v_mul_f32 v44, v44, v249
    v_mul_f32 v45, v45, v249
    v_mfma_f32_32x32x16_bf16 v[176:191], v[200:203], v[104:107], v[176:191]
    ds_read_b64_tr_b16 v[196:197], v233 offset:0
    ds_read_b64_tr_b16 v[198:199], v233 offset:2048
    v_mul_f32 v46, v46, v249
    v_mul_f32 v47, v47, v249
    v_cvt_pk_bf16_f32 v84, v40, v41
    v_cvt_pk_bf16_f32 v85, v42, v43
    v_cvt_pk_bf16_f32 v86, v44, v45
    v_cvt_pk_bf16_f32 v87, v46, v47
    v_mfma_f32_32x32x16_bf16 v[176:191], v[204:207], v[108:111], v[176:191]
    ds_read_b64_tr_b16 v[200:201], v234 offset:0
    ds_read_b64_tr_b16 v[202:203], v234 offset:2048
    v_mul_f32 v48, v48, v249
    v_mul_f32 v49, v49, v249
    v_mul_f32 v50, v50, v249
    v_mul_f32 v51, v51, v249
    v_mul_f32 v52, v52, v249
    v_mul_f32 v53, v53, v249
    v_mfma_f32_32x32x16_bf16 v[176:191], v[208:211], v[112:115], v[176:191]
    ds_read_b64_tr_b16 v[204:205], v235 offset:0
    ds_read_b64_tr_b16 v[206:207], v235 offset:2048
    v_mul_f32 v54, v54, v249
    v_mul_f32 v55, v55, v249
    v_cvt_pk_bf16_f32 v88, v48, v49
    v_cvt_pk_bf16_f32 v89, v50, v51
    v_cvt_pk_bf16_f32 v90, v52, v53
    v_cvt_pk_bf16_f32 v91, v54, v55
    v_mfma_f32_32x32x16_bf16 v[176:191], v[212:215], v[116:119], v[176:191]
    ds_read_b64_tr_b16 v[208:209], v232 offset:4096
    ds_read_b64_tr_b16 v[210:211], v232 offset:6144
    v_mul_f32 v56, v56, v249
    v_mul_f32 v57, v57, v249
    v_mul_f32 v58, v58, v249
    v_mul_f32 v59, v59, v249
    v_mul_f32 v60, v60, v249
    v_mul_f32 v61, v61, v249
    v_mfma_f32_32x32x16_bf16 v[176:191], v[216:219], v[120:123], v[176:191]
    ds_read_b64_tr_b16 v[212:213], v233 offset:4096
    ds_read_b64_tr_b16 v[214:215], v233 offset:6144
    v_mul_f32 v62, v62, v249
    v_mul_f32 v63, v63, v249
    v_cvt_pk_bf16_f32 v92, v56, v57
    v_cvt_pk_bf16_f32 v93, v58, v59
    v_cvt_pk_bf16_f32 v94, v60, v61
    v_cvt_pk_bf16_f32 v95, v62, v63
    v_mfma_f32_32x32x16_bf16 v[176:191], v[220:223], v[124:127], v[176:191]
    ds_read_b64_tr_b16 v[216:217], v234 offset:4096
    ds_read_b64_tr_b16 v[218:219], v234 offset:6144
    v_max3_f32 v244, v160, v161, v162
    v_max3_f32 v244, v244, v163, v164
    v_max3_f32 v244, v244, v165, v166
    v_max3_f32 v244, v244, v167, v168
    v_max3_f32 v244, v244, v169, v170
    s_waitcnt lgkmcnt(12)
    v_mfma_f32_32x32x16_bf16 v[0:15], v[192:195], v[128:131], 0
    ds_read_b64_tr_b16 v[220:221], v235 offset:4096
    ds_read_b64_tr_b16 v[222:223], v235 offset:6144
    v_max3_f32 v244, v244, v171, v172
    v_max3_f32 v244, v244, v173, v174
    v_max3_f32 v245, v176, v177, v178
    v_max3_f32 v245, v245, v179, v180
    v_max3_f32 v245, v245, v181, v182
    s_waitcnt lgkmcnt(12)
    v_mfma_f32_32x32x16_bf16 v[16:31], v[196:199], v[128:131], 0
    ds_read_b64_tr_b16 v[192:193], v232 offset:8192
    ds_read_b64_tr_b16 v[194:195], v232 offset:10240
    v_max3_f32 v245, v245, v183, v184
    v_max3_f32 v245, v245, v185, v186
    v_max3_f32 v245, v245, v187, v188
    v_max3_f32 v245, v245, v189, v190
    v_max3_f32 v238, v244, v175, v191
    s_waitcnt lgkmcnt(12)
    v_mfma_f32_32x32x16_bf16 v[32:47], v[200:203], v[128:131], 0
    ds_read_b64_tr_b16 v[196:197], v233 offset:8192
    ds_read_b64_tr_b16 v[198:199], v233 offset:10240
    v_max_f32 v238, v238, v245
    v_mov_b32 v239, v238
    s_nop 1
    v_permlane32_swap_b32 v238, v239
    v_max_f32 v238, v238, v239
    v_fma_f32 v239, v238, s73, -v240
    s_waitcnt lgkmcnt(12)
    v_mfma_f32_32x32x16_bf16 v[48:63], v[204:207], v[128:131], 0
    ds_read_b64_tr_b16 v[200:201], v234 offset:8192
    ds_read_b64_tr_b16 v[202:203], v234 offset:10240
    v_cmp_lt_f32 vcc, s74, v239
    s_cbranch_vccnz L_rare1_9
L_back1_9:
    v_fma_f32 v160, v160, s73, -v240
    v_fma_f32 v161, v161, s73, -v240
    s_waitcnt lgkmcnt(12)
    v_mfma_f32_32x32x16_bf16 v[0:15], v[208:211], v[136:139], v[0:15]
    ds_read_b64_tr_b16 v[204:205], v235 offset:8192
    ds_read_b64_tr_b16 v[206:207], v235 offset:10240
    v_fma_f32 v162, v162, s73, -v240
    v_fma_f32 v163, v163, s73, -v240
    v_fma_f32 v164, v164, s73, -v240
    v_fma_f32 v165, v165, s73, -v240
    v_fma_f32 v166, v166, s73, -v240
    s_waitcnt lgkmcnt(12)
    v_mfma_f32_32x32x16_bf16 v[16:31], v[212:215], v[136:139], v[16:31]
    ds_read_b64_tr_b16 v[208:209], v232 offset:12288
    ds_read_b64_tr_b16 v[210:211], v232 offset:14336
    v_fma_f32 v167, v167, s73, -v240
    v_exp_f32 v160, v160
    v_exp_f32 v161, v161
    v_exp_f32 v162, v162
    v_exp_f32 v163, v163
    s_waitcnt lgkmcnt(12)
    v_mfma_f32_32x32x16_bf16 v[32:47], v[216:219], v[136:139], v[32:47]
    ds_read_b64_tr_b16 v[212:213], v233 offset:12288
    ds_read_b64_tr_b16 v[214:215], v233 offset:14336
    v_exp_f32 v164, v164
    v_exp_f32 v165, v165
    v_exp_f32 v166, v166
    v_exp_f32 v167, v167
    v_add_f32 v241, v241, v160
    s_waitcnt lgkmcnt(12)
    v_mfma_f32_32x32x16_bf16 v[48:63], v[220:223], v[136:139], v[48:63]
    ds_read_b64_tr_b16 v[216:217], v234 offset:12288
    ds_read_b64_tr_b16 v[218:219], v234 offset:14336
    v_add_f32 v242, v242, v161
    v_add_f32 v241, v241, v162
    v_add_f32 v242, v242, v163
    v_add_f32 v241, v241, v164
    v_add_f32 v242, v242, v165
    s_waitcnt lgkmcnt(12)
    v_mfma_f32_32x32x16_bf16 v[0:15], v[192:195], v[144:147], v[0:15]
    ds_read_b64_tr_b16 v[220:221], v235 offset:12288
    ds_read_b64_tr_b16 v[222:223], v235 offset:14336
    v_add_f32 v241, v241, v166
    v_add_f32 v242, v242, v167
    v_cvt_pk_bf16_f32 v160, v160, v161
    v_cvt_pk_bf16_f32 v161, v162, v163
    v_cvt_pk_bf16_f32 v162, v164, v165
    s_waitcnt lgkmcnt(12)
    v_mfma_f32_32x32x16_bf16 v[16:31], v[196:199], v[144:147], v[16:31]
    ds_read_b128 v[192:195], v224 offset:32768
    v_cvt_pk_bf16_f32 v163, v166, v167
    v_fma_f32 v168, v168, s73, -v240
    v_fma_f32 v169, v169, s73, -v240
    v_fma_f32 v170, v170, s73, -v240
    v_fma_f32 v171, v171, s73, -v240
    s_waitcnt lgkmcnt(11)
    v_mfma_f32_32x32x16_bf16 v[32:47], v[200:203], v[144:147], v[32:47]
    ds_read_b128 v[196:199], v225 offset:32768
    v_fma_f32 v172, v172, s73, -v240
    v_fma_f32 v173, v173, s73, -v240
    v_fma_f32 v174, v174, s73, -v240
    v_fma_f32 v175, v175, s73, -v240
    v_exp_f32 v168, v168
    s_waitcnt lgkmcnt(10)
    v_mfma_f32_32x32x16_bf16 v[48:63], v[204:207], v[144:147], v[48:63]
    ds_read_b128 v[200:203], v226 offset:32768
    v_exp_f32 v169, v169
    v_exp_f32 v170, v170
    v_exp_f32 v171, v171
    v_exp_f32 v172, v172
    v_exp_f32 v173, v173
    s_waitcnt lgkmcnt(9)
    v_mfma_f32_32x32x16_bf16 v[0:15], v[208:211], v[152:155], v[0:15]
    ds_read_b128 v[204:207], v227 offset:32768
    v_exp_f32 v174, v174
    v_exp_f32 v175, v175
    v_add_f32 v241, v241, v168
    v_add_f32 v242, v242, v169
    v_add_f32 v241, v241, v170
    s_waitcnt lgkmcnt(8)
    v_mfma_f32_32x32x16_bf16 v[16:31], v[212:215], v[152:155], v[16:31]
    ds_read_b128 v[208:211], v228 offset:32768
    v_add_f32 v242, v242, v171
    v_add_f32 v241, v241, v172
    v_add_f32 v242, v242, v173
    v_add_f32 v241, v241, v174
    v_add_f32 v242, v242, v175
    s_waitcnt lgkmcnt(7)
    v_mfma_f32_32x32x16_bf16 v[32:47], v[216:219], v[152:155], v[32:47]
    ds_read_b128 v[212:215], v229 offset:32768
    v_cvt_pk_bf16_f32 v168, v168, v169
    v_cvt_pk_bf16_f32 v169, v170, v171
    v_cvt_pk_bf16_f32 v170, v172, v173
    v_cvt_pk_bf16_f32 v171, v174, v175
    v_fma_f32 v176, v176, s73, -v240
    s_waitcnt lgkmcnt(6)
    v_mfma_f32_32x32x16_bf16 v[48:63], v[220:223], v[152:155], v[48:63]
    ds_read_b128 v[216:219], v230 offset:32768
    s_cmp_lg_u32 s72, 0
    s_cbranch_scc1 L_rare2_9
L_back2_9:
    v_fma_f32 v177, v177, s73, -v240
    v_fma_f32 v178, v178, s73, -v240
    v_fma_f32 v179, v179, s73, -v240
    v_fma_f32 v180, v180, s73, -v240
    v_fma_f32 v181, v181, s73, -v240
    s_waitcnt lgkmcnt(6)
    v_mfma_f32_32x32x16_bf16 v[128:143], v[192:195], v[96:99], 0
    ds_read_b128 v[220:223], v231 offset:32768
    v_fma_f32 v182, v182, s73, -v240
    v_fma_f32 v183, v183, s73, -v240
    v_exp_f32 v176, v176
    v_exp_f32 v177, v177
    v_exp_f32 v178, v178
    s_waitcnt lgkmcnt(6)
    v_mfma_f32_32x32x16_bf16 v[128:143], v[196:199], v[100:103], v[128:143]
    ds_read_b128 v[192:195], v224 offset:40960
    v_exp_f32 v179, v179
    v_exp_f32 v180, v180
    v_exp_f32 v181, v181
    v_exp_f32 v182, v182
    v_exp_f32 v183, v183
    s_waitcnt lgkmcnt(6)
    v_mfma_f32_32x32x16_bf16 v[128:143], v[200:203], v[104:107], v[128:143]
    ds_read_b128 v[196:199], v225 offset:40960
    v_add_f32 v241, v241, v176
    v_add_f32 v242, v242, v177
    v_add_f32 v241, v241, v178
    v_add_f32 v242, v242, v179
    v_add_f32 v241, v241, v180
    s_waitcnt lgkmcnt(6)
    v_mfma_f32_32x32x16_bf16 v[128:143], v[204:207], v[108:111], v[128:143]
    ds_read_b128 v[200:203], v226 offset:40960
    v_add_f32 v242, v242, v181
    v_add_f32 v241, v241, v182
    v_add_f32 v242, v242, v183
    v_cvt_pk_bf16_f32 v176, v176, v177
    v_cvt_pk_bf16_f32 v177, v178, v179
    s_waitcnt lgkmcnt(6)
    v_mfma_f32_32x32x16_bf16 v[128:143], v[208:211], v[112:115], v[128:143]
    ds_read_b128 v[204:207], v227 offset:40960
    v_cvt_pk_bf16_f32 v178, v180, v181
    v_cvt_pk_bf16_f32 v179, v182, v183
    v_fma_f32 v184, v184, s73, -v240
    v_fma_f32 v185, v185, s73, -v240
    v_fma_f32 v186, v186, s73, -v240
    s_waitcnt lgkmcnt(6)
    v_mfma_f32_32x32x16_bf16 v[128:143], v[212:215], v[116:119], v[128:143]
    ds_read_b128 v[208:211], v228 offset:40960
    v_fma_f32 v187, v187, s73, -v240
    v_fma_f32 v188, v188, s73, -v240
    v_fma_f32 v189, v189, s73, -v240
    v_fma_f32 v190, v190, s73, -v240
    v_fma_f32 v191, v191, s73, -v240
    s_waitcnt lgkmcnt(6)
    v_mfma_f32_32x32x16_bf16 v[128:143], v[216:219], v[120:123], v[128:143]
    ds_read_b128 v[212:215], v229 offset:40960
    v_exp_f32 v184, v184
    v_exp_f32 v185, v185
    v_exp_f32 v186, v186
    v_exp_f32 v187, v187
    v_exp_f32 v188, v188
    s_waitcnt lgkmcnt(6)
    v_mfma_f32_32x32x16_bf16 v[128:143], v[220:223], v[124:127], v[128:143]
    ds_read_b128 v[216:219], v230 offset:40960
    v_exp_f32 v189, v189
    v_exp_f32 v190, v190
    v_exp_f32 v191, v191
    v_add_f32 v241, v241, v184
    v_add_f32 v242, v242, v185
    s_waitcnt lgkmcnt(6)
    v_mfma_f32_32x32x16_bf16 v[144:159], v[192:195], v[96:99], 0
    ds_read_b128 v[220:223], v231 offset:40960
    v_add_f32 v241, v241, v186
    v_add_f32 v242, v242, v187
    v_add_f32 v241, v241, v188
    v_add_f32 v242, v242, v189
    v_add_f32 v241, v241, v190
    s_waitcnt lgkmcnt(6)
    v_mfma_f32_32x32x16_bf16 v[144:159], v[196:199], v[100:103], v[144:159]
    s_waitcnt vmcnt(10) lgkmcnt(0)
    s_barrier
    s_add_u32 m0, s67, 32768
    s_add_u32 s71, s69, 229376
    buffer_load_dwordx4 v236, s[48:51], s71 offen sc1 nt lds
    s_add_u32 m0, s67, 40960
    s_add_u32 s71, s69, 237568
    buffer_load_dwordx4 v236, s[48:51], s71 offen sc1 nt lds
    s_add_u32 m0, s67, 65536
    s_add_u32 s71, s69, 196608
    buffer_load_dwordx4 v237, s[52:55], s71 offen sc1 nt lds
    s_add_u32 m0, s67, 73728
    s_add_u32 s71, s69, 204800
    buffer_load_dwordx4 v237, s[52:55], s71 offen sc1 nt lds
    s_add_u32 m0, s67, 147456
    s_add_u32 s71, s77, 65536
    buffer_load_dwordx4 v247, s[88:91], s71 offen  lds
    s_add_u32 m0, s67, 155648
    s_add_u32 s71, s77, 98304
    buffer_load_dwordx4 v247, s[88:91], s71 offen  lds
    ds_read_b64_tr_b16 v[192:193], v232 offset:16384
    ds_read_b64_tr_b16 v[194:195], v232 offset:18432
    v_add_f32 v242, v242, v191
    v_cvt_pk_bf16_f32 v184, v184, v185
    v_cvt_pk_bf16_f32 v185, v186, v187
    v_cvt_pk_bf16_f32 v186, v188, v189
    v_cvt_pk_bf16_f32 v187, v190, v191
    v_mfma_f32_32x32x16_bf16 v[144:159], v[200:203], v[104:107], v[144:159]
    ds_read_b64_tr_b16 v[196:197], v233 offset:16384
    ds_read_b64_tr_b16 v[198:199], v233 offset:18432
    v_mfma_f32_32x32x16_bf16 v[144:159], v[204:207], v[108:111], v[144:159]
    ds_read_b64_tr_b16 v[200:201], v234 offset:16384
    ds_read_b64_tr_b16 v[202:203], v234 offset:18432
    v_mfma_f32_32x32x16_bf16 v[144:159], v[208:211], v[112:115], v[144:159]
    ds_read_b64_tr_b16 v[204:205], v235 offset:16384
    ds_read_b64_tr_b16 v[206:207], v235 offset:18432
    v_mfma_f32_32x32x16_bf16 v[144:159], v[212:215], v[116:119], v[144:159]
    ds_read_b64_tr_b16 v[208:209], v232 offset:20480
    ds_read_b64_tr_b16 v[210:211], v232 offset:22528
    v_mfma_f32_32x32x16_bf16 v[144:159], v[216:219], v[120:123], v[144:159]
    ds_read_b64_tr_b16 v[212:213], v233 offset:20480
    ds_read_b64_tr_b16 v[214:215], v233 offset:22528
    v_mfma_f32_32x32x16_bf16 v[144:159], v[220:223], v[124:127], v[144:159]
    ds_read_b64_tr_b16 v[216:217], v234 offset:20480
    ds_read_b64_tr_b16 v[218:219], v234 offset:22528
    v_max3_f32 v244, v128, v129, v130
    v_max3_f32 v244, v244, v131, v132
    v_max3_f32 v244, v244, v133, v134
    v_max3_f32 v244, v244, v135, v136
    v_max3_f32 v244, v244, v137, v138
    s_waitcnt lgkmcnt(12)
    v_mfma_f32_32x32x16_bf16 v[0:15], v[192:195], v[160:163], v[0:15]
    ds_read_b64_tr_b16 v[220:221], v235 offset:20480
    ds_read_b64_tr_b16 v[222:223], v235 offset:22528
    v_max3_f32 v244, v244, v139, v140
    v_max3_f32 v244, v244, v141, v142
    v_max3_f32 v245, v144, v145, v146
    v_max3_f32 v245, v245, v147, v148
    v_max3_f32 v245, v245, v149, v150
    s_waitcnt lgkmcnt(12)
    v_mfma_f32_32x32x16_bf16 v[16:31], v[196:199], v[160:163], v[16:31]
    ds_read_b64_tr_b16 v[192:193], v232 offset:24576
    ds_read_b64_tr_b16 v[194:195], v232 offset:26624
    v_max3_f32 v245, v245, v151, v152
    v_max3_f32 v245, v245, v153, v154
    v_max3_f32 v245, v245, v155, v156
    v_max3_f32 v245, v245, v157, v158
    v_max3_f32 v238, v244, v143, v159
    s_waitcnt lgkmcnt(12)
    v_mfma_f32_32x32x16_bf16 v[32:47], v[200:203], v[160:163], v[32:47]
    ds_read_b64_tr_b16 v[196:197], v233 offset:24576
    ds_read_b64_tr_b16 v[198:199], v233 offset:26624
    v_max_f32 v238, v238, v245
    v_mov_b32 v239, v238
    s_nop 1
    v_permlane32_swap_b32 v238, v239
    v_max_f32 v238, v238, v239
    v_fma_f32 v239, v238, s73, -v240
    s_waitcnt lgkmcnt(12)
    v_mfma_f32_32x32x16_bf16 v[48:63], v[204:207], v[160:163], v[48:63]
    ds_read_b64_tr_b16 v[200:201], v234 offset:24576
    ds_read_b64_tr_b16 v[202:203], v234 offset:26624
    v_cmp_lt_f32 vcc, s74, v239
    s_cbranch_vccnz L_rare1_10
L_back1_10:
    v_fma_f32 v128, v128, s73, -v240
    v_fma_f32 v129, v129, s73, -v240
    s_waitcnt lgkmcnt(12)
    v_mfma_f32_32x32x16_bf16 v[0:15], v[208:211], v[168:171], v[0:15]
    ds_read_b64_tr_b16 v[204:205], v235 offset:24576
    ds_read_b64_tr_b16 v[206:207], v235 offset:26624
    v_fma_f32 v130, v130, s73, -v240
    v_fma_f32 v131, v131, s73, -v240
    v_fma_f32 v132, v132, s73, -v240
    v_fma_f32 v133, v133, s73, -v240
    v_fma_f32 v134, v134, s73, -v240
    s_waitcnt lgkmcnt(12)
    v_mfma_f32_32x32x16_bf16 v[16:31], v[212:215], v[168:171], v[16:31]
    ds_read_b64_tr_b16 v[208:209], v232 offset:28672
    ds_read_b64_tr_b16 v[210:211], v232 offset:30720
    v_fma_f32 v135, v135, s73, -v240
    v_exp_f32 v128, v128
    v_exp_f32 v129, v129
    v_exp_f32 v130, v130
    v_exp_f32 v131, v131
    s_waitcnt lgkmcnt(12)
    v_mfma_f32_32x32x16_bf16 v[32:47], v[216:219], v[168:171], v[32:47]
    ds_read_b64_tr_b16 v[212:213], v233 offset:28672
    ds_read_b64_tr_b16 v[214:215], v233 offset:30720
    v_exp_f32 v132, v132
    v_exp_f32 v133, v133
    v_exp_f32 v134, v134
    v_exp_f32 v135, v135
    v_add_f32 v241, v241, v128
    s_waitcnt lgkmcnt(12)
    v_mfma_f32_32x32x16_bf16 v[48:63], v[220:223], v[168:171], v[48:63]
    ds_read_b64_tr_b16 v[216:217], v234 offset:28672
    ds_read_b64_tr_b16 v[218:219], v234 offset:30720
    v_add_f32 v242, v242, v129
    v_add_f32 v241, v241, v130
    v_add_f32 v242, v242, v131
    v_add_f32 v241, v241, v132
    v_add_f32 v242, v242, v133
    s_waitcnt lgkmcnt(12)
    v_mfma_f32_32x32x16_bf16 v[0:15], v[192:195], v[176:179], v[0:15]
    ds_read_b64_tr_b16 v[220:221], v235 offset:28672
    ds_read_b64_tr_b16 v[222:223], v235 offset:30720
    v_add_f32 v241, v241, v134
    v_add_f32 v242, v242, v135
    v_cvt_pk_bf16_f32 v128, v128, v129
    v_cvt_pk_bf16_f32 v129, v130, v131
    v_cvt_pk_bf16_f32 v130, v132, v133
    s_waitcnt lgkmcnt(12)
    v_mfma_f32_32x32x16_bf16 v[16:31], v[196:199], v[176:179], v[16:31]
    ds_read_b128 v[192:195], v224 offset:49152
    v_cvt_pk_bf16_f32 v131, v134, v135
    v_fma_f32 v136, v136, s73, -v240
    v_fma_f32 v137, v137, s73, -v240
    v_fma_f32 v138, v138, s73, -v240
    v_fma_f32 v139, v139, s73, -v240
    s_waitcnt lgkmcnt(11)
    v_mfma_f32_32x32x16_bf16 v[32:47], v[200:203], v[176:179], v[32:47]
    ds_read_b128 v[196:199], v225 offset:49152
    v_fma_f32 v140, v140, s73, -v240
    v_fma_f32 v141, v141, s73, -v240
    v_fma_f32 v142, v142, s73, -v240
    v_fma_f32 v143, v143, s73, -v240
    v_exp_f32 v136, v136
    s_waitcnt lgkmcnt(10)
    v_mfma_f32_32x32x16_bf16 v[48:63], v[204:207], v[176:179], v[48:63]
    ds_read_b128 v[200:203], v226 offset:49152
    v_exp_f32 v137, v137
    v_exp_f32 v138, v138
    v_exp_f32 v139, v139
    v_exp_f32 v140, v140
    v_exp_f32 v141, v141
    s_waitcnt lgkmcnt(9)
    v_mfma_f32_32x32x16_bf16 v[0:15], v[208:211], v[184:187], v[0:15]
    ds_read_b128 v[204:207], v227 offset:49152
    v_exp_f32 v142, v142
    v_exp_f32 v143, v143
    v_add_f32 v241, v241, v136
    v_add_f32 v242, v242, v137
    v_add_f32 v241, v241, v138
    s_waitcnt lgkmcnt(8)
    v_mfma_f32_32x32x16_bf16 v[16:31], v[212:215], v[184:187], v[16:31]
    ds_read_b128 v[208:211], v228 offset:49152
    v_add_f32 v242, v242, v139
    v_add_f32 v241, v241, v140
    v_add_f32 v242, v242, v141
    v_add_f32 v241, v241, v142
    v_add_f32 v242, v242, v143
    s_waitcnt lgkmcnt(7)
    v_mfma_f32_32x32x16_bf16 v[32:47], v[216:219], v[184:187], v[32:47]
    ds_read_b128 v[212:215], v229 offset:49152
    v_cvt_pk_bf16_f32 v136, v136, v137
    v_cvt_pk_bf16_f32 v137, v138, v139
    v_cvt_pk_bf16_f32 v138, v140, v141
    v_cvt_pk_bf16_f32 v139, v142, v143
    v_fma_f32 v144, v144, s73, -v240
    s_waitcnt lgkmcnt(6)
    v_mfma_f32_32x32x16_bf16 v[48:63], v[220:223], v[184:187], v[48:63]
    ds_read_b128 v[216:219], v230 offset:49152
    s_cmp_lg_u32 s72, 0
    s_cbranch_scc1 L_rare2_10
L_back2_10:
    v_fma_f32 v145, v145, s73, -v240
    v_fma_f32 v146, v146, s73, -v240
    v_fma_f32 v147, v147, s73, -v240
    v_fma_f32 v148, v148, s73, -v240
    v_fma_f32 v149, v149, s73, -v240
    s_waitcnt lgkmcnt(6)
    v_mfma_f32_32x32x16_bf16 v[160:175], v[192:195], v[96:99], 0
    ds_read_b128 v[220:223], v231 offset:49152
    v_fma_f32 v150, v150, s73, -v240
    v_fma_f32 v151, v151, s73, -v240
    v_exp_f32 v144, v144
    v_exp_f32 v145, v145
    v_exp_f32 v146, v146
    s_waitcnt lgkmcnt(6)
    v_mfma_f32_32x32x16_bf16 v[160:175], v[196:199], v[100:103], v[160:175]
    ds_read_b128 v[192:195], v224 offset:57344
    v_exp_f32 v147, v147
    v_exp_f32 v148, v148
    v_exp_f32 v149, v149
    v_exp_f32 v150, v150
    v_exp_f32 v151, v151
    s_waitcnt lgkmcnt(6)
    v_mfma_f32_32x32x16_bf16 v[160:175], v[200:203], v[104:107], v[160:175]
    ds_read_b128 v[196:199], v225 offset:57344
    v_add_f32 v241, v241, v144
    v_add_f32 v242, v242, v145
    v_add_f32 v241, v241, v146
    v_add_f32 v242, v242, v147
    v_add_f32 v241, v241, v148
    s_waitcnt lgkmcnt(6)
    v_mfma_f32_32x32x16_bf16 v[160:175], v[204:207], v[108:111], v[160:175]
    ds_read_b128 v[200:203], v226 offset:57344
    v_add_f32 v242, v242, v149
    v_add_f32 v241, v241, v150
    v_add_f32 v242, v242, v151
    v_cvt_pk_bf16_f32 v144, v144, v145
    v_cvt_pk_bf16_f32 v145, v146, v147
    s_waitcnt lgkmcnt(6)
    v_mfma_f32_32x32x16_bf16 v[160:175], v[208:211], v[112:115], v[160:175]
    ds_read_b128 v[204:207], v227 offset:57344
    v_cvt_pk_bf16_f32 v146, v148, v149
    v_cvt_pk_bf16_f32 v147, v150, v151
    v_fma_f32 v152, v152, s73, -v240
    v_fma_f32 v153, v153, s73, -v240
    v_fma_f32 v154, v154, s73, -v240
    s_waitcnt lgkmcnt(6)
    v_mfma_f32_32x32x16_bf16 v[160:175], v[212:215], v[116:119], v[160:175]
    ds_read_b128 v[208:211], v228 offset:57344
    v_fma_f32 v155, v155, s73, -v240
    v_fma_f32 v156, v156, s73, -v240
    v_fma_f32 v157, v157, s73, -v240
    v_fma_f32 v158, v158, s73, -v240
    v_fma_f32 v159, v159, s73, -v240
    s_waitcnt lgkmcnt(6)
    v_mfma_f32_32x32x16_bf16 v[160:175], v[216:219], v[120:123], v[160:175]
    ds_read_b128 v[212:215], v229 offset:57344
    v_exp_f32 v152, v152
    v_exp_f32 v153, v153
    v_exp_f32 v154, v154
    v_exp_f32 v155, v155
    v_exp_f32 v156, v156
    s_waitcnt lgkmcnt(6)
    v_mfma_f32_32x32x16_bf16 v[160:175], v[220:223], v[124:127], v[160:175]
    ds_read_b128 v[216:219], v230 offset:57344
    v_exp_f32 v157, v157
    v_exp_f32 v158, v158
    v_exp_f32 v159, v159
    v_add_f32 v241, v241, v152
    v_add_f32 v242, v242, v153
    s_waitcnt lgkmcnt(6)
    v_mfma_f32_32x32x16_bf16 v[176:191], v[192:195], v[96:99], 0
    ds_read_b128 v[220:223], v231 offset:57344
    v_add_f32 v241, v241, v154
    v_add_f32 v242, v242, v155
    v_add_f32 v241, v241, v156
    v_add_f32 v242, v242, v157
    v_add_f32 v241, v241, v158
    s_waitcnt lgkmcnt(6)
    v_mfma_f32_32x32x16_bf16 v[176:191], v[196:199], v[100:103], v[176:191]
    s_waitcnt vmcnt(12) lgkmcnt(0)
    s_barrier
    s_add_u32 m0, s67, 49152
    s_add_u32 s71, s69, 245760
    buffer_load_dwordx4 v236, s[48:51], s71 offen sc1 nt lds
    s_add_u32 m0, s67, 57344
    s_add_u32 s71, s69, 253952
    buffer_load_dwordx4 v236, s[48:51], s71 offen sc1 nt lds
    s_add_u32 m0, s67, 81920
    s_add_u32 s71, s69, 212992
    buffer_load_dwordx4 v237, s[52:55], s71 offen sc1 nt lds
    s_add_u32 m0, s67, 90112
    s_add_u32 s71, s69, 221184
    buffer_load_dwordx4 v237, s[52:55], s71 offen sc1 nt lds
    ds_read_b64_tr_b16 v[192:193], v232 offset:32768
    ds_read_b64_tr_b16 v[194:195], v232 offset:34816
    v_add_f32 v242, v242, v159
    v_cvt_pk_bf16_f32 v152, v152, v153
    v_cvt_pk_bf16_f32 v153, v154, v155
    v_cvt_pk_bf16_f32 v154, v156, v157
    v_cvt_pk_bf16_f32 v155, v158, v159
    v_mfma_f32_32x32x16_bf16 v[176:191], v[200:203], v[104:107], v[176:191]
    ds_read_b64_tr_b16 v[196:197], v233 offset:32768
    ds_read_b64_tr_b16 v[198:199], v233 offset:34816
    v_mfma_f32_32x32x16_bf16 v[176:191], v[204:207], v[108:111], v[176:191]
    ds_read_b64_tr_b16 v[200:201], v234 offset:32768
    ds_read_b64_tr_b16 v[202:203], v234 offset:34816
    v_mfma_f32_32x32x16_bf16 v[176:191], v[208:211], v[112:115], v[176:191]
    ds_read_b64_tr_b16 v[204:205], v235 offset:32768
    ds_read_b64_tr_b16 v[206:207], v235 offset:34816
    v_mfma_f32_32x32x16_bf16 v[176:191], v[212:215], v[116:119], v[176:191]
    ds_read_b64_tr_b16 v[208:209], v232 offset:36864
    ds_read_b64_tr_b16 v[210:211], v232 offset:38912
    v_mfma_f32_32x32x16_bf16 v[176:191], v[216:219], v[120:123], v[176:191]
    ds_read_b64_tr_b16 v[212:213], v233 offset:36864
    ds_read_b64_tr_b16 v[214:215], v233 offset:38912
    v_mfma_f32_32x32x16_bf16 v[176:191], v[220:223], v[124:127], v[176:191]
    ds_read_b64_tr_b16 v[216:217], v234 offset:36864
    ds_read_b64_tr_b16 v[218:219], v234 offset:38912
    v_max3_f32 v244, v160, v161, v162
    v_max3_f32 v244, v244, v163, v164
    v_max3_f32 v244, v244, v165, v166
    v_max3_f32 v244, v244, v167, v168
    v_max3_f32 v244, v244, v169, v170
    s_waitcnt lgkmcnt(12)
    v_mfma_f32_32x32x16_bf16 v[0:15], v[192:195], v[128:131], v[0:15]
    ds_read_b64_tr_b16 v[220:221], v235 offset:36864
    ds_read_b64_tr_b16 v[222:223], v235 offset:38912
    v_max3_f32 v244, v244, v171, v172
    v_max3_f32 v244, v244, v173, v174
    v_max3_f32 v245, v176, v177, v178
    v_max3_f32 v245, v245, v179, v180
    v_max3_f32 v245, v245, v181, v182
    s_waitcnt lgkmcnt(12)
    v_mfma_f32_32x32x16_bf16 v[16:31], v[196:199], v[128:131], v[16:31]
    ds_read_b64_tr_b16 v[192:193], v232 offset:40960
    ds_read_b64_tr_b16 v[194:195], v232 offset:43008
    v_max3_f32 v245, v245, v183, v184
    v_max3_f32 v245, v245, v185, v186
    v_max3_f32 v245, v245, v187, v188
    v_max3_f32 v245, v245, v189, v190
    v_max3_f32 v238, v244, v175, v191
    s_waitcnt lgkmcnt(12)
    v_mfma_f32_32x32x16_bf16 v[32:47], v[200:203], v[128:131], v[32:47]
    ds_read_b64_tr_b16 v[196:197], v233 offset:40960
    ds_read_b64_tr_b16 v[198:199], v233 offset:43008
    v_max_f32 v238, v238, v245
    v_mov_b32 v239, v238
    s_nop 1
    v_permlane32_swap_b32 v238, v239
    v_max_f32 v238, v238, v239
    v_fma_f32 v239, v238, s73, -v240
    s_waitcnt lgkmcnt(12)
    v_mfma_f32_32x32x16_bf16 v[48:63], v[204:207], v[128:131], v[48:63]
    ds_read_b64_tr_b16 v[200:201], v234 offset:40960
    ds_read_b64_tr_b16 v[202:203], v234 offset:43008
    v_cmp_lt_f32 vcc, s74, v239
    s_cbranch_vccnz L_rare1_11
L_back1_11:
    v_fma_f32 v160, v160, s73, -v240
    v_fma_f32 v161, v161, s73, -v240
    s_waitcnt lgkmcnt(12)
    v_mfma_f32_32x32x16_bf16 v[0:15], v[208:211], v[136:139], v[0:15]
    ds_read_b64_tr_b16 v[204:205], v235 offset:40960
    ds_read_b64_tr_b16 v[206:207], v235 offset:43008
    v_fma_f32 v162, v162, s73, -v240
    v_fma_f32 v163, v163, s73, -v240
    v_fma_f32 v164, v164, s73, -v240
    v_fma_f32 v165, v165, s73, -v240
    v_fma_f32 v166, v166, s73, -v240
    s_waitcnt lgkmcnt(12)
    v_mfma_f32_32x32x16_bf16 v[16:31], v[212:215], v[136:139], v[16:31]
    ds_read_b64_tr_b16 v[208:209], v232 offset:45056
    ds_read_b64_tr_b16 v[210:211], v232 offset:47104
    v_fma_f32 v167, v167, s73, -v240
    v_exp_f32 v160, v160
    v_exp_f32 v161, v161
    v_exp_f32 v162, v162
    v_exp_f32 v163, v163
    s_waitcnt lgkmcnt(12)
    v_mfma_f32_32x32x16_bf16 v[32:47], v[216:219], v[136:139], v[32:47]
    ds_read_b64_tr_b16 v[212:213], v233 offset:45056
    ds_read_b64_tr_b16 v[214:215], v233 offset:47104
    v_exp_f32 v164, v164
    v_exp_f32 v165, v165
    v_exp_f32 v166, v166
    v_exp_f32 v167, v167
    v_add_f32 v241, v241, v160
    s_waitcnt lgkmcnt(12)
    v_mfma_f32_32x32x16_bf16 v[48:63], v[220:223], v[136:139], v[48:63]
    ds_read_b64_tr_b16 v[216:217], v234 offset:45056
    ds_read_b64_tr_b16 v[218:219], v234 offset:47104
    v_add_f32 v242, v242, v161
    v_add_f32 v241, v241, v162
    v_add_f32 v242, v242, v163
    v_add_f32 v241, v241, v164
    v_add_f32 v242, v242, v165
    s_waitcnt lgkmcnt(12)
    v_mfma_f32_32x32x16_bf16 v[0:15], v[192:195], v[144:147], v[0:15]
    ds_read_b64_tr_b16 v[220:221], v235 offset:45056
    ds_read_b64_tr_b16 v[222:223], v235 offset:47104
    v_add_f32 v241, v241, v166
    v_add_f32 v242, v242, v167
    v_cvt_pk_bf16_f32 v160, v160, v161
    v_cvt_pk_bf16_f32 v161, v162, v163
    v_cvt_pk_bf16_f32 v162, v164, v165
    s_waitcnt lgkmcnt(12)
    v_mfma_f32_32x32x16_bf16 v[16:31], v[196:199], v[144:147], v[16:31]
    ds_read_b128 v[192:195], v224 offset:0
    v_cvt_pk_bf16_f32 v163, v166, v167
    v_fma_f32 v168, v168, s73, -v240
    v_fma_f32 v169, v169, s73, -v240
    v_fma_f32 v170, v170, s73, -v240
    v_fma_f32 v171, v171, s73, -v240
    s_waitcnt lgkmcnt(11)
    v_mfma_f32_32x32x16_bf16 v[32:47], v[200:203], v[144:147], v[32:47]
    ds_read_b128 v[196:199], v225 offset:0
    v_fma_f32 v172, v172, s73, -v240
    v_fma_f32 v173, v173, s73, -v240
    v_fma_f32 v174, v174, s73, -v240
    v_fma_f32 v175, v175, s73, -v240
    v_exp_f32 v168, v168
    s_waitcnt lgkmcnt(10)
    v_mfma_f32_32x32x16_bf16 v[48:63], v[204:207], v[144:147], v[48:63]
    ds_read_b128 v[200:203], v226 offset:0
    v_exp_f32 v169, v169
    v_exp_f32 v170, v170
    v_exp_f32 v171, v171
    v_exp_f32 v172, v172
    v_exp_f32 v173, v173
    s_waitcnt lgkmcnt(9)
    v_mfma_f32_32x32x16_bf16 v[0:15], v[208:211], v[152:155], v[0:15]
    ds_read_b128 v[204:207], v227 offset:0
    v_exp_f32 v174, v174
    v_exp_f32 v175, v175
    v_add_f32 v241, v241, v168
    v_add_f32 v242, v242, v169
    v_add_f32 v241, v241, v170
    s_waitcnt lgkmcnt(8)
    v_mfma_f32_32x32x16_bf16 v[16:31], v[212:215], v[152:155], v[16:31]
    ds_read_b128 v[208:211], v228 offset:0
    v_add_f32 v242, v242, v171
    v_add_f32 v241, v241, v172
    v_add_f32 v242, v242, v173
    v_add_f32 v241, v241, v174
    v_add_f32 v242, v242, v175
    s_waitcnt lgkmcnt(7)
    v_mfma_f32_32x32x16_bf16 v[32:47], v[216:219], v[152:155], v[32:47]
    ds_read_b128 v[212:215], v229 offset:0
    v_cvt_pk_bf16_f32 v168, v168, v169
    v_cvt_pk_bf16_f32 v169, v170, v171
    v_cvt_pk_bf16_f32 v170, v172, v173
    v_cvt_pk_bf16_f32 v171, v174, v175
    v_fma_f32 v176, v176, s73, -v240
    s_waitcnt lgkmcnt(6)
    v_mfma_f32_32x32x16_bf16 v[48:63], v[220:223], v[152:155], v[48:63]
    ds_read_b128 v[216:219], v230 offset:0
    s_cmp_lg_u32 s72, 0
    s_cbranch_scc1 L_rare2_11
L_back2_11:
    v_fma_f32 v177, v177, s73, -v240
    v_fma_f32 v178, v178, s73, -v240
    v_fma_f32 v179, v179, s73, -v240
    v_fma_f32 v180, v180, s73, -v240
    v_fma_f32 v181, v181, s73, -v240
    s_waitcnt lgkmcnt(6)
    v_mfma_f32_32x32x16_bf16 v[128:143], v[192:195], v[96:99], 0
    ds_read_b128 v[220:223], v231 offset:0
    v_fma_f32 v182, v182, s73, -v240
    v_fma_f32 v183, v183, s73, -v240
    v_exp_f32 v176, v176
    v_exp_f32 v177, v177
    v_exp_f32 v178, v178
    s_waitcnt lgkmcnt(6)
    v_mfma_f32_32x32x16_bf16 v[128:143], v[196:199], v[100:103], v[128:143]
    ds_read_b128 v[192:195], v224 offset:8192
    v_exp_f32 v179, v179
    v_exp_f32 v180, v180
    v_exp_f32 v181, v181
    v_exp_f32 v182, v182
    v_exp_f32 v183, v183
    s_waitcnt lgkmcnt(6)
    v_mfma_f32_32x32x16_bf16 v[128:143], v[200:203], v[104:107], v[128:143]
    ds_read_b128 v[196:199], v225 offset:8192
    v_add_f32 v241, v241, v176
    v_add_f32 v242, v242, v177
    v_add_f32 v241, v241, v178
    v_add_f32 v242, v242, v179
    v_add_f32 v241, v241, v180
    s_waitcnt lgkmcnt(6)
    v_mfma_f32_32x32x16_bf16 v[128:143], v[204:207], v[108:111], v[128:143]
    ds_read_b128 v[200:203], v226 offset:8192
    v_add_f32 v242, v242, v181
    v_add_f32 v241, v241, v182
    v_add_f32 v242, v242, v183
    v_cvt_pk_bf16_f32 v176, v176, v177
    v_cvt_pk_bf16_f32 v177, v178, v179
    s_waitcnt lgkmcnt(6)
    v_mfma_f32_32x32x16_bf16 v[128:143], v[208:211], v[112:115], v[128:143]
    ds_read_b128 v[204:207], v227 offset:8192
    v_cvt_pk_bf16_f32 v178, v180, v181
    v_cvt_pk_bf16_f32 v179, v182, v183
    v_fma_f32 v184, v184, s73, -v240
    v_fma_f32 v185, v185, s73, -v240
    v_fma_f32 v186, v186, s73, -v240
    s_waitcnt lgkmcnt(6)
    v_mfma_f32_32x32x16_bf16 v[128:143], v[212:215], v[116:119], v[128:143]
    ds_read_b128 v[208:211], v228 offset:8192
    v_fma_f32 v187, v187, s73, -v240
    v_fma_f32 v188, v188, s73, -v240
    v_fma_f32 v189, v189, s73, -v240
    v_fma_f32 v190, v190, s73, -v240
    v_fma_f32 v191, v191, s73, -v240
    s_waitcnt lgkmcnt(6)
    v_mfma_f32_32x32x16_bf16 v[128:143], v[216:219], v[120:123], v[128:143]
    ds_read_b128 v[212:215], v229 offset:8192
    v_exp_f32 v184, v184
    v_exp_f32 v185, v185
    v_exp_f32 v186, v186
    v_exp_f32 v187, v187
    v_exp_f32 v188, v188
    s_waitcnt lgkmcnt(6)
    v_mfma_f32_32x32x16_bf16 v[128:143], v[220:223], v[124:127], v[128:143]
    ds_read_b128 v[216:219], v230 offset:8192
    v_exp_f32 v189, v189
    v_exp_f32 v190, v190
    v_exp_f32 v191, v191
    v_add_f32 v241, v241, v184
    v_add_f32 v242, v242, v185
    s_waitcnt lgkmcnt(6)
    v_mfma_f32_32x32x16_bf16 v[144:159], v[192:195], v[96:99], 0
    ds_read_b128 v[220:223], v231 offset:8192
    v_add_f32 v241, v241, v186
    v_add_f32 v242, v242, v187
    v_add_f32 v241, v241, v188
    v_add_f32 v242, v242, v189
    v_add_f32 v241, v241, v190
    s_waitcnt lgkmcnt(6)
    v_mfma_f32_32x32x16_bf16 v[144:159], v[196:199], v[100:103], v[144:159]
    s_waitcnt vmcnt(12) lgkmcnt(0)
    s_barrier
    s_add_u32 m0, s67, 98304
    s_add_u32 s71, s69, 229376
    buffer_load_dwordx4 v237, s[52:55], s71 offen sc1 nt lds
    s_add_u32 m0, s67, 106496
    s_add_u32 s71, s69, 237568
    buffer_load_dwordx4 v237, s[52:55], s71 offen sc1 nt lds
    s_add_u32 m0, s67, 0
    s_add_u32 s71, s77, 131072
    buffer_load_dwordx4 v247, s[88:91], s71 offen  lds
    s_add_u32 m0, s67, 8192
    s_add_u32 s71, s77, 163840
    buffer_load_dwordx4 v247, s[88:91], s71 offen  lds
    ds_read_b64_tr_b16 v[192:193], v232 offset:49152
    ds_read_b64_tr_b16 v[194:195], v232 offset:51200
    v_add_f32 v242, v242, v191
    v_cvt_pk_bf16_f32 v184, v184, v185
    v_cvt_pk_bf16_f32 v185, v186, v187
    v_cvt_pk_bf16_f32 v186, v188, v189
    v_cvt_pk_bf16_f32 v187, v190, v191
    v_mfma_f32_32x32x16_bf16 v[144:159], v[200:203], v[104:107], v[144:159]
    ds_read_b64_tr_b16 v[196:197], v233 offset:49152
    ds_read_b64_tr_b16 v[198:199], v233 offset:51200
    v_mfma_f32_32x32x16_bf16 v[144:159], v[204:207], v[108:111], v[144:159]
    ds_read_b64_tr_b16 v[200:201], v234 offset:49152
    ds_read_b64_tr_b16 v[202:203], v234 offset:51200
    v_mfma_f32_32x32x16_bf16 v[144:159], v[208:211], v[112:115], v[144:159]
    ds_read_b64_tr_b16 v[204:205], v235 offset:49152
    ds_read_b64_tr_b16 v[206:207], v235 offset:51200
    v_mfma_f32_32x32x16_bf16 v[144:159], v[212:215], v[116:119], v[144:159]
    ds_read_b64_tr_b16 v[208:209], v232 offset:53248
    ds_read_b64_tr_b16 v[210:211], v232 offset:55296
    v_mfma_f32_32x32x16_bf16 v[144:159], v[216:219], v[120:123], v[144:159]
    ds_read_b64_tr_b16 v[212:213], v233 offset:53248
    ds_read_b64_tr_b16 v[214:215], v233 offset:55296
    v_mfma_f32_32x32x16_bf16 v[144:159], v[220:223], v[124:127], v[144:159]
    ds_read_b64_tr_b16 v[216:217], v234 offset:53248
    ds_read_b64_tr_b16 v[218:219], v234 offset:55296
    v_max3_f32 v244, v128, v129, v130
    v_max3_f32 v244, v244, v131, v132
    v_max3_f32 v244, v244, v133, v134
    v_max3_f32 v244, v244, v135, v136
    v_max3_f32 v244, v244, v137, v138
    s_waitcnt lgkmcnt(12)
    v_mfma_f32_32x32x16_bf16 v[0:15], v[192:195], v[160:163], v[0:15]
    ds_read_b64_tr_b16 v[220:221], v235 offset:53248
    ds_read_b64_tr_b16 v[222:223], v235 offset:55296
    v_max3_f32 v244, v244, v139, v140
    v_max3_f32 v244, v244, v141, v142
    v_max3_f32 v245, v144, v145, v146
    v_max3_f32 v245, v245, v147, v148
    v_max3_f32 v245, v245, v149, v150
    s_waitcnt lgkmcnt(12)
    v_mfma_f32_32x32x16_bf16 v[16:31], v[196:199], v[160:163], v[16:31]
    ds_read_b64_tr_b16 v[192:193], v232 offset:57344
    ds_read_b64_tr_b16 v[194:195], v232 offset:59392
    v_max3_f32 v245, v245, v151, v152
    v_max3_f32 v245, v245, v153, v154
    v_max3_f32 v245, v245, v155, v156
    v_max3_f32 v245, v245, v157, v158
    v_max3_f32 v238, v244, v143, v159
    s_waitcnt lgkmcnt(12)
    v_mfma_f32_32x32x16_bf16 v[32:47], v[200:203], v[160:163], v[32:47]
    ds_read_b64_tr_b16 v[196:197], v233 offset:57344
    ds_read_b64_tr_b16 v[198:199], v233 offset:59392
    v_max_f32 v238, v238, v245
    v_mov_b32 v239, v238
    s_nop 1
    v_permlane32_swap_b32 v238, v239
    v_max_f32 v238, v238, v239
    v_fma_f32 v239, v238, s73, -v240
    s_waitcnt lgkmcnt(12)
    v_mfma_f32_32x32x16_bf16 v[48:63], v[204:207], v[160:163], v[48:63]
    ds_read_b64_tr_b16 v[200:201], v234 offset:57344
    ds_read_b64_tr_b16 v[202:203], v234 offset:59392
    v_cmp_lt_f32 vcc, s74, v239
    s_cbranch_vccnz L_rare1_12
L_back1_12:
    v_fma_f32 v128, v128, s73, -v240
    v_fma_f32 v129, v129, s73, -v240
    s_waitcnt lgkmcnt(12)
    v_mfma_f32_32x32x16_bf16 v[0:15], v[208:211], v[168:171], v[0:15]
    ds_read_b64_tr_b16 v[204:205], v235 offset:57344
    ds_read_b64_tr_b16 v[206:207], v235 offset:59392
    v_fma_f32 v130, v130, s73, -v240
    v_fma_f32 v131, v131, s73, -v240
    v_fma_f32 v132, v132, s73, -v240
    v_fma_f32 v133, v133, s73, -v240
    v_fma_f32 v134, v134, s73, -v240
    s_waitcnt lgkmcnt(12)
    v_mfma_f32_32x32x16_bf16 v[16:31], v[212:215], v[168:171], v[16:31]
    ds_read_b64_tr_b16 v[208:209], v232 offset:61440
    ds_read_b64_tr_b16 v[210:211], v232 offset:63488
    v_fma_f32 v135, v135, s73, -v240
    v_exp_f32 v128, v128
    v_exp_f32 v129, v129
    v_exp_f32 v130, v130
    v_exp_f32 v131, v131
    s_waitcnt lgkmcnt(12)
    v_mfma_f32_32x32x16_bf16 v[32:47], v[216:219], v[168:171], v[32:47]
    ds_read_b64_tr_b16 v[212:213], v233 offset:61440
    ds_read_b64_tr_b16 v[214:215], v233 offset:63488
    v_exp_f32 v132, v132
    v_exp_f32 v133, v133
    v_exp_f32 v134, v134
    v_exp_f32 v135, v135
    v_add_f32 v241, v241, v128
    s_waitcnt lgkmcnt(12)
    v_mfma_f32_32x32x16_bf16 v[48:63], v[220:223], v[168:171], v[48:63]
    ds_read_b64_tr_b16 v[216:217], v234 offset:61440
    ds_read_b64_tr_b16 v[218:219], v234 offset:63488
    v_add_f32 v242, v242, v129
    v_add_f32 v241, v241, v130
    v_add_f32 v242, v242, v131
    v_add_f32 v241, v241, v132
    v_add_f32 v242, v242, v133
    s_waitcnt lgkmcnt(12)
    v_mfma_f32_32x32x16_bf16 v[0:15], v[192:195], v[176:179], v[0:15]
    ds_read_b64_tr_b16 v[220:221], v235 offset:61440
    ds_read_b64_tr_b16 v[222:223], v235 offset:63488
    v_add_f32 v241, v241, v134
    v_add_f32 v242, v242, v135
    v_cvt_pk_bf16_f32 v128, v128, v129
    v_cvt_pk_bf16_f32 v129, v130, v131
    v_cvt_pk_bf16_f32 v130, v132, v133
    s_waitcnt lgkmcnt(12)
    v_mfma_f32_32x32x16_bf16 v[16:31], v[196:199], v[176:179], v[16:31]
    ds_read_b128 v[192:195], v224 offset:16384
    v_cvt_pk_bf16_f32 v131, v134, v135
    v_fma_f32 v136, v136, s73, -v240
    v_fma_f32 v137, v137, s73, -v240
    v_fma_f32 v138, v138, s73, -v240
    v_fma_f32 v139, v139, s73, -v240
    s_waitcnt lgkmcnt(11)
    v_mfma_f32_32x32x16_bf16 v[32:47], v[200:203], v[176:179], v[32:47]
    ds_read_b128 v[196:199], v225 offset:16384
    v_fma_f32 v140, v140, s73, -v240
    v_fma_f32 v141, v141, s73, -v240
    v_fma_f32 v142, v142, s73, -v240
    v_fma_f32 v143, v143, s73, -v240
    v_exp_f32 v136, v136
    s_waitcnt lgkmcnt(10)
    v_mfma_f32_32x32x16_bf16 v[48:63], v[204:207], v[176:179], v[48:63]
    ds_read_b128 v[200:203], v226 offset:16384
    v_exp_f32 v137, v137
    v_exp_f32 v138, v138
    v_exp_f32 v139, v139
    v_exp_f32 v140, v140
    v_exp_f32 v141, v141
    s_waitcnt lgkmcnt(9)
    v_mfma_f32_32x32x16_bf16 v[0:15], v[208:211], v[184:187], v[0:15]
    ds_read_b128 v[204:207], v227 offset:16384
    v_exp_f32 v142, v142
    v_exp_f32 v143, v143
    v_add_f32 v241, v241, v136
    v_add_f32 v242, v242, v137
    v_add_f32 v241, v241, v138
    s_waitcnt lgkmcnt(8)
    v_mfma_f32_32x32x16_bf16 v[16:31], v[212:215], v[184:187], v[16:31]
    ds_read_b128 v[208:211], v228 offset:16384
    v_add_f32 v242, v242, v139
    v_add_f32 v241, v241, v140
    v_add_f32 v242, v242, v141
    v_add_f32 v241, v241, v142
    v_add_f32 v242, v242, v143
    s_waitcnt lgkmcnt(7)
    v_mfma_f32_32x32x16_bf16 v[32:47], v[216:219], v[184:187], v[32:47]
    ds_read_b128 v[212:215], v229 offset:16384
    v_cvt_pk_bf16_f32 v136, v136, v137
    v_cvt_pk_bf16_f32 v137, v138, v139
    v_cvt_pk_bf16_f32 v138, v140, v141
    v_cvt_pk_bf16_f32 v139, v142, v143
    v_fma_f32 v144, v144, s73, -v240
    s_waitcnt lgkmcnt(6)
    v_mfma_f32_32x32x16_bf16 v[48:63], v[220:223], v[184:187], v[48:63]
    ds_read_b128 v[216:219], v230 offset:16384
    s_cmp_lg_u32 s72, 0
    s_cbranch_scc1 L_rare2_12
L_back2_12:
    v_fma_f32 v145, v145, s73, -v240
    v_fma_f32 v146, v146, s73, -v240
    v_fma_f32 v147, v147, s73, -v240
    v_fma_f32 v148, v148, s73, -v240
    v_fma_f32 v149, v149, s73, -v240
    s_waitcnt lgkmcnt(6)
    v_mfma_f32_32x32x16_bf16 v[160:175], v[192:195], v[96:99], 0
    ds_read_b128 v[220:223], v231 offset:16384
    v_fma_f32 v150, v150, s73, -v240
    v_fma_f32 v151, v151, s73, -v240
    v_exp_f32 v144, v144
    v_exp_f32 v145, v145
    v_exp_f32 v146, v146
    s_waitcnt lgkmcnt(6)
    v_mfma_f32_32x32x16_bf16 v[160:175], v[196:199], v[100:103], v[160:175]
    ds_read_b128 v[192:195], v224 offset:24576
    v_exp_f32 v147, v147
    v_exp_f32 v148, v148
    v_exp_f32 v149, v149
    v_exp_f32 v150, v150
    v_exp_f32 v151, v151
    s_waitcnt lgkmcnt(6)
    v_mfma_f32_32x32x16_bf16 v[160:175], v[200:203], v[104:107], v[160:175]
    ds_read_b128 v[196:199], v225 offset:24576
    v_add_f32 v241, v241, v144
    v_add_f32 v242, v242, v145
    v_add_f32 v241, v241, v146
    v_add_f32 v242, v242, v147
    v_add_f32 v241, v241, v148
    s_waitcnt lgkmcnt(6)
    v_mfma_f32_32x32x16_bf16 v[160:175], v[204:207], v[108:111], v[160:175]
    ds_read_b128 v[200:203], v226 offset:24576
    v_add_f32 v242, v242, v149
    v_add_f32 v241, v241, v150
    v_add_f32 v242, v242, v151
    v_cvt_pk_bf16_f32 v144, v144, v145
    v_cvt_pk_bf16_f32 v145, v146, v147
    s_waitcnt lgkmcnt(6)
    v_mfma_f32_32x32x16_bf16 v[160:175], v[208:211], v[112:115], v[160:175]
    ds_read_b128 v[204:207], v227 offset:24576
    v_cvt_pk_bf16_f32 v146, v148, v149
    v_cvt_pk_bf16_f32 v147, v150, v151
    v_fma_f32 v152, v152, s73, -v240
    v_fma_f32 v153, v153, s73, -v240
    v_fma_f32 v154, v154, s73, -v240
    s_waitcnt lgkmcnt(6)
    v_mfma_f32_32x32x16_bf16 v[160:175], v[212:215], v[116:119], v[160:175]
    ds_read_b128 v[208:211], v228 offset:24576
    v_fma_f32 v155, v155, s73, -v240
    v_fma_f32 v156, v156, s73, -v240
    v_fma_f32 v157, v157, s73, -v240
    v_fma_f32 v158, v158, s73, -v240
    v_fma_f32 v159, v159, s73, -v240
    s_waitcnt lgkmcnt(6)
    v_mfma_f32_32x32x16_bf16 v[160:175], v[216:219], v[120:123], v[160:175]
    ds_read_b128 v[212:215], v229 offset:24576
    v_exp_f32 v152, v152
    v_exp_f32 v153, v153
    v_exp_f32 v154, v154
    v_exp_f32 v155, v155
    v_exp_f32 v156, v156
    s_waitcnt lgkmcnt(6)
    v_mfma_f32_32x32x16_bf16 v[160:175], v[220:223], v[124:127], v[160:175]
    ds_read_b128 v[216:219], v230 offset:24576
    v_exp_f32 v157, v157
    v_exp_f32 v158, v158
    v_exp_f32 v159, v159
    v_add_f32 v241, v241, v152
    v_add_f32 v242, v242, v153
    s_waitcnt lgkmcnt(6)
    v_mfma_f32_32x32x16_bf16 v[176:191], v[192:195], v[96:99], 0
    ds_read_b128 v[220:223], v231 offset:24576
    v_add_f32 v241, v241, v154
    v_add_f32 v242, v242, v155
    v_add_f32 v241, v241, v156
    v_add_f32 v242, v242, v157
    v_add_f32 v241, v241, v158
    s_waitcnt lgkmcnt(6)
    v_mfma_f32_32x32x16_bf16 v[176:191], v[196:199], v[100:103], v[176:191]
    s_waitcnt vmcnt(10) lgkmcnt(0)
    s_barrier
    s_add_u32 m0, s67, 114688
    s_add_u32 s71, s69, 245760
    buffer_load_dwordx4 v237, s[52:55], s71 offen sc1 nt lds
    s_add_u32 m0, s67, 122880
    s_add_u32 s71, s69, 253952
    buffer_load_dwordx4 v237, s[52:55], s71 offen sc1 nt lds
    s_add_u32 m0, s67, 16384
    s_add_u32 s71, s77, 196608
    buffer_load_dwordx4 v247, s[88:91], s71 offen  lds
    s_add_u32 m0, s67, 24576
    s_add_u32 s71, s77, 229376
    buffer_load_dwordx4 v247, s[88:91], s71 offen  lds
    ds_read_b64_tr_b16 v[192:193], v232 offset:0
    ds_read_b64_tr_b16 v[194:195], v232 offset:2048
    v_add_f32 v242, v242, v159
    v_cvt_pk_bf16_f32 v152, v152, v153
    v_cvt_pk_bf16_f32 v153, v154, v155
    v_cvt_pk_bf16_f32 v154, v156, v157
    v_cvt_pk_bf16_f32 v155, v158, v159
    v_mfma_f32_32x32x16_bf16 v[176:191], v[200:203], v[104:107], v[176:191]
    ds_read_b64_tr_b16 v[196:197], v233 offset:0
    ds_read_b64_tr_b16 v[198:199], v233 offset:2048
    v_mfma_f32_32x32x16_bf16 v[176:191], v[204:207], v[108:111], v[176:191]
    ds_read_b64_tr_b16 v[200:201], v234 offset:0
    ds_read_b64_tr_b16 v[202:203], v234 offset:2048
    v_mfma_f32_32x32x16_bf16 v[176:191], v[208:211], v[112:115], v[176:191]
    ds_read_b64_tr_b16 v[204:205], v235 offset:0
    ds_read_b64_tr_b16 v[206:207], v235 offset:2048
    v_mfma_f32_32x32x16_bf16 v[176:191], v[212:215], v[116:119], v[176:191]
    ds_read_b64_tr_b16 v[208:209], v232 offset:4096
    ds_read_b64_tr_b16 v[210:211], v232 offset:6144
    v_mfma_f32_32x32x16_bf16 v[176:191], v[216:219], v[120:123], v[176:191]
    ds_read_b64_tr_b16 v[212:213], v233 offset:4096
    ds_read_b64_tr_b16 v[214:215], v233 offset:6144
    v_mfma_f32_32x32x16_bf16 v[176:191], v[220:223], v[124:127], v[176:191]
    ds_read_b64_tr_b16 v[216:217], v234 offset:4096
    ds_read_b64_tr_b16 v[218:219], v234 offset:6144
    v_max3_f32 v244, v160, v161, v162
    v_max3_f32 v244, v244, v163, v164
    v_max3_f32 v244, v244, v165, v166
    v_max3_f32 v244, v244, v167, v168
    v_max3_f32 v244, v244, v169, v170
    s_waitcnt lgkmcnt(12)
    v_mfma_f32_32x32x16_bf16 v[0:15], v[192:195], v[128:131], v[0:15]
    ds_read_b64_tr_b16 v[220:221], v235 offset:4096
    ds_read_b64_tr_b16 v[222:223], v235 offset:6144
    v_max3_f32 v244, v244, v171, v172
    v_max3_f32 v244, v244, v173, v174
    v_max3_f32 v245, v176, v177, v178
    v_max3_f32 v245, v245, v179, v180
    v_max3_f32 v245, v245, v181, v182
    s_waitcnt lgkmcnt(12)
    v_mfma_f32_32x32x16_bf16 v[16:31], v[196:199], v[128:131], v[16:31]
    ds_read_b64_tr_b16 v[192:193], v232 offset:8192
    ds_read_b64_tr_b16 v[194:195], v232 offset:10240
    v_max3_f32 v245, v245, v183, v184
    v_max3_f32 v245, v245, v185, v186
    v_max3_f32 v245, v245, v187, v188
    v_max3_f32 v245, v245, v189, v190
    v_max3_f32 v238, v244, v175, v191
    s_waitcnt lgkmcnt(12)
    v_mfma_f32_32x32x16_bf16 v[32:47], v[200:203], v[128:131], v[32:47]
    ds_read_b64_tr_b16 v[196:197], v233 offset:8192
    ds_read_b64_tr_b16 v[198:199], v233 offset:10240
    v_max_f32 v238, v238, v245
    v_mov_b32 v239, v238
    s_nop 1
    v_permlane32_swap_b32 v238, v239
    v_max_f32 v238, v238, v239
    v_fma_f32 v239, v238, s73, -v240
    s_waitcnt lgkmcnt(12)
    v_mfma_f32_32x32x16_bf16 v[48:63], v[204:207], v[128:131], v[48:63]
    ds_read_b64_tr_b16 v[200:201], v234 offset:8192
    ds_read_b64_tr_b16 v[202:203], v234 offset:10240
    v_cmp_lt_f32 vcc, s74, v239
    s_cbranch_vccnz L_rare1_13
L_back1_13:
    v_fma_f32 v160, v160, s73, -v240
    v_fma_f32 v161, v161, s73, -v240
    s_waitcnt lgkmcnt(12)
    v_mfma_f32_32x32x16_bf16 v[0:15], v[208:211], v[136:139], v[0:15]
    ds_read_b64_tr_b16 v[204:205], v235 offset:8192
    ds_read_b64_tr_b16 v[206:207], v235 offset:10240
    v_fma_f32 v162, v162, s73, -v240
    v_fma_f32 v163, v163, s73, -v240
    v_fma_f32 v164, v164, s73, -v240
    v_fma_f32 v165, v165, s73, -v240
    v_fma_f32 v166, v166, s73, -v240
    s_waitcnt lgkmcnt(12)
    v_mfma_f32_32x32x16_bf16 v[16:31], v[212:215], v[136:139], v[16:31]
    ds_read_b64_tr_b16 v[208:209], v232 offset:12288
    ds_read_b64_tr_b16 v[210:211], v232 offset:14336
    v_fma_f32 v167, v167, s73, -v240
    v_exp_f32 v160, v160
    v_exp_f32 v161, v161
    v_exp_f32 v162, v162
    v_exp_f32 v163, v163
    s_waitcnt lgkmcnt(12)
    v_mfma_f32_32x32x16_bf16 v[32:47], v[216:219], v[136:139], v[32:47]
    ds_read_b64_tr_b16 v[212:213], v233 offset:12288
    ds_read_b64_tr_b16 v[214:215], v233 offset:14336
    v_exp_f32 v164, v164
    v_exp_f32 v165, v165
    v_exp_f32 v166, v166
    v_exp_f32 v167, v167
    v_add_f32 v241, v241, v160
    s_waitcnt lgkmcnt(12)
    v_mfma_f32_32x32x16_bf16 v[48:63], v[220:223], v[136:139], v[48:63]
    ds_read_b64_tr_b16 v[216:217], v234 offset:12288
    ds_read_b64_tr_b16 v[218:219], v234 offset:14336
    v_add_f32 v242, v242, v161
    v_add_f32 v241, v241, v162
    v_add_f32 v242, v242, v163
    v_add_f32 v241, v241, v164
    v_add_f32 v242, v242, v165
    s_waitcnt lgkmcnt(12)
    v_mfma_f32_32x32x16_bf16 v[0:15], v[192:195], v[144:147], v[0:15]
    ds_read_b64_tr_b16 v[220:221], v235 offset:12288
    ds_read_b64_tr_b16 v[222:223], v235 offset:14336
    v_add_f32 v241, v241, v166
    v_add_f32 v242, v242, v167
    v_cvt_pk_bf16_f32 v160, v160, v161
    v_cvt_pk_bf16_f32 v161, v162, v163
    v_cvt_pk_bf16_f32 v162, v164, v165
    s_waitcnt lgkmcnt(12)
    v_mfma_f32_32x32x16_bf16 v[16:31], v[196:199], v[144:147], v[16:31]
    ds_read_b128 v[192:195], v224 offset:32768
    v_cvt_pk_bf16_f32 v163, v166, v167
    v_fma_f32 v168, v168, s73, -v240
    v_fma_f32 v169, v169, s73, -v240
    v_fma_f32 v170, v170, s73, -v240
    v_fma_f32 v171, v171, s73, -v240
    s_waitcnt lgkmcnt(11)
    v_mfma_f32_32x32x16_bf16 v[32:47], v[200:203], v[144:147], v[32:47]
    ds_read_b128 v[196:199], v225 offset:32768
    v_fma_f32 v172, v172, s73, -v240
    v_fma_f32 v173, v173, s73, -v240
    v_fma_f32 v174, v174, s73, -v240
    v_fma_f32 v175, v175, s73, -v240
    v_exp_f32 v168, v168
    s_waitcnt lgkmcnt(10)
    v_mfma_f32_32x32x16_bf16 v[48:63], v[204:207], v[144:147], v[48:63]
    ds_read_b128 v[200:203], v226 offset:32768
    v_exp_f32 v169, v169
    v_exp_f32 v170, v170
    v_exp_f32 v171, v171
    v_exp_f32 v172, v172
    v_exp_f32 v173, v173
    s_waitcnt lgkmcnt(9)
    v_mfma_f32_32x32x16_bf16 v[0:15], v[208:211], v[152:155], v[0:15]
    ds_read_b128 v[204:207], v227 offset:32768
    v_exp_f32 v174, v174
    v_exp_f32 v175, v175
    v_add_f32 v241, v241, v168
    v_add_f32 v242, v242, v169
    v_add_f32 v241, v241, v170
    s_waitcnt lgkmcnt(8)
    v_mfma_f32_32x32x16_bf16 v[16:31], v[212:215], v[152:155], v[16:31]
    ds_read_b128 v[208:211], v228 offset:32768
    v_add_f32 v242, v242, v171
    v_add_f32 v241, v241, v172
    v_add_f32 v242, v242, v173
    v_add_f32 v241, v241, v174
    v_add_f32 v242, v242, v175
    s_waitcnt lgkmcnt(7)
    v_mfma_f32_32x32x16_bf16 v[32:47], v[216:219], v[152:155], v[32:47]
    ds_read_b128 v[212:215], v229 offset:32768
    v_cvt_pk_bf16_f32 v168, v168, v169
    v_cvt_pk_bf16_f32 v169, v170, v171
    v_cvt_pk_bf16_f32 v170, v172, v173
    v_cvt_pk_bf16_f32 v171, v174, v175
    v_fma_f32 v176, v176, s73, -v240
    s_waitcnt lgkmcnt(6)
    v_mfma_f32_32x32x16_bf16 v[48:63], v[220:223], v[152:155], v[48:63]
    ds_read_b128 v[216:219], v230 offset:32768
    s_cmp_lg_u32 s72, 0
    s_cbranch_scc1 L_rare2_13
L_back2_13:
    v_fma_f32 v177, v177, s73, -v240
    v_fma_f32 v178, v178, s73, -v240
    v_fma_f32 v179, v179, s73, -v240
    v_fma_f32 v180, v180, s73, -v240
    v_fma_f32 v181, v181, s73, -v240
    s_waitcnt lgkmcnt(6)
    v_mfma_f32_32x32x16_bf16 v[128:143], v[192:195], v[96:99], 0
    ds_read_b128 v[220:223], v231 offset:32768
    v_fma_f32 v182, v182, s73, -v240
    v_fma_f32 v183, v183, s73, -v240
    v_exp_f32 v176, v176
    v_exp_f32 v177, v177
    v_exp_f32 v178, v178
    s_waitcnt lgkmcnt(6)
    v_mfma_f32_32x32x16_bf16 v[128:143], v[196:199], v[100:103], v[128:143]
    ds_read_b128 v[192:195], v224 offset:40960
    v_exp_f32 v179, v179
    v_exp_f32 v180, v180
    v_exp_f32 v181, v181
    v_exp_f32 v182, v182
    v_exp_f32 v183, v183
    s_waitcnt lgkmcnt(6)
    v_mfma_f32_32x32x16_bf16 v[128:143], v[200:203], v[104:107], v[128:143]
    ds_read_b128 v[196:199], v225 offset:40960
    v_add_f32 v241, v241, v176
    v_add_f32 v242, v242, v177
    v_add_f32 v241, v241, v178
    v_add_f32 v242, v242, v179
    v_add_f32 v241, v241, v180
    s_waitcnt lgkmcnt(6)
    v_mfma_f32_32x32x16_bf16 v[128:143], v[204:207], v[108:111], v[128:143]
    ds_read_b128 v[200:203], v226 offset:40960
    v_add_f32 v242, v242, v181
    v_add_f32 v241, v241, v182
    v_add_f32 v242, v242, v183
    v_cvt_pk_bf16_f32 v176, v176, v177
    v_cvt_pk_bf16_f32 v177, v178, v179
    s_waitcnt lgkmcnt(6)
    v_mfma_f32_32x32x16_bf16 v[128:143], v[208:211], v[112:115], v[128:143]
    ds_read_b128 v[204:207], v227 offset:40960
    v_cvt_pk_bf16_f32 v178, v180, v181
    v_cvt_pk_bf16_f32 v179, v182, v183
    v_fma_f32 v184, v184, s73, -v240
    v_fma_f32 v185, v185, s73, -v240
    v_fma_f32 v186, v186, s73, -v240
    s_waitcnt lgkmcnt(6)
    v_mfma_f32_32x32x16_bf16 v[128:143], v[212:215], v[116:119], v[128:143]
    ds_read_b128 v[208:211], v228 offset:40960
    v_fma_f32 v187, v187, s73, -v240
    v_fma_f32 v188, v188, s73, -v240
    v_fma_f32 v189, v189, s73, -v240
    v_fma_f32 v190, v190, s73, -v240
    v_fma_f32 v191, v191, s73, -v240
    s_waitcnt lgkmcnt(6)
    v_mfma_f32_32x32x16_bf16 v[128:143], v[216:219], v[120:123], v[128:143]
    ds_read_b128 v[212:215], v229 offset:40960
    v_exp_f32 v184, v184
    v_exp_f32 v185, v185
    v_exp_f32 v186, v186
    v_exp_f32 v187, v187
    v_exp_f32 v188, v188
    s_waitcnt lgkmcnt(6)
    v_mfma_f32_32x32x16_bf16 v[128:143], v[220:223], v[124:127], v[128:143]
    ds_read_b128 v[216:219], v230 offset:40960
    v_exp_f32 v189, v189
    v_exp_f32 v190, v190
    v_exp_f32 v191, v191
    v_add_f32 v241, v241, v184
    v_add_f32 v242, v242, v185
    s_waitcnt lgkmcnt(6)
    v_mfma_f32_32x32x16_bf16 v[144:159], v[192:195], v[96:99], 0
    ds_read_b128 v[220:223], v231 offset:40960
    v_add_f32 v241, v241, v186
    v_add_f32 v242, v242, v187
    v_add_f32 v241, v241, v188
    v_add_f32 v242, v242, v189
    v_add_f32 v241, v241, v190
    s_waitcnt lgkmcnt(6)
    v_mfma_f32_32x32x16_bf16 v[144:159], v[196:199], v[100:103], v[144:159]
    s_waitcnt vmcnt(8) lgkmcnt(0)
    s_barrier
    s_add_u32 m0, s67, 32768
    s_add_u32 s71, s77, 256
    buffer_load_dwordx4 v247, s[88:91], s71 offen  lds
    s_add_u32 m0, s67, 40960
    s_add_u32 s71, s77, 33024
    buffer_load_dwordx4 v247, s[88:91], s71 offen  lds
    s_add_u32 m0, s67, 65536
    s_add_u32 s71, s77, 131328
    buffer_load_dwordx4 v247, s[88:91], s71 offen  lds
    s_add_u32 m0, s67, 73728
    s_add_u32 s71, s77, 164096
    buffer_load_dwordx4 v247, s[88:91], s71 offen  lds
    ds_read_b64_tr_b16 v[192:193], v232 offset:16384
    ds_read_b64_tr_b16 v[194:195], v232 offset:18432
    v_add_f32 v242, v242, v191
    v_cvt_pk_bf16_f32 v184, v184, v185
    v_cvt_pk_bf16_f32 v185, v186, v187
    v_cvt_pk_bf16_f32 v186, v188, v189
    v_cvt_pk_bf16_f32 v187, v190, v191
    v_mfma_f32_32x32x16_bf16 v[144:159], v[200:203], v[104:107], v[144:159]
    ds_read_b64_tr_b16 v[196:197], v233 offset:16384
    ds_read_b64_tr_b16 v[198:199], v233 offset:18432
    v_mfma_f32_32x32x16_bf16 v[144:159], v[204:207], v[108:111], v[144:159]
    ds_read_b64_tr_b16 v[200:201], v234 offset:16384
    ds_read_b64_tr_b16 v[202:203], v234 offset:18432
    v_mfma_f32_32x32x16_bf16 v[144:159], v[208:211], v[112:115], v[144:159]
    ds_read_b64_tr_b16 v[204:205], v235 offset:16384
    ds_read_b64_tr_b16 v[206:207], v235 offset:18432
    v_mfma_f32_32x32x16_bf16 v[144:159], v[212:215], v[116:119], v[144:159]
    ds_read_b64_tr_b16 v[208:209], v232 offset:20480
    ds_read_b64_tr_b16 v[210:211], v232 offset:22528
    v_mfma_f32_32x32x16_bf16 v[144:159], v[216:219], v[120:123], v[144:159]
    ds_read_b64_tr_b16 v[212:213], v233 offset:20480
    ds_read_b64_tr_b16 v[214:215], v233 offset:22528
    v_mfma_f32_32x32x16_bf16 v[144:159], v[220:223], v[124:127], v[144:159]
    ds_read_b64_tr_b16 v[216:217], v234 offset:20480
    ds_read_b64_tr_b16 v[218:219], v234 offset:22528
    v_max3_f32 v244, v128, v129, v130
    v_max3_f32 v244, v244, v131, v132
    v_max3_f32 v244, v244, v133, v134
    v_max3_f32 v244, v244, v135, v136
    v_max3_f32 v244, v244, v137, v138
    s_waitcnt lgkmcnt(12)
    v_mfma_f32_32x32x16_bf16 v[0:15], v[192:195], v[160:163], v[0:15]
    ds_read_b64_tr_b16 v[220:221], v235 offset:20480
    ds_read_b64_tr_b16 v[222:223], v235 offset:22528
    v_max3_f32 v244, v244, v139, v140
    v_max3_f32 v244, v244, v141, v142
    v_max3_f32 v245, v144, v145, v146
    v_max3_f32 v245, v245, v147, v148
    v_max3_f32 v245, v245, v149, v150
    s_waitcnt lgkmcnt(12)
    v_mfma_f32_32x32x16_bf16 v[16:31], v[196:199], v[160:163], v[16:31]
    ds_read_b64_tr_b16 v[192:193], v232 offset:24576
    ds_read_b64_tr_b16 v[194:195], v232 offset:26624
    v_max3_f32 v245, v245, v151, v152
    v_max3_f32 v245, v245, v153, v154
    v_max3_f32 v245, v245, v155, v156
    v_max3_f32 v245, v245, v157, v158
    v_max3_f32 v238, v244, v143, v159
    s_waitcnt lgkmcnt(12)
    v_mfma_f32_32x32x16_bf16 v[32:47], v[200:203], v[160:163], v[32:47]
    ds_read_b64_tr_b16 v[196:197], v233 offset:24576
    ds_read_b64_tr_b16 v[198:199], v233 offset:26624
    v_max_f32 v238, v238, v245
    v_mov_b32 v239, v238
    s_nop 1
    v_permlane32_swap_b32 v238, v239
    v_max_f32 v238, v238, v239
    v_fma_f32 v239, v238, s73, -v240
    s_waitcnt lgkmcnt(12)
    v_mfma_f32_32x32x16_bf16 v[48:63], v[204:207], v[160:163], v[48:63]
    ds_read_b64_tr_b16 v[200:201], v234 offset:24576
    ds_read_b64_tr_b16 v[202:203], v234 offset:26624
    v_cmp_lt_f32 vcc, s74, v239
    s_cbranch_vccnz L_rare1_14
L_back1_14:
    v_fma_f32 v128, v128, s73, -v240
    v_fma_f32 v129, v129, s73, -v240
    s_waitcnt lgkmcnt(12)
    v_mfma_f32_32x32x16_bf16 v[0:15], v[208:211], v[168:171], v[0:15]
    ds_read_b64_tr_b16 v[204:205], v235 offset:24576
    ds_read_b64_tr_b16 v[206:207], v235 offset:26624
    v_fma_f32 v130, v130, s73, -v240
    v_fma_f32 v131, v131, s73, -v240
    v_fma_f32 v132, v132, s73, -v240
    v_fma_f32 v133, v133, s73, -v240
    v_fma_f32 v134, v134, s73, -v240
    s_waitcnt lgkmcnt(12)
    v_mfma_f32_32x32x16_bf16 v[16:31], v[212:215], v[168:171], v[16:31]
    ds_read_b64_tr_b16 v[208:209], v232 offset:28672
    ds_read_b64_tr_b16 v[210:211], v232 offset:30720
    v_fma_f32 v135, v135, s73, -v240
    v_exp_f32 v128, v128
    v_exp_f32 v129, v129
    v_exp_f32 v130, v130
    v_exp_f32 v131, v131
    s_waitcnt lgkmcnt(12)
    v_mfma_f32_32x32x16_bf16 v[32:47], v[216:219], v[168:171], v[32:47]
    ds_read_b64_tr_b16 v[212:213], v233 offset:28672
    ds_read_b64_tr_b16 v[214:215], v233 offset:30720
    v_exp_f32 v132, v132
    v_exp_f32 v133, v133
    v_exp_f32 v134, v134
    v_exp_f32 v135, v135
    v_add_f32 v241, v241, v128
    s_waitcnt lgkmcnt(12)
    v_mfma_f32_32x32x16_bf16 v[48:63], v[220:223], v[168:171], v[48:63]
    ds_read_b64_tr_b16 v[216:217], v234 offset:28672
    ds_read_b64_tr_b16 v[218:219], v234 offset:30720
    v_add_f32 v242, v242, v129
    v_add_f32 v241, v241, v130
    v_add_f32 v242, v242, v131
    v_add_f32 v241, v241, v132
    v_add_f32 v242, v242, v133
    s_waitcnt lgkmcnt(12)
    v_mfma_f32_32x32x16_bf16 v[0:15], v[192:195], v[176:179], v[0:15]
    ds_read_b64_tr_b16 v[220:221], v235 offset:28672
    ds_read_b64_tr_b16 v[222:223], v235 offset:30720
    v_add_f32 v241, v241, v134
    v_add_f32 v242, v242, v135
    v_cvt_pk_bf16_f32 v128, v128, v129
    v_cvt_pk_bf16_f32 v129, v130, v131
    v_cvt_pk_bf16_f32 v130, v132, v133
    s_waitcnt lgkmcnt(12)
    v_mfma_f32_32x32x16_bf16 v[16:31], v[196:199], v[176:179], v[16:31]
    ds_read_b128 v[192:195], v224 offset:49152
    v_cvt_pk_bf16_f32 v131, v134, v135
    v_fma_f32 v136, v136, s73, -v240
    v_fma_f32 v137, v137, s73, -v240
    v_fma_f32 v138, v138, s73, -v240
    v_fma_f32 v139, v139, s73, -v240
    s_waitcnt lgkmcnt(11)
    v_mfma_f32_32x32x16_bf16 v[32:47], v[200:203], v[176:179], v[32:47]
    ds_read_b128 v[196:199], v225 offset:49152
    v_fma_f32 v140, v140, s73, -v240
    v_fma_f32 v141, v141, s73, -v240
    v_fma_f32 v142, v142, s73, -v240
    v_fma_f32 v143, v143, s73, -v240
    v_exp_f32 v136, v136
    s_waitcnt lgkmcnt(10)
    v_mfma_f32_32x32x16_bf16 v[48:63], v[204:207], v[176:179], v[48:63]
    ds_read_b128 v[200:203], v226 offset:49152
    v_exp_f32 v137, v137
    v_exp_f32 v138, v138
    v_exp_f32 v139, v139
    v_exp_f32 v140, v140
    v_exp_f32 v141, v141
    s_waitcnt lgkmcnt(9)
    v_mfma_f32_32x32x16_bf16 v[0:15], v[208:211], v[184:187], v[0:15]
    ds_read_b128 v[204:207], v227 offset:49152
    v_exp_f32 v142, v142
    v_exp_f32 v143, v143
    v_add_f32 v241, v241, v136
    v_add_f32 v242, v242, v137
    v_add_f32 v241, v241, v138
    s_waitcnt lgkmcnt(8)
    v_mfma_f32_32x32x16_bf16 v[16:31], v[212:215], v[184:187], v[16:31]
    ds_read_b128 v[208:211], v228 offset:49152
    v_add_f32 v242, v242, v139
    v_add_f32 v241, v241, v140
    v_add_f32 v242, v242, v141
    v_add_f32 v241, v241, v142
    v_add_f32 v242, v242, v143
    s_waitcnt lgkmcnt(7)
    v_mfma_f32_32x32x16_bf16 v[32:47], v[216:219], v[184:187], v[32:47]
    ds_read_b128 v[212:215], v229 offset:49152
    v_cvt_pk_bf16_f32 v136, v136, v137
    v_cvt_pk_bf16_f32 v137, v138, v139
    v_cvt_pk_bf16_f32 v138, v140, v141
    v_cvt_pk_bf16_f32 v139, v142, v143
    v_fma_f32 v144, v144, s73, -v240
    s_waitcnt lgkmcnt(6)
    v_mfma_f32_32x32x16_bf16 v[48:63], v[220:223], v[184:187], v[48:63]
    ds_read_b128 v[216:219], v230 offset:49152
    s_cmp_lg_u32 s72, 0
    s_cbranch_scc1 L_rare2_14
L_back2_14:
    v_fma_f32 v145, v145, s73, -v240
    v_fma_f32 v146, v146, s73, -v240
    v_fma_f32 v147, v147, s73, -v240
    v_fma_f32 v148, v148, s73, -v240
    v_fma_f32 v149, v149, s73, -v240
    s_waitcnt lgkmcnt(6)
    v_mfma_f32_32x32x16_bf16 v[160:175], v[192:195], v[96:99], 0
    ds_read_b128 v[220:223], v231 offset:49152
    v_fma_f32 v150, v150, s73, -v240
    v_fma_f32 v151, v151, s73, -v240
    v_exp_f32 v144, v144
    v_exp_f32 v145, v145
    v_exp_f32 v146, v146
    s_waitcnt lgkmcnt(6)
    v_mfma_f32_32x32x16_bf16 v[160:175], v[196:199], v[100:103], v[160:175]
    ds_read_b128 v[192:195], v224 offset:57344
    v_exp_f32 v147, v147
    v_exp_f32 v148, v148
    v_exp_f32 v149, v149
    v_exp_f32 v150, v150
    v_exp_f32 v151, v151
    s_waitcnt lgkmcnt(6)
    v_mfma_f32_32x32x16_bf16 v[160:175], v[200:203], v[104:107], v[160:175]
    ds_read_b128 v[196:199], v225 offset:57344
    v_add_f32 v241, v241, v144
    v_add_f32 v242, v242, v145
    v_add_f32 v241, v241, v146
    v_add_f32 v242, v242, v147
    v_add_f32 v241, v241, v148
    s_waitcnt lgkmcnt(6)
    v_mfma_f32_32x32x16_bf16 v[160:175], v[204:207], v[108:111], v[160:175]
    ds_read_b128 v[200:203], v226 offset:57344
    v_add_f32 v242, v242, v149
    v_add_f32 v241, v241, v150
    v_add_f32 v242, v242, v151
    v_cvt_pk_bf16_f32 v144, v144, v145
    v_cvt_pk_bf16_f32 v145, v146, v147
    s_waitcnt lgkmcnt(6)
    v_mfma_f32_32x32x16_bf16 v[160:175], v[208:211], v[112:115], v[160:175]
    ds_read_b128 v[204:207], v227 offset:57344
    v_cvt_pk_bf16_f32 v146, v148, v149
    v_cvt_pk_bf16_f32 v147, v150, v151
    v_fma_f32 v152, v152, s73, -v240
    v_fma_f32 v153, v153, s73, -v240
    v_fma_f32 v154, v154, s73, -v240
    s_waitcnt lgkmcnt(6)
    v_mfma_f32_32x32x16_bf16 v[160:175], v[212:215], v[116:119], v[160:175]
    ds_read_b128 v[208:211], v228 offset:57344
    v_fma_f32 v155, v155, s73, -v240
    v_fma_f32 v156, v156, s73, -v240
    v_fma_f32 v157, v157, s73, -v240
    v_fma_f32 v158, v158, s73, -v240
    v_fma_f32 v159, v159, s73, -v240
    s_waitcnt lgkmcnt(6)
    v_mfma_f32_32x32x16_bf16 v[160:175], v[216:219], v[120:123], v[160:175]
    ds_read_b128 v[212:215], v229 offset:57344
    v_exp_f32 v152, v152
    v_exp_f32 v153, v153
    v_exp_f32 v154, v154
    v_exp_f32 v155, v155
    v_exp_f32 v156, v156
    s_waitcnt lgkmcnt(6)
    v_mfma_f32_32x32x16_bf16 v[160:175], v[220:223], v[124:127], v[160:175]
    ds_read_b128 v[216:219], v230 offset:57344
    v_exp_f32 v157, v157
    v_exp_f32 v158, v158
    v_exp_f32 v159, v159
    v_add_f32 v241, v241, v152
    v_add_f32 v242, v242, v153
    s_waitcnt lgkmcnt(6)
    v_mfma_f32_32x32x16_bf16 v[176:191], v[192:195], v[96:99], 0
    ds_read_b128 v[220:223], v231 offset:57344
    v_add_f32 v241, v241, v154
    v_add_f32 v242, v242, v155
    v_add_f32 v241, v241, v156
    v_add_f32 v242, v242, v157
    v_add_f32 v241, v241, v158
    s_waitcnt lgkmcnt(6)
    v_mfma_f32_32x32x16_bf16 v[176:191], v[196:199], v[100:103], v[176:191]
    s_waitcnt vmcnt(10) lgkmcnt(0)
    s_barrier
    s_add_u32 m0, s67, 49152
    s_add_u32 s71, s77, 65792
    buffer_load_dwordx4 v247, s[88:91], s71 offen  lds
    s_add_u32 m0, s67, 57344
    s_add_u32 s71, s77, 98560
    buffer_load_dwordx4 v247, s[88:91], s71 offen  lds
    s_add_u32 m0, s67, 81920
    s_add_u32 s71, s77, 196864
    buffer_load_dwordx4 v247, s[88:91], s71 offen  lds
    s_add_u32 m0, s67, 90112
    s_add_u32 s71, s77, 229632
    buffer_load_dwordx4 v247, s[88:91], s71 offen  lds
    ds_read_b64_tr_b16 v[192:193], v232 offset:32768
    ds_read_b64_tr_b16 v[194:195], v232 offset:34816
    v_add_f32 v242, v242, v159
    v_cvt_pk_bf16_f32 v152, v152, v153
    v_cvt_pk_bf16_f32 v153, v154, v155
    v_cvt_pk_bf16_f32 v154, v156, v157
    v_cvt_pk_bf16_f32 v155, v158, v159
    v_mfma_f32_32x32x16_bf16 v[176:191], v[200:203], v[104:107], v[176:191]
    ds_read_b64_tr_b16 v[196:197], v233 offset:32768
    ds_read_b64_tr_b16 v[198:199], v233 offset:34816
    v_mfma_f32_32x32x16_bf16 v[176:191], v[204:207], v[108:111], v[176:191]
    ds_read_b64_tr_b16 v[200:201], v234 offset:32768
    ds_read_b64_tr_b16 v[202:203], v234 offset:34816
    v_mfma_f32_32x32x16_bf16 v[176:191], v[208:211], v[112:115], v[176:191]
    ds_read_b64_tr_b16 v[204:205], v235 offset:32768
    ds_read_b64_tr_b16 v[206:207], v235 offset:34816
    v_mfma_f32_32x32x16_bf16 v[176:191], v[212:215], v[116:119], v[176:191]
    ds_read_b64_tr_b16 v[208:209], v232 offset:36864
    ds_read_b64_tr_b16 v[210:211], v232 offset:38912
    v_mfma_f32_32x32x16_bf16 v[176:191], v[216:219], v[120:123], v[176:191]
    ds_read_b64_tr_b16 v[212:213], v233 offset:36864
    ds_read_b64_tr_b16 v[214:215], v233 offset:38912
    v_mfma_f32_32x32x16_bf16 v[176:191], v[220:223], v[124:127], v[176:191]
    ds_read_b64_tr_b16 v[216:217], v234 offset:36864
    ds_read_b64_tr_b16 v[218:219], v234 offset:38912
    v_max3_f32 v244, v160, v161, v162
    v_max3_f32 v244, v244, v163, v164
    v_max3_f32 v244, v244, v165, v166
    v_max3_f32 v244, v244, v167, v168
    v_max3_f32 v244, v244, v169, v170
    v_max3_f32 v244, v244, v171, v172
    v_max3_f32 v244, v244, v173, v174
    s_nop 2
    v_max3_f32 v245, v176, v177, v178
    v_max3_f32 v245, v245, v179, v180
    v_max3_f32 v245, v245, v181, v182
    s_waitcnt lgkmcnt(12)
    v_mfma_f32_32x32x16_bf16 v[0:15], v[192:195], v[128:131], v[0:15]
    ds_read_b64_tr_b16 v[220:221], v235 offset:36864
    ds_read_b64_tr_b16 v[222:223], v235 offset:38912
    v_max3_f32 v245, v245, v183, v184
    v_max3_f32 v245, v245, v185, v186
    v_max3_f32 v245, v245, v187, v188
    v_max3_f32 v245, v245, v189, v190
    v_max3_f32 v238, v244, v175, v191
    v_max_f32 v238, v238, v245
    v_mov_b32 v239, v238
    s_nop 1
    v_permlane32_swap_b32 v238, v239
    v_max_f32 v238, v238, v239
    v_fma_f32 v239, v238, s73, -v240
    s_waitcnt lgkmcnt(12)
    v_mfma_f32_32x32x16_bf16 v[16:31], v[196:199], v[128:131], v[16:31]
    ds_read_b64_tr_b16 v[192:193], v232 offset:40960
    ds_read_b64_tr_b16 v[194:195], v232 offset:43008
    v_cmp_lt_f32 vcc, s74, v239
    s_cbranch_vccnz L_rare1_15
L_back1_15:
    v_fma_f32 v160, v160, s73, -v240
    v_fma_f32 v161, v161, s73, -v240
    v_fma_f32 v162, v162, s73, -v240
    v_fma_f32 v163, v163, s73, -v240
    v_fma_f32 v164, v164, s73, -v240
    v_fma_f32 v165, v165, s73, -v240
    v_fma_f32 v166, v166, s73, -v240
    s_waitcnt lgkmcnt(12)
    v_mfma_f32_32x32x16_bf16 v[32:47], v[200:203], v[128:131], v[32:47]
    ds_read_b64_tr_b16 v[196:197], v233 offset:40960
    ds_read_b64_tr_b16 v[198:199], v233 offset:43008
    v_fma_f32 v167, v167, s73, -v240
    v_exp_f32 v160, v160
    v_exp_f32 v161, v161
    v_exp_f32 v162, v162
    v_exp_f32 v163, v163
    v_exp_f32 v164, v164
    v_exp_f32 v165, v165
    v_exp_f32 v166, v166
    v_exp_f32 v167, v167
    v_add_f32 v241, v241, v160
    s_waitcnt lgkmcnt(12)
    v_mfma_f32_32x32x16_bf16 v[48:63], v[204:207], v[128:131], v[48:63]
    ds_read_b64_tr_b16 v[200:201], v234 offset:40960
    ds_read_b64_tr_b16 v[202:203], v234 offset:43008
    v_add_f32 v242, v242, v161
    v_add_f32 v241, v241, v162
    v_add_f32 v242, v242, v163
    v_add_f32 v241, v241, v164
    v_add_f32 v242, v242, v165
    v_add_f32 v241, v241, v166
    v_add_f32 v242, v242, v167
    v_cvt_pk_bf16_f32 v160, v160, v161
    v_cvt_pk_bf16_f32 v161, v162, v163
    v_cvt_pk_bf16_f32 v162, v164, v165
    s_waitcnt lgkmcnt(12)
    v_mfma_f32_32x32x16_bf16 v[0:15], v[208:211], v[136:139], v[0:15]
    ds_read_b64_tr_b16 v[204:205], v235 offset:40960
    ds_read_b64_tr_b16 v[206:207], v235 offset:43008
    v_cvt_pk_bf16_f32 v163, v166, v167
    v_fma_f32 v168, v168, s73, -v240
    v_fma_f32 v169, v169, s73, -v240
    v_fma_f32 v170, v170, s73, -v240
    v_fma_f32 v171, v171, s73, -v240
    v_fma_f32 v172, v172, s73, -v240
    v_fma_f32 v173, v173, s73, -v240
    v_fma_f32 v174, v174, s73, -v240
    v_fma_f32 v175, v175, s73, -v240
    v_exp_f32 v168, v168
    s_waitcnt lgkmcnt(12)
    v_mfma_f32_32x32x16_bf16 v[16:31], v[212:215], v[136:139], v[16:31]
    ds_read_b64_tr_b16 v[208:209], v232 offset:45056
    ds_read_b64_tr_b16 v[210:211], v232 offset:47104
    v_exp_f32 v169, v169
    v_exp_f32 v170, v170
    v_exp_f32 v171, v171
    v_exp_f32 v172, v172
    v_exp_f32 v173, v173
    v_exp_f32 v174, v174
    v_exp_f32 v175, v175
    v_add_f32 v241, v241, v168
    v_add_f32 v242, v242, v169
    v_add_f32 v241, v241, v170
    s_waitcnt lgkmcnt(12)
    v_mfma_f32_32x32x16_bf16 v[32:47], v[216:219], v[136:139], v[32:47]
    ds_read_b64_tr_b16 v[212:213], v233 offset:45056
    ds_read_b64_tr_b16 v[214:215], v233 offset:47104
    v_add_f32 v242, v242, v171
    v_add_f32 v241, v241, v172
    v_add_f32 v242, v242, v173
    v_add_f32 v241, v241, v174
    v_add_f32 v242, v242, v175
    v_cvt_pk_bf16_f32 v168, v168, v169
    v_cvt_pk_bf16_f32 v169, v170, v171
    v_cvt_pk_bf16_f32 v170, v172, v173
    v_cvt_pk_bf16_f32 v171, v174, v175
    v_fma_f32 v176, v176, s73, -v240
    s_waitcnt lgkmcnt(12)
    v_mfma_f32_32x32x16_bf16 v[48:63], v[220:223], v[136:139], v[48:63]
    ds_read_b64_tr_b16 v[216:217], v234 offset:45056
    ds_read_b64_tr_b16 v[218:219], v234 offset:47104
    v_fma_f32 v177, v177, s73, -v240
    v_fma_f32 v178, v178, s73, -v240
    v_fma_f32 v179, v179, s73, -v240
    v_fma_f32 v180, v180, s73, -v240
    v_fma_f32 v181, v181, s73, -v240
    v_fma_f32 v182, v182, s73, -v240
    v_fma_f32 v183, v183, s73, -v240
    v_exp_f32 v176, v176
    v_exp_f32 v177, v177
    v_exp_f32 v178, v178
    s_waitcnt lgkmcnt(12)
    v_mfma_f32_32x32x16_bf16 v[0:15], v[192:195], v[144:147], v[0:15]
    ds_read_b64_tr_b16 v[220:221], v235 offset:45056
    ds_read_b64_tr_b16 v[222:223], v235 offset:47104
    v_exp_f32 v179, v179
    v_exp_f32 v180, v180
    v_exp_f32 v181, v181
    v_exp_f32 v182, v182
    v_exp_f32 v183, v183
    v_add_f32 v241, v241, v176
    v_add_f32 v242, v242, v177
    v_add_f32 v241, v241, v178
    v_add_f32 v242, v242, v179
    v_add_f32 v241, v241, v180
    s_waitcnt lgkmcnt(12)
    v_mfma_f32_32x32x16_bf16 v[16:31], v[196:199], v[144:147], v[16:31]
    s_waitcnt vmcnt(10) lgkmcnt(0)
    s_barrier
    s_add_u32 m0, s67, 98304
    s_add_u32 s71, s77, 512
    buffer_load_dwordx4 v247, s[88:91], s71 offen  lds
    s_add_u32 m0, s67, 106496
    s_add_u32 s71, s77, 33280
    buffer_load_dwordx4 v247, s[88:91], s71 offen  lds
    ds_read_b64_tr_b16 v[192:193], v232 offset:49152
    ds_read_b64_tr_b16 v[194:195], v232 offset:51200
    v_add_f32 v242, v242, v181
    v_add_f32 v241, v241, v182
    v_add_f32 v242, v242, v183
    v_cvt_pk_bf16_f32 v176, v176, v177
    v_cvt_pk_bf16_f32 v177, v178, v179
    v_cvt_pk_bf16_f32 v178, v180, v181
    v_cvt_pk_bf16_f32 v179, v182, v183
    v_fma_f32 v184, v184, s73, -v240
    v_fma_f32 v185, v185, s73, -v240
    v_fma_f32 v186, v186, s73, -v240
    v_mfma_f32_32x32x16_bf16 v[32:47], v[200:203], v[144:147], v[32:47]
    ds_read_b64_tr_b16 v[196:197], v233 offset:49152
    ds_read_b64_tr_b16 v[198:199], v233 offset:51200
    v_fma_f32 v187, v187, s73, -v240
    v_fma_f32 v188, v188, s73, -v240
    v_fma_f32 v189, v189, s73, -v240
    v_fma_f32 v190, v190, s73, -v240
    v_fma_f32 v191, v191, s73, -v240
    v_exp_f32 v184, v184
    v_exp_f32 v185, v185
    v_exp_f32 v186, v186
    v_exp_f32 v187, v187
    v_exp_f32 v188, v188
    v_mfma_f32_32x32x16_bf16 v[48:63], v[204:207], v[144:147], v[48:63]
    ds_read_b64_tr_b16 v[200:201], v234 offset:49152
    ds_read_b64_tr_b16 v[202:203], v234 offset:51200
    v_exp_f32 v189, v189
    v_exp_f32 v190, v190
    v_exp_f32 v191, v191
    v_add_f32 v241, v241, v184
    v_add_f32 v242, v242, v185
    v_add_f32 v241, v241, v186
    v_add_f32 v242, v242, v187
    v_add_f32 v241, v241, v188
    v_add_f32 v242, v242, v189
    v_add_f32 v241, v241, v190
    v_mfma_f32_32x32x16_bf16 v[0:15], v[208:211], v[152:155], v[0:15]
    ds_read_b64_tr_b16 v[204:205], v235 offset:49152
    ds_read_b64_tr_b16 v[206:207], v235 offset:51200
    v_add_f32 v242, v242, v191
    v_cvt_pk_bf16_f32 v184, v184, v185
    v_cvt_pk_bf16_f32 v185, v186, v187
    v_cvt_pk_bf16_f32 v186, v188, v189
    v_cvt_pk_bf16_f32 v187, v190, v191
    v_add_f32 v250, v241, v242
    v_mov_b32 v251, v250
    s_nop 1
    v_permlane32_swap_b32 v250, v251
    v_add_f32 v250, v250, v251
    v_rcp_f32 v249, v250
    v_mfma_f32_32x32x16_bf16 v[16:31], v[212:215], v[152:155], v[16:31]
    ds_read_b64_tr_b16 v[208:209], v232 offset:53248
    ds_read_b64_tr_b16 v[210:211], v232 offset:55296
    v_lshrrev_b32 v252, 9, v246
    v_lshlrev_b32 v252, 10, v252
    v_add_u32 v228, v232, v252
    v_subrev_u32 v224, 0x10000, v228
    v_add_u32 v229, v233, v252
    v_subrev_u32 v225, 0x10000, v229
    v_add_u32 v230, v234, v252
    v_subrev_u32 v226, 0x10000, v230
    v_add_u32 v231, v235, v252
    v_subrev_u32 v227, 0x10000, v231
    v_mfma_f32_32x32x16_bf16 v[32:47], v[216:219], v[152:155], v[32:47]
    ds_read_b64_tr_b16 v[212:213], v233 offset:53248
    ds_read_b64_tr_b16 v[214:215], v233 offset:55296
    v_mov_b32 v236, 0x40000000
    v_cmp_gt_u32 vcc, 0x3c000, v248
    s_nop 1
    v_cndmask_b32 v248, v236, v246, vcc
    v_mfma_f32_32x32x16_bf16 v[48:63], v[220:223], v[152:155], v[48:63]
    s_cmp_lg_u32 s72, 0
    s_cbranch_scc1 L_rare2_15
L_back2_15:
    ds_read_b64_tr_b16 v[216:217], v234 offset:53248
    ds_read_b64_tr_b16 v[218:219], v234 offset:55296
    v_add_u32 v252, 0x10000, v228
    v_add_u32 v253, 0x10000, v229
    v_add_u32 v254, 0x10000, v230
    v_add_u32 v255, 0x10000, v231
    s_waitcnt lgkmcnt(12)
    v_mfma_f32_32x32x16_bf16 v[0:15], v[192:195], v[160:163], v[0:15]
    ds_read_b64_tr_b16 v[220:221], v235 offset:53248
    ds_read_b64_tr_b16 v[222:223], v235 offset:55296
    s_waitcnt lgkmcnt(12)
    v_mfma_f32_32x32x16_bf16 v[16:31], v[196:199], v[160:163], v[16:31]
    ds_read_b64_tr_b16 v[192:193], v232 offset:57344
    ds_read_b64_tr_b16 v[194:195], v232 offset:59392
    s_waitcnt lgkmcnt(12)
    v_mfma_f32_32x32x16_bf16 v[32:47], v[200:203], v[160:163], v[32:47]
    ds_read_b64_tr_b16 v[196:197], v233 offset:57344
    ds_read_b64_tr_b16 v[198:199], v233 offset:59392
    s_waitcnt lgkmcnt(12)
    v_mfma_f32_32x32x16_bf16 v[48:63], v[204:207], v[160:163], v[48:63]
    ds_read_b64_tr_b16 v[200:201], v234 offset:57344
    ds_read_b64_tr_b16 v[202:203], v234 offset:59392
    s_waitcnt lgkmcnt(12)
    v_mfma_f32_32x32x16_bf16 v[0:15], v[208:211], v[168:171], v[0:15]
    ds_read_b64_tr_b16 v[204:205], v235 offset:57344
    ds_read_b64_tr_b16 v[206:207], v235 offset:59392
    s_waitcnt lgkmcnt(12)
    v_mfma_f32_32x32x16_bf16 v[16:31], v[212:215], v[168:171], v[16:31]
    ds_read_b64_tr_b16 v[208:209], v232 offset:61440
    ds_read_b64_tr_b16 v[210:211], v232 offset:63488
    s_waitcnt lgkmcnt(12)
    v_mfma_f32_32x32x16_bf16 v[32:47], v[216:219], v[168:171], v[32:47]
    ds_read_b64_tr_b16 v[212:213], v233 offset:61440
    ds_read_b64_tr_b16 v[214:215], v233 offset:63488
    s_waitcnt lgkmcnt(12)
    v_mfma_f32_32x32x16_bf16 v[48:63], v[220:223], v[168:171], v[48:63]
    ds_read_b64_tr_b16 v[216:217], v234 offset:61440
    ds_read_b64_tr_b16 v[218:219], v234 offset:63488
    s_waitcnt lgkmcnt(12)
    v_mfma_f32_32x32x16_bf16 v[0:15], v[192:195], v[176:179], v[0:15]
    ds_read_b64_tr_b16 v[220:221], v235 offset:61440
    ds_read_b64_tr_b16 v[222:223], v235 offset:63488
    s_waitcnt lgkmcnt(12)
    v_mfma_f32_32x32x16_bf16 v[16:31], v[196:199], v[176:179], v[16:31]
    s_waitcnt lgkmcnt(0)
    s_barrier
    s_add_u32 m0, s67, 114688
    s_add_u32 s71, s77, 66048
    buffer_load_dwordx4 v247, s[88:91], s71 offen  lds
    s_add_u32 m0, s67, 122880
    s_add_u32 s71, s77, 98816
    buffer_load_dwordx4 v247, s[88:91], s71 offen  lds
    ds_read_b64_tr_b16 v[192:193], v252 offset:0
    ds_read_b64_tr_b16 v[194:195], v252 offset:1024
    v_mfma_f32_32x32x16_bf16 v[32:47], v[200:203], v[176:179], v[32:47]
    ds_read_b64_tr_b16 v[196:197], v253 offset:0
    ds_read_b64_tr_b16 v[198:199], v253 offset:1024
    v_mfma_f32_32x32x16_bf16 v[48:63], v[204:207], v[176:179], v[48:63]
    ds_read_b64_tr_b16 v[200:201], v254 offset:0
    ds_read_b64_tr_b16 v[202:203], v254 offset:1024
    v_mfma_f32_32x32x16_bf16 v[0:15], v[208:211], v[184:187], v[0:15]
    ds_read_b64_tr_b16 v[204:205], v255 offset:0
    ds_read_b64_tr_b16 v[206:207], v255 offset:1024
    v_mfma_f32_32x32x16_bf16 v[16:31], v[212:215], v[184:187], v[16:31]
    ds_read_b64_tr_b16 v[208:209], v252 offset:4096
    ds_read_b64_tr_b16 v[210:211], v252 offset:5120
    v_mfma_f32_32x32x16_bf16 v[32:47], v[216:219], v[184:187], v[32:47]
    ds_read_b64_tr_b16 v[212:213], v253 offset:4096
    ds_read_b64_tr_b16 v[214:215], v253 offset:5120
    v_mfma_f32_32x32x16_bf16 v[48:63], v[220:223], v[184:187], v[48:63]
    ds_read_b64_tr_b16 v[216:217], v254 offset:4096
    ds_read_b64_tr_b16 v[218:219], v254 offset:5120
    s_waitcnt lgkmcnt(12)
    v_mfma_f32_32x32x16_bf16 v[128:143], v[192:195], v[64:67], 0
    ds_read_b64_tr_b16 v[220:221], v255 offset:4096
    ds_read_b64_tr_b16 v[222:223], v255 offset:5120
    s_waitcnt lgkmcnt(12)
    v_mfma_f32_32x32x16_bf16 v[144:159], v[196:199], v[64:67], 0
    ds_read_b64_tr_b16 v[192:193], v252 offset:8192
    ds_read_b64_tr_b16 v[194:195], v252 offset:9216
    v_mul_f32 v0, v0, v249
    v_mul_f32 v1, v1, v249
    v_mul_f32 v2, v2, v249
    v_mul_f32 v3, v3, v249
    s_waitcnt lgkmcnt(12)
    v_mfma_f32_32x32x16_bf16 v[160:175], v[200:203], v[64:67], 0
    ds_read_b64_tr_b16 v[196:197], v253 offset:8192
    ds_read_b64_tr_b16 v[198:199], v253 offset:9216
    v_mul_f32 v4, v4, v249
    v_mul_f32 v5, v5, v249
    v_mul_f32 v6, v6, v249
    v_mul_f32 v7, v7, v249
    s_waitcnt lgkmcnt(12)
    v_mfma_f32_32x32x16_bf16 v[176:191], v[204:207], v[64:67], 0
    ds_read_b64_tr_b16 v[200:201], v254 offset:8192
    ds_read_b64_tr_b16 v[202:203], v254 offset:9216
    v_cvt_pk_bf16_f32 v96, v0, v1
    v_cvt_pk_bf16_f32 v97, v2, v3
    v_cvt_pk_bf16_f32 v98, v4, v5
    v_cvt_pk_bf16_f32 v99, v6, v7
    s_waitcnt lgkmcnt(12)
    v_mfma_f32_32x32x16_bf16 v[128:143], v[208:211], v[68:71], v[128:143]
    ds_read_b64_tr_b16 v[204:205], v255 offset:8192
    ds_read_b64_tr_b16 v[206:207], v255 offset:9216
    v_mul_f32 v8, v8, v249
    v_mul_f32 v9, v9, v249
    v_mul_f32 v10, v10, v249
    v_mul_f32 v11, v11, v249
    s_waitcnt lgkmcnt(12)
    v_mfma_f32_32x32x16_bf16 v[144:159], v[212:215], v[68:71], v[144:159]
    ds_read_b64_tr_b16 v[208:209], v252 offset:12288
    ds_read_b64_tr_b16 v[210:211], v252 offset:13312
    v_mul_f32 v12, v12, v249
    v_mul_f32 v13, v13, v249
    v_mul_f32 v14, v14, v249
    v_mul_f32 v15, v15, v249
    s_waitcnt lgkmcnt(12)
    v_mfma_f32_32x32x16_bf16 v[160:175], v[216:219], v[68:71], v[160:175]
    ds_read_b64_tr_b16 v[212:213], v253 offset:12288
    ds_read_b64_tr_b16 v[214:215], v253 offset:13312
    v_cvt_pk_bf16_f32 v100, v8, v9
    v_cvt_pk_bf16_f32 v101, v10, v11
    v_cvt_pk_bf16_f32 v102, v12, v13
    v_cvt_pk_bf16_f32 v103, v14, v15
    s_waitcnt lgkmcnt(12)
    v_mfma_f32_32x32x16_bf16 v[176:191], v[220:223], v[68:71], v[176:191]
    ds_read_b64_tr_b16 v[216:217], v254 offset:12288
    ds_read_b64_tr_b16 v[218:219], v254 offset:13312
    v_mul_f32 v16, v16, v249
    v_mul_f32 v17, v17, v249
    v_mul_f32 v18, v18, v249
    v_mul_f32 v19, v19, v249
    s_waitcnt lgkmcnt(12)
    v_mfma_f32_32x32x16_bf16 v[128:143], v[192:195], v[72:75], v[128:143]
    ds_read_b64_tr_b16 v[220:221], v255 offset:12288
    ds_read_b64_tr_b16 v[222:223], v255 offset:13312
    v_mul_f32 v20, v20, v249
    v_mul_f32 v21, v21, v249
    v_mul_f32 v22, v22, v249
    v_mul_f32 v23, v23, v249
    s_waitcnt lgkmcnt(12)
    v_mfma_f32_32x32x16_bf16 v[144:159], v[196:199], v[72:75], v[144:159]
    ds_read_b64_tr_b16 v[192:193], v252 offset:16384
    ds_read_b64_tr_b16 v[194:195], v252 offset:17408
    v_cvt_pk_bf16_f32 v104, v16, v17
    v_cvt_pk_bf16_f32 v105, v18, v19
    v_cvt_pk_bf16_f32 v106, v20, v21
    v_cvt_pk_bf16_f32 v107, v22, v23
    s_waitcnt lgkmcnt(12)
    v_mfma_f32_32x32x16_bf16 v[160:175], v[200:203], v[72:75], v[160:175]
    ds_read_b64_tr_b16 v[196:197], v253 offset:16384
    ds_read_b64_tr_b16 v[198:199], v253 offset:17408
    v_mul_f32 v24, v24, v249
    v_mul_f32 v25, v25, v249
    v_mul_f32 v26, v26, v249
    v_mul_f32 v27, v27, v249
    s_waitcnt lgkmcnt(12)
    v_mfma_f32_32x32x16_bf16 v[176:191], v[204:207], v[72:75], v[176:191]
    ds_read_b64_tr_b16 v[200:201], v254 offset:16384
    ds_read_b64_tr_b16 v[202:203], v254 offset:17408
    v_mul_f32 v28, v28, v249
    v_mul_f32 v29, v29, v249
    v_mul_f32 v30, v30, v249
    v_mul_f32 v31, v31, v249
    s_waitcnt lgkmcnt(12)
    v_mfma_f32_32x32x16_bf16 v[128:143], v[208:211], v[76:79], v[128:143]
    ds_read_b64_tr_b16 v[204:205], v255 offset:16384
    ds_read_b64_tr_b16 v[206:207], v255 offset:17408
    v_cvt_pk_bf16_f32 v108, v24, v25
    v_cvt_pk_bf16_f32 v109, v26, v27
    v_cvt_pk_bf16_f32 v110, v28, v29
    v_cvt_pk_bf16_f32 v111, v30, v31
    s_waitcnt lgkmcnt(12)
    v_mfma_f32_32x32x16_bf16 v[144:159], v[212:215], v[76:79], v[144:159]
    ds_read_b64_tr_b16 v[208:209], v252 offset:20480
    ds_read_b64_tr_b16 v[210:211], v252 offset:21504
    v_mul_f32 v32, v32, v249
    v_mul_f32 v33, v33, v249
    v_mul_f32 v34, v34, v249
    v_mul_f32 v35, v35, v249
    s_waitcnt lgkmcnt(12)
    v_mfma_f32_32x32x16_bf16 v[160:175], v[216:219], v[76:79], v[160:175]
    ds_read_b64_tr_b16 v[212:213], v253 offset:20480
    ds_read_b64_tr_b16 v[214:215], v253 offset:21504
    v_mul_f32 v36, v36, v249
    v_mul_f32 v37, v37, v249
    v_mul_f32 v38, v38, v249
    v_mul_f32 v39, v39, v249
    s_waitcnt lgkmcnt(12)
    v_mfma_f32_32x32x16_bf16 v[176:191], v[220:223], v[76:79], v[176:191]
    ds_read_b64_tr_b16 v[216:217], v254 offset:20480
    ds_read_b64_tr_b16 v[218:219], v254 offset:21504
    v_cvt_pk_bf16_f32 v112, v32, v33
    v_cvt_pk_bf16_f32 v113, v34, v35
    v_cvt_pk_bf16_f32 v114, v36, v37
    v_cvt_pk_bf16_f32 v115, v38, v39
    s_waitcnt lgkmcnt(12)
    v_mfma_f32_32x32x16_bf16 v[128:143], v[192:195], v[80:83], v[128:143]
    ds_read_b64_tr_b16 v[220:221], v255 offset:20480
    ds_read_b64_tr_b16 v[222:223], v255 offset:21504
    v_mul_f32 v40, v40, v249
    v_mul_f32 v41, v41, v249
    v_mul_f32 v42, v42, v249
    v_mul_f32 v43, v43, v249
    s_waitcnt lgkmcnt(12)
    v_mfma_f32_32x32x16_bf16 v[144:159], v[196:199], v[80:83], v[144:159]
    ds_read_b64_tr_b16 v[192:193], v252 offset:24576
    ds_read_b64_tr_b16 v[194:195], v252 offset:25600
    v_mul_f32 v44, v44, v249
    v_mul_f32 v45, v45, v249
    v_mul_f32 v46, v46, v249
    v_mul_f32 v47, v47, v249
    s_waitcnt lgkmcnt(12)
    v_mfma_f32_32x32x16_bf16 v[160:175], v[200:203], v[80:83], v[160:175]
    ds_read_b64_tr_b16 v[196:197], v253 offset:24576
    ds_read_b64_tr_b16 v[198:199], v253 offset:25600
    v_cvt_pk_bf16_f32 v116, v40, v41
    v_cvt_pk_bf16_f32 v117, v42, v43
    v_cvt_pk_bf16_f32 v118, v44, v45
    v_cvt_pk_bf16_f32 v119, v46, v47
    s_waitcnt lgkmcnt(12)
    v_mfma_f32_32x32x16_bf16 v[176:191], v[204:207], v[80:83], v[176:191]
    ds_read_b64_tr_b16 v[200:201], v254 offset:24576
    ds_read_b64_tr_b16 v[202:203], v254 offset:25600
    v_mul_f32 v48, v48, v249
    v_mul_f32 v49, v49, v249
    v_mul_f32 v50, v50, v249
    v_mul_f32 v51, v51, v249
    s_waitcnt lgkmcnt(12)
    v_mfma_f32_32x32x16_bf16 v[128:143], v[208:211], v[84:87], v[128:143]
    ds_read_b64_tr_b16 v[204:205], v255 offset:24576
    ds_read_b64_tr_b16 v[206:207], v255 offset:25600
    v_mul_f32 v52, v52, v249
    v_mul_f32 v53, v53, v249
    v_mul_f32 v54, v54, v249
    v_mul_f32 v55, v55, v249
    s_waitcnt lgkmcnt(12)
    v_mfma_f32_32x32x16_bf16 v[144:159], v[212:215], v[84:87], v[144:159]
    ds_read_b64_tr_b16 v[208:209], v252 offset:28672
    ds_read_b64_tr_b16 v[210:211], v252 offset:29696
    v_cvt_pk_bf16_f32 v120, v48, v49
    v_cvt_pk_bf16_f32 v121, v50, v51
    v_cvt_pk_bf16_f32 v122, v52, v53
    v_cvt_pk_bf16_f32 v123, v54, v55
    s_waitcnt lgkmcnt(12)
    v_mfma_f32_32x32x16_bf16 v[160:175], v[216:219], v[84:87], v[160:175]
    ds_read_b64_tr_b16 v[212:213], v253 offset:28672
    ds_read_b64_tr_b16 v[214:215], v253 offset:29696
    v_mul_f32 v56, v56, v249
    v_mul_f32 v57, v57, v249
    v_mul_f32 v58, v58, v249
    v_mul_f32 v59, v59, v249
    s_waitcnt lgkmcnt(12)
    v_mfma_f32_32x32x16_bf16 v[176:191], v[220:223], v[84:87], v[176:191]
    ds_read_b64_tr_b16 v[216:217], v254 offset:28672
    ds_read_b64_tr_b16 v[218:219], v254 offset:29696
    v_mul_f32 v60, v60, v249
    v_mul_f32 v61, v61, v249
    v_mul_f32 v62, v62, v249
    v_mul_f32 v63, v63, v249
    s_waitcnt lgkmcnt(12)
    v_mfma_f32_32x32x16_bf16 v[128:143], v[192:195], v[88:91], v[128:143]
    ds_read_b64_tr_b16 v[220:221], v255 offset:28672
    ds_read_b64_tr_b16 v[222:223], v255 offset:29696
    v_cvt_pk_bf16_f32 v124, v56, v57
    v_cvt_pk_bf16_f32 v125, v58, v59
    v_cvt_pk_bf16_f32 v126, v60, v61
    v_cvt_pk_bf16_f32 v127, v62, v63
    s_waitcnt lgkmcnt(12)
    v_mfma_f32_32x32x16_bf16 v[144:159], v[196:199], v[88:91], v[144:159]
    s_waitcnt vmcnt(12) lgkmcnt(0)
    s_barrier
    s_add_u32 m0, s67, 131072
    s_add_u32 s71, s77, 131584
    buffer_load_dwordx4 v247, s[88:91], s71 offen  lds
    s_add_u32 m0, s67, 139264
    s_add_u32 s71, s77, 164352
    buffer_load_dwordx4 v247, s[88:91], s71 offen  lds
    s_add_u32 m0, s67, 147456
    s_add_u32 s71, s77, 197120
    buffer_load_dwordx4 v247, s[88:91], s71 offen  lds
    s_add_u32 m0, s67, 155648
    s_add_u32 s71, s77, 229888
    buffer_load_dwordx4 v247, s[88:91], s71 offen  lds
    ds_read_b64_tr_b16 v[192:193], v224 offset:0
    ds_read_b64_tr_b16 v[194:195], v224 offset:1024
    v_mfma_f32_32x32x16_bf16 v[160:175], v[200:203], v[88:91], v[160:175]
    ds_read_b64_tr_b16 v[196:197], v225 offset:0
    ds_read_b64_tr_b16 v[198:199], v225 offset:1024
    v_mfma_f32_32x32x16_bf16 v[176:191], v[204:207], v[88:91], v[176:191]
    ds_read_b64_tr_b16 v[200:201], v226 offset:0
    ds_read_b64_tr_b16 v[202:203], v226 offset:1024
    v_mfma_f32_32x32x16_bf16 v[128:143], v[208:211], v[92:95], v[128:143]
    ds_read_b64_tr_b16 v[204:205], v227 offset:0
    ds_read_b64_tr_b16 v[206:207], v227 offset:1024
    v_mfma_f32_32x32x16_bf16 v[144:159], v[212:215], v[92:95], v[144:159]
    ds_read_b64_tr_b16 v[208:209], v224 offset:4096
    ds_read_b64_tr_b16 v[210:211], v224 offset:5120
    v_mfma_f32_32x32x16_bf16 v[160:175], v[216:219], v[92:95], v[160:175]
    ds_read_b64_tr_b16 v[212:213], v225 offset:4096
    ds_read_b64_tr_b16 v[214:215], v225 offset:5120
    v_mfma_f32_32x32x16_bf16 v[176:191], v[220:223], v[92:95], v[176:191]
    ds_read_b64_tr_b16 v[216:217], v226 offset:4096
    ds_read_b64_tr_b16 v[218:219], v226 offset:5120
    s_waitcnt lgkmcnt(12)
    v_mfma_f32_32x32x16_bf16 v[128:143], v[192:195], v[96:99], v[128:143]
    ds_read_b64_tr_b16 v[220:221], v227 offset:4096
    ds_read_b64_tr_b16 v[222:223], v227 offset:5120
    s_waitcnt lgkmcnt(12)
    v_mfma_f32_32x32x16_bf16 v[144:159], v[196:199], v[96:99], v[144:159]
    ds_read_b64_tr_b16 v[192:193], v224 offset:8192
    ds_read_b64_tr_b16 v[194:195], v224 offset:9216
    s_waitcnt lgkmcnt(12)
    v_mfma_f32_32x32x16_bf16 v[160:175], v[200:203], v[96:99], v[160:175]
    ds_read_b64_tr_b16 v[196:197], v225 offset:8192
    ds_read_b64_tr_b16 v[198:199], v225 offset:9216
    s_waitcnt lgkmcnt(12)
    v_mfma_f32_32x32x16_bf16 v[176:191], v[204:207], v[96:99], v[176:191]
    ds_read_b64_tr_b16 v[200:201], v226 offset:8192
    ds_read_b64_tr_b16 v[202:203], v226 offset:9216
    s_waitcnt lgkmcnt(12)
    v_mfma_f32_32x32x16_bf16 v[128:143], v[208:211], v[100:103], v[128:143]
    ds_read_b64_tr_b16 v[204:205], v227 offset:8192
    ds_read_b64_tr_b16 v[206:207], v227 offset:9216
    s_waitcnt lgkmcnt(12)
    v_mfma_f32_32x32x16_bf16 v[144:159], v[212:215], v[100:103], v[144:159]
    ds_read_b64_tr_b16 v[208:209], v224 offset:12288
    ds_read_b64_tr_b16 v[210:211], v224 offset:13312
    s_waitcnt lgkmcnt(12)
    v_mfma_f32_32x32x16_bf16 v[160:175], v[216:219], v[100:103], v[160:175]
    ds_read_b64_tr_b16 v[212:213], v225 offset:12288
    ds_read_b64_tr_b16 v[214:215], v225 offset:13312
    s_waitcnt lgkmcnt(12)
    v_mfma_f32_32x32x16_bf16 v[176:191], v[220:223], v[100:103], v[176:191]
    ds_read_b64_tr_b16 v[216:217], v226 offset:12288
    ds_read_b64_tr_b16 v[218:219], v226 offset:13312
    s_waitcnt lgkmcnt(12)
    v_mfma_f32_32x32x16_bf16 v[128:143], v[192:195], v[104:107], v[128:143]
    ds_read_b64_tr_b16 v[220:221], v227 offset:12288
    ds_read_b64_tr_b16 v[222:223], v227 offset:13312
    s_waitcnt lgkmcnt(12)
    v_mfma_f32_32x32x16_bf16 v[144:159], v[196:199], v[104:107], v[144:159]
    ds_read_b64_tr_b16 v[192:193], v224 offset:16384
    ds_read_b64_tr_b16 v[194:195], v224 offset:17408
    s_waitcnt lgkmcnt(12)
    v_mfma_f32_32x32x16_bf16 v[160:175], v[200:203], v[104:107], v[160:175]
    ds_read_b64_tr_b16 v[196:197], v225 offset:16384
    ds_read_b64_tr_b16 v[198:199], v225 offset:17408
    s_waitcnt lgkmcnt(12)
    v_mfma_f32_32x32x16_bf16 v[176:191], v[204:207], v[104:107], v[176:191]
    ds_read_b64_tr_b16 v[200:201], v226 offset:16384
    ds_read_b64_tr_b16 v[202:203], v226 offset:17408
    s_waitcnt lgkmcnt(12)
    v_mfma_f32_32x32x16_bf16 v[128:143], v[208:211], v[108:111], v[128:143]
    ds_read_b64_tr_b16 v[204:205], v227 offset:16384
    ds_read_b64_tr_b16 v[206:207], v227 offset:17408
    s_waitcnt lgkmcnt(12)
    v_mfma_f32_32x32x16_bf16 v[144:159], v[212:215], v[108:111], v[144:159]
    ds_read_b64_tr_b16 v[208:209], v224 offset:20480
    ds_read_b64_tr_b16 v[210:211], v224 offset:21504
    s_waitcnt lgkmcnt(12)
    v_mfma_f32_32x32x16_bf16 v[160:175], v[216:219], v[108:111], v[160:175]
    ds_read_b64_tr_b16 v[212:213], v225 offset:20480
    ds_read_b64_tr_b16 v[214:215], v225 offset:21504
    s_waitcnt lgkmcnt(12)
    v_mfma_f32_32x32x16_bf16 v[176:191], v[220:223], v[108:111], v[176:191]
    ds_read_b64_tr_b16 v[216:217], v226 offset:20480
    ds_read_b64_tr_b16 v[218:219], v226 offset:21504
    s_waitcnt lgkmcnt(12)
    v_mfma_f32_32x32x16_bf16 v[128:143], v[192:195], v[112:115], v[128:143]
    ds_read_b64_tr_b16 v[220:221], v227 offset:20480
    ds_read_b64_tr_b16 v[222:223], v227 offset:21504
    s_waitcnt lgkmcnt(12)
    v_mfma_f32_32x32x16_bf16 v[144:159], v[196:199], v[112:115], v[144:159]
    ds_read_b64_tr_b16 v[192:193], v224 offset:24576
    ds_read_b64_tr_b16 v[194:195], v224 offset:25600
    s_waitcnt lgkmcnt(12)
    v_mfma_f32_32x32x16_bf16 v[160:175], v[200:203], v[112:115], v[160:175]
    ds_read_b64_tr_b16 v[196:197], v225 offset:24576
    ds_read_b64_tr_b16 v[198:199], v225 offset:25600
    s_waitcnt lgkmcnt(12)
    v_mfma_f32_32x32x16_bf16 v[176:191], v[204:207], v[112:115], v[176:191]
    ds_read_b64_tr_b16 v[200:201], v226 offset:24576
    ds_read_b64_tr_b16 v[202:203], v226 offset:25600
    s_waitcnt lgkmcnt(12)
    v_mfma_f32_32x32x16_bf16 v[128:143], v[208:211], v[116:119], v[128:143]
    ds_read_b64_tr_b16 v[204:205], v227 offset:24576
    ds_read_b64_tr_b16 v[206:207], v227 offset:25600
    s_waitcnt lgkmcnt(12)
    v_mfma_f32_32x32x16_bf16 v[144:159], v[212:215], v[116:119], v[144:159]
    ds_read_b64_tr_b16 v[208:209], v224 offset:28672
    ds_read_b64_tr_b16 v[210:211], v224 offset:29696
    s_waitcnt lgkmcnt(12)
    v_mfma_f32_32x32x16_bf16 v[160:175], v[216:219], v[116:119], v[160:175]
    ds_read_b64_tr_b16 v[212:213], v225 offset:28672
    ds_read_b64_tr_b16 v[214:215], v225 offset:29696
    s_waitcnt lgkmcnt(12)
    v_mfma_f32_32x32x16_bf16 v[176:191], v[220:223], v[116:119], v[176:191]
    ds_read_b64_tr_b16 v[216:217], v226 offset:28672
    ds_read_b64_tr_b16 v[218:219], v226 offset:29696
    s_waitcnt lgkmcnt(12)
    v_mfma_f32_32x32x16_bf16 v[128:143], v[192:195], v[120:123], v[128:143]
    ds_read_b64_tr_b16 v[220:221], v227 offset:28672
    ds_read_b64_tr_b16 v[222:223], v227 offset:29696
    s_waitcnt lgkmcnt(12)
    v_mfma_f32_32x32x16_bf16 v[144:159], v[196:199], v[120:123], v[144:159]
    s_waitcnt vmcnt(10) lgkmcnt(0)
    s_barrier
    s_add_u32 m0, s67, 0
    s_add_u32 s71, s77, 768
    buffer_load_dwordx4 v247, s[88:91], s71 offen  lds
    s_add_u32 m0, s67, 8192
    s_add_u32 s71, s77, 33536
    buffer_load_dwordx4 v247, s[88:91], s71 offen  lds
    s_add_u32 m0, s67, 16384
    s_add_u32 s71, s77, 66304
    buffer_load_dwordx4 v247, s[88:91], s71 offen  lds
    s_add_u32 m0, s67, 24576
    s_add_u32 s71, s77, 99072
    buffer_load_dwordx4 v247, s[88:91], s71 offen  lds
    ds_read_b64_tr_b16 v[192:193], v224 offset:32768
    ds_read_b64_tr_b16 v[194:195], v224 offset:33792
    v_mfma_f32_32x32x16_bf16 v[160:175], v[200:203], v[120:123], v[160:175]
    ds_read_b64_tr_b16 v[196:197], v225 offset:32768
    ds_read_b64_tr_b16 v[198:199], v225 offset:33792
    v_mfma_f32_32x32x16_bf16 v[176:191], v[204:207], v[120:123], v[176:191]
    ds_read_b64_tr_b16 v[200:201], v226 offset:32768
    ds_read_b64_tr_b16 v[202:203], v226 offset:33792
    v_mfma_f32_32x32x16_bf16 v[128:143], v[208:211], v[124:127], v[128:143]
    ds_read_b64_tr_b16 v[204:205], v227 offset:32768
    ds_read_b64_tr_b16 v[206:207], v227 offset:33792
    v_mfma_f32_32x32x16_bf16 v[144:159], v[212:215], v[124:127], v[144:159]
    ds_read_b64_tr_b16 v[208:209], v224 offset:36864
    ds_read_b64_tr_b16 v[210:211], v224 offset:37888
    v_mfma_f32_32x32x16_bf16 v[160:175], v[216:219], v[124:127], v[160:175]
    ds_read_b64_tr_b16 v[212:213], v225 offset:36864
    ds_read_b64_tr_b16 v[214:215], v225 offset:37888
    v_mfma_f32_32x32x16_bf16 v[176:191], v[220:223], v[124:127], v[176:191]
    ds_read_b64_tr_b16 v[216:217], v226 offset:36864
    ds_read_b64_tr_b16 v[218:219], v226 offset:37888
    s_waitcnt lgkmcnt(12)
    v_mfma_f32_32x32x16_bf16 v[0:15], v[192:195], v[64:67], 0
    ds_read_b64_tr_b16 v[220:221], v227 offset:36864
    ds_read_b64_tr_b16 v[222:223], v227 offset:37888
    s_waitcnt lgkmcnt(12)
    v_mfma_f32_32x32x16_bf16 v[16:31], v[196:199], v[64:67], 0
    ds_read_b64_tr_b16 v[192:193], v224 offset:40960
    ds_read_b64_tr_b16 v[194:195], v224 offset:41984
    s_add_u32 s76, s75, 0
    v_cvt_pk_bf16_f32 v128, v128, v129
    v_cvt_pk_bf16_f32 v129, v130, v131
    s_waitcnt lgkmcnt(12)
    v_mfma_f32_32x32x16_bf16 v[32:47], v[200:203], v[64:67], 0
    ds_read_b64_tr_b16 v[196:197], v225 offset:40960
    ds_read_b64_tr_b16 v[198:199], v225 offset:41984
    v_cvt_pk_bf16_f32 v130, v132, v133
    v_cvt_pk_bf16_f32 v131, v134, v135
    buffer_store_dwordx4 v[128:131], v248, s[60:63], s76 offen offset:0 sc0 sc1
    s_waitcnt lgkmcnt(12)
    v_mfma_f32_32x32x16_bf16 v[48:63], v[204:207], v[64:67], 0
    ds_read_b64_tr_b16 v[200:201], v226 offset:40960
    ds_read_b64_tr_b16 v[202:203], v226 offset:41984
    v_cvt_pk_bf16_f32 v136, v136, v137
    v_cvt_pk_bf16_f32 v137, v138, v139
    v_cvt_pk_bf16_f32 v138, v140, v141
    s_waitcnt lgkmcnt(12)
    v_mfma_f32_32x32x16_bf16 v[0:15], v[208:211], v[68:71], v[0:15]
    ds_read_b64_tr_b16 v[204:205], v227 offset:40960
    ds_read_b64_tr_b16 v[206:207], v227 offset:41984
    v_cvt_pk_bf16_f32 v139, v142, v143
    buffer_store_dwordx4 v[136:139], v248, s[60:63], s76 offen offset:1024 sc0 sc1
    v_cvt_pk_bf16_f32 v144, v144, v145
    s_waitcnt lgkmcnt(12)
    v_mfma_f32_32x32x16_bf16 v[16:31], v[212:215], v[68:71], v[16:31]
    ds_read_b64_tr_b16 v[208:209], v224 offset:45056
    ds_read_b64_tr_b16 v[210:211], v224 offset:46080
    v_cvt_pk_bf16_f32 v145, v146, v147
    v_cvt_pk_bf16_f32 v146, v148, v149
    v_cvt_pk_bf16_f32 v147, v150, v151
    s_waitcnt lgkmcnt(12)
    v_mfma_f32_32x32x16_bf16 v[32:47], v[216:219], v[68:71], v[32:47]
    ds_read_b64_tr_b16 v[212:213], v225 offset:45056
    ds_read_b64_tr_b16 v[214:215], v225 offset:46080
    buffer_store_dwordx4 v[144:147], v248, s[60:63], s76 offen offset:2048 sc0 sc1
    v_cvt_pk_bf16_f32 v152, v152, v153
    v_cvt_pk_bf16_f32 v153, v154, v155
    s_waitcnt lgkmcnt(12)
    v_mfma_f32_32x32x16_bf16 v[48:63], v[220:223], v[68:71], v[48:63]
    ds_read_b64_tr_b16 v[216:217], v226 offset:45056
    ds_read_b64_tr_b16 v[218:219], v226 offset:46080
    v_cvt_pk_bf16_f32 v154, v156, v157
    v_cvt_pk_bf16_f32 v155, v158, v159
    buffer_store_dwordx4 v[152:155], v248, s[60:63], s76 offen offset:3072 sc0 sc1
    s_waitcnt lgkmcnt(12)
    v_mfma_f32_32x32x16_bf16 v[0:15], v[192:195], v[72:75], v[0:15]
    ds_read_b64_tr_b16 v[220:221], v227 offset:45056
    ds_read_b64_tr_b16 v[222:223], v227 offset:46080
    s_add_u32 s76, s75, 4096
    v_cvt_pk_bf16_f32 v160, v160, v161
    v_cvt_pk_bf16_f32 v161, v162, v163
    s_waitcnt lgkmcnt(12)
    v_mfma_f32_32x32x16_bf16 v[16:31], v[196:199], v[72:75], v[16:31]
    ds_read_b64_tr_b16 v[192:193], v224 offset:49152
    ds_read_b64_tr_b16 v[194:195], v224 offset:50176
    v_cvt_pk_bf16_f32 v162, v164, v165
    v_cvt_pk_bf16_f32 v163, v166, v167
    buffer_store_dwordx4 v[160:163], v248, s[60:63], s76 offen offset:0 sc0 sc1
    s_waitcnt lgkmcnt(12)
    v_mfma_f32_32x32x16_bf16 v[32:47], v[200:203], v[72:75], v[32:47]
    ds_read_b64_tr_b16 v[196:197], v225 offset:49152
    ds_read_b64_tr_b16 v[198:199], v225 offset:50176
    v_cvt_pk_bf16_f32 v168, v168, v169
    v_cvt_pk_bf16_f32 v169, v170, v171
    v_cvt_pk_bf16_f32 v170, v172, v173
    s_waitcnt lgkmcnt(12)
    v_mfma_f32_32x32x16_bf16 v[48:63], v[204:207], v[72:75], v[48:63]
    ds_read_b64_tr_b16 v[200:201], v226 offset:49152
    ds_read_b64_tr_b16 v[202:203], v226 offset:50176
    v_cvt_pk_bf16_f32 v171, v174, v175
    buffer_store_dwordx4 v[168:171], v248, s[60:63], s76 offen offset:1024 sc0 sc1
    v_cvt_pk_bf16_f32 v176, v176, v177
    s_waitcnt lgkmcnt(12)
    v_mfma_f32_32x32x16_bf16 v[0:15], v[208:211], v[76:79], v[0:15]
    ds_read_b64_tr_b16 v[204:205], v227 offset:49152
    ds_read_b64_tr_b16 v[206:207], v227 offset:50176
    v_cvt_pk_bf16_f32 v177, v178, v179
    v_cvt_pk_bf16_f32 v178, v180, v181
    v_cvt_pk_bf16_f32 v179, v182, v183
    s_waitcnt lgkmcnt(12)
    v_mfma_f32_32x32x16_bf16 v[16:31], v[212:215], v[76:79], v[16:31]
    ds_read_b64_tr_b16 v[208:209], v224 offset:53248
    ds_read_b64_tr_b16 v[210:211], v224 offset:54272
    buffer_store_dwordx4 v[176:179], v248, s[60:63], s76 offen offset:2048 sc0 sc1
    v_cvt_pk_bf16_f32 v184, v184, v185
    v_cvt_pk_bf16_f32 v185, v186, v187
    s_waitcnt lgkmcnt(12)
    v_mfma_f32_32x32x16_bf16 v[32:47], v[216:219], v[76:79], v[32:47]
    ds_read_b64_tr_b16 v[212:213], v225 offset:53248
    ds_read_b64_tr_b16 v[214:215], v225 offset:54272
    v_cvt_pk_bf16_f32 v186, v188, v189
    v_cvt_pk_bf16_f32 v187, v190, v191
    buffer_store_dwordx4 v[184:187], v248, s[60:63], s76 offen offset:3072 sc0 sc1
    s_waitcnt lgkmcnt(12)
    v_mfma_f32_32x32x16_bf16 v[48:63], v[220:223], v[76:79], v[48:63]
    ds_read_b64_tr_b16 v[216:217], v226 offset:53248
    ds_read_b64_tr_b16 v[218:219], v226 offset:54272
    s_waitcnt lgkmcnt(12)
    v_mfma_f32_32x32x16_bf16 v[0:15], v[192:195], v[80:83], v[0:15]
    ds_read_b64_tr_b16 v[220:221], v227 offset:53248
    ds_read_b64_tr_b16 v[222:223], v227 offset:54272
    s_waitcnt lgkmcnt(12)
    v_mfma_f32_32x32x16_bf16 v[16:31], v[196:199], v[80:83], v[16:31]
    ds_read_b64_tr_b16 v[192:193], v224 offset:57344
    ds_read_b64_tr_b16 v[194:195], v224 offset:58368
    s_waitcnt lgkmcnt(12)
    v_mfma_f32_32x32x16_bf16 v[32:47], v[200:203], v[80:83], v[32:47]
    ds_read_b64_tr_b16 v[196:197], v225 offset:57344
    ds_read_b64_tr_b16 v[198:199], v225 offset:58368
    s_waitcnt lgkmcnt(12)
    v_mfma_f32_32x32x16_bf16 v[48:63], v[204:207], v[80:83], v[48:63]
    ds_read_b64_tr_b16 v[200:201], v226 offset:57344
    ds_read_b64_tr_b16 v[202:203], v226 offset:58368
    s_waitcnt lgkmcnt(12)
    v_mfma_f32_32x32x16_bf16 v[0:15], v[208:211], v[84:87], v[0:15]
    ds_read_b64_tr_b16 v[204:205], v227 offset:57344
    ds_read_b64_tr_b16 v[206:207], v227 offset:58368
    s_waitcnt lgkmcnt(12)
    v_mfma_f32_32x32x16_bf16 v[16:31], v[212:215], v[84:87], v[16:31]
    ds_read_b64_tr_b16 v[208:209], v224 offset:61440
    ds_read_b64_tr_b16 v[210:211], v224 offset:62464
    s_waitcnt lgkmcnt(12)
    v_mfma_f32_32x32x16_bf16 v[32:47], v[216:219], v[84:87], v[32:47]
    ds_read_b64_tr_b16 v[212:213], v225 offset:61440
    ds_read_b64_tr_b16 v[214:215], v225 offset:62464
    s_waitcnt lgkmcnt(12)
    v_mfma_f32_32x32x16_bf16 v[48:63], v[220:223], v[84:87], v[48:63]
    ds_read_b64_tr_b16 v[216:217], v226 offset:61440
    ds_read_b64_tr_b16 v[218:219], v226 offset:62464
    s_waitcnt lgkmcnt(12)
    v_mfma_f32_32x32x16_bf16 v[0:15], v[192:195], v[88:91], v[0:15]
    ds_read_b64_tr_b16 v[220:221], v227 offset:61440
    ds_read_b64_tr_b16 v[222:223], v227 offset:62464
    s_waitcnt lgkmcnt(12)
    v_mfma_f32_32x32x16_bf16 v[16:31], v[196:199], v[88:91], v[16:31]
    s_waitcnt vmcnt(20) lgkmcnt(0)
    s_barrier
    s_add_u32 m0, s67, 32768
    s_add_u32 s71, s77, 131840
    buffer_load_dwordx4 v247, s[88:91], s71 offen  lds
    s_add_u32 m0, s67, 40960
    s_add_u32 s71, s77, 164608
    buffer_load_dwordx4 v247, s[88:91], s71 offen  lds
    s_add_u32 m0, s67, 49152
    s_add_u32 s71, s77, 197376
    buffer_load_dwordx4 v247, s[88:91], s71 offen  lds
    s_add_u32 m0, s67, 57344
    s_add_u32 s71, s77, 230144
    buffer_load_dwordx4 v247, s[88:91], s71 offen  lds
    ds_read_b64_tr_b16 v[192:193], v228 offset:0
    ds_read_b64_tr_b16 v[194:195], v228 offset:1024
    v_mfma_f32_32x32x16_bf16 v[32:47], v[200:203], v[88:91], v[32:47]
    ds_read_b64_tr_b16 v[196:197], v229 offset:0
    ds_read_b64_tr_b16 v[198:199], v229 offset:1024
    v_mfma_f32_32x32x16_bf16 v[48:63], v[204:207], v[88:91], v[48:63]
    ds_read_b64_tr_b16 v[200:201], v230 offset:0
    ds_read_b64_tr_b16 v[202:203], v230 offset:1024
    v_mfma_f32_32x32x16_bf16 v[0:15], v[208:211], v[92:95], v[0:15]
    ds_read_b64_tr_b16 v[204:205], v231 offset:0
    ds_read_b64_tr_b16 v[206:207], v231 offset:1024
    v_mfma_f32_32x32x16_bf16 v[16:31], v[212:215], v[92:95], v[16:31]
    ds_read_b64_tr_b16 v[208:209], v228 offset:4096
    ds_read_b64_tr_b16 v[210:211], v228 offset:5120
    v_mfma_f32_32x32x16_bf16 v[32:47], v[216:219], v[92:95], v[32:47]
    ds_read_b64_tr_b16 v[212:213], v229 offset:4096
    ds_read_b64_tr_b16 v[214:215], v229 offset:5120
    v_mfma_f32_32x32x16_bf16 v[48:63], v[220:223], v[92:95], v[48:63]
    ds_read_b64_tr_b16 v[216:217], v230 offset:4096
    ds_read_b64_tr_b16 v[218:219], v230 offset:5120
    s_waitcnt lgkmcnt(12)
    v_mfma_f32_32x32x16_bf16 v[0:15], v[192:195], v[96:99], v[0:15]
    ds_read_b64_tr_b16 v[220:221], v231 offset:4096
    ds_read_b64_tr_b16 v[222:223], v231 offset:5120
    s_waitcnt lgkmcnt(12)
    v_mfma_f32_32x32x16_bf16 v[16:31], v[196:199], v[96:99], v[16:31]
    ds_read_b64_tr_b16 v[192:193], v228 offset:8192
    ds_read_b64_tr_b16 v[194:195], v228 offset:9216
    s_waitcnt lgkmcnt(12)
    v_mfma_f32_32x32x16_bf16 v[32:47], v[200:203], v[96:99], v[32:47]
    ds_read_b64_tr_b16 v[196:197], v229 offset:8192
    ds_read_b64_tr_b16 v[198:199], v229 offset:9216
    s_waitcnt lgkmcnt(12)
    v_mfma_f32_32x32x16_bf16 v[48:63], v[204:207], v[96:99], v[48:63]
    ds_read_b64_tr_b16 v[200:201], v230 offset:8192
    ds_read_b64_tr_b16 v[202:203], v230 offset:9216
    s_waitcnt lgkmcnt(12)
    v_mfma_f32_32x32x16_bf16 v[0:15], v[208:211], v[100:103], v[0:15]
    ds_read_b64_tr_b16 v[204:205], v231 offset:8192
    ds_read_b64_tr_b16 v[206:207], v231 offset:9216
    s_waitcnt lgkmcnt(12)
    v_mfma_f32_32x32x16_bf16 v[16:31], v[212:215], v[100:103], v[16:31]
    ds_read_b64_tr_b16 v[208:209], v228 offset:12288
    ds_read_b64_tr_b16 v[210:211], v228 offset:13312
    s_waitcnt lgkmcnt(12)
    v_mfma_f32_32x32x16_bf16 v[32:47], v[216:219], v[100:103], v[32:47]
    ds_read_b64_tr_b16 v[212:213], v229 offset:12288
    ds_read_b64_tr_b16 v[214:215], v229 offset:13312
    s_waitcnt lgkmcnt(12)
    v_mfma_f32_32x32x16_bf16 v[48:63], v[220:223], v[100:103], v[48:63]
    ds_read_b64_tr_b16 v[216:217], v230 offset:12288
    ds_read_b64_tr_b16 v[218:219], v230 offset:13312
    s_waitcnt lgkmcnt(12)
    v_mfma_f32_32x32x16_bf16 v[0:15], v[192:195], v[104:107], v[0:15]
    ds_read_b64_tr_b16 v[220:221], v231 offset:12288
    ds_read_b64_tr_b16 v[222:223], v231 offset:13312
    s_waitcnt lgkmcnt(12)
    v_mfma_f32_32x32x16_bf16 v[16:31], v[196:199], v[104:107], v[16:31]
    ds_read_b64_tr_b16 v[192:193], v228 offset:16384
    ds_read_b64_tr_b16 v[194:195], v228 offset:17408
    s_waitcnt lgkmcnt(12)
    v_mfma_f32_32x32x16_bf16 v[32:47], v[200:203], v[104:107], v[32:47]
    ds_read_b64_tr_b16 v[196:197], v229 offset:16384
    ds_read_b64_tr_b16 v[198:199], v229 offset:17408
    s_waitcnt lgkmcnt(12)
    v_mfma_f32_32x32x16_bf16 v[48:63], v[204:207], v[104:107], v[48:63]
    ds_read_b64_tr_b16 v[200:201], v230 offset:16384
    ds_read_b64_tr_b16 v[202:203], v230 offset:17408
    s_waitcnt lgkmcnt(12)
    v_mfma_f32_32x32x16_bf16 v[0:15], v[208:211], v[108:111], v[0:15]
    ds_read_b64_tr_b16 v[204:205], v231 offset:16384
    ds_read_b64_tr_b16 v[206:207], v231 offset:17408
    s_waitcnt lgkmcnt(12)
    v_mfma_f32_32x32x16_bf16 v[16:31], v[212:215], v[108:111], v[16:31]
    ds_read_b64_tr_b16 v[208:209], v228 offset:20480
    ds_read_b64_tr_b16 v[210:211], v228 offset:21504
    s_waitcnt lgkmcnt(12)
    v_mfma_f32_32x32x16_bf16 v[32:47], v[216:219], v[108:111], v[32:47]
    ds_read_b64_tr_b16 v[212:213], v229 offset:20480
    ds_read_b64_tr_b16 v[214:215], v229 offset:21504
    s_waitcnt lgkmcnt(12)
    v_mfma_f32_32x32x16_bf16 v[48:63], v[220:223], v[108:111], v[48:63]
    ds_read_b64_tr_b16 v[216:217], v230 offset:20480
    ds_read_b64_tr_b16 v[218:219], v230 offset:21504
    s_waitcnt lgkmcnt(12)
    v_mfma_f32_32x32x16_bf16 v[0:15], v[192:195], v[112:115], v[0:15]
    ds_read_b64_tr_b16 v[220:221], v231 offset:20480
    ds_read_b64_tr_b16 v[222:223], v231 offset:21504
    s_waitcnt lgkmcnt(12)
    v_mfma_f32_32x32x16_bf16 v[16:31], v[196:199], v[112:115], v[16:31]
    ds_read_b64_tr_b16 v[192:193], v228 offset:24576
    ds_read_b64_tr_b16 v[194:195], v228 offset:25600
    s_waitcnt lgkmcnt(12)
    v_mfma_f32_32x32x16_bf16 v[32:47], v[200:203], v[112:115], v[32:47]
    ds_read_b64_tr_b16 v[196:197], v229 offset:24576
    ds_read_b64_tr_b16 v[198:199], v229 offset:25600
    s_waitcnt lgkmcnt(12)
    v_mfma_f32_32x32x16_bf16 v[48:63], v[204:207], v[112:115], v[48:63]
    ds_read_b64_tr_b16 v[200:201], v230 offset:24576
    ds_read_b64_tr_b16 v[202:203], v230 offset:25600
    s_waitcnt lgkmcnt(12)
    v_mfma_f32_32x32x16_bf16 v[0:15], v[208:211], v[116:119], v[0:15]
    ds_read_b64_tr_b16 v[204:205], v231 offset:24576
    ds_read_b64_tr_b16 v[206:207], v231 offset:25600
    s_waitcnt lgkmcnt(12)
    v_mfma_f32_32x32x16_bf16 v[16:31], v[212:215], v[116:119], v[16:31]
    ds_read_b64_tr_b16 v[208:209], v228 offset:28672
    ds_read_b64_tr_b16 v[210:211], v228 offset:29696
    s_waitcnt lgkmcnt(12)
    v_mfma_f32_32x32x16_bf16 v[32:47], v[216:219], v[116:119], v[32:47]
    ds_read_b64_tr_b16 v[212:213], v229 offset:28672
    ds_read_b64_tr_b16 v[214:215], v229 offset:29696
    s_waitcnt lgkmcnt(12)
    v_mfma_f32_32x32x16_bf16 v[48:63], v[220:223], v[116:119], v[48:63]
    ds_read_b64_tr_b16 v[216:217], v230 offset:28672
    ds_read_b64_tr_b16 v[218:219], v230 offset:29696
    s_waitcnt lgkmcnt(12)
    v_mfma_f32_32x32x16_bf16 v[0:15], v[192:195], v[120:123], v[0:15]
    ds_read_b64_tr_b16 v[220:221], v231 offset:28672
    ds_read_b64_tr_b16 v[222:223], v231 offset:29696
    s_waitcnt lgkmcnt(12)
    v_mfma_f32_32x32x16_bf16 v[16:31], v[196:199], v[120:123], v[16:31]
    s_waitcnt vmcnt(20) lgkmcnt(0)
    s_barrier
    ds_read_b64_tr_b16 v[192:193], v228 offset:32768
    ds_read_b64_tr_b16 v[194:195], v228 offset:33792
    v_mfma_f32_32x32x16_bf16 v[32:47], v[200:203], v[120:123], v[32:47]
    ds_read_b64_tr_b16 v[196:197], v229 offset:32768
    ds_read_b64_tr_b16 v[198:199], v229 offset:33792
    v_mfma_f32_32x32x16_bf16 v[48:63], v[204:207], v[120:123], v[48:63]
    ds_read_b64_tr_b16 v[200:201], v230 offset:32768
    ds_read_b64_tr_b16 v[202:203], v230 offset:33792
    v_mfma_f32_32x32x16_bf16 v[0:15], v[208:211], v[124:127], v[0:15]
    ds_read_b64_tr_b16 v[204:205], v231 offset:32768
    ds_read_b64_tr_b16 v[206:207], v231 offset:33792
    v_mfma_f32_32x32x16_bf16 v[16:31], v[212:215], v[124:127], v[16:31]
    ds_read_b64_tr_b16 v[208:209], v228 offset:36864
    ds_read_b64_tr_b16 v[210:211], v228 offset:37888
    v_mfma_f32_32x32x16_bf16 v[32:47], v[216:219], v[124:127], v[32:47]
    ds_read_b64_tr_b16 v[212:213], v229 offset:36864
    ds_read_b64_tr_b16 v[214:215], v229 offset:37888
    v_mfma_f32_32x32x16_bf16 v[48:63], v[220:223], v[124:127], v[48:63]
    ds_read_b64_tr_b16 v[216:217], v230 offset:36864
    ds_read_b64_tr_b16 v[218:219], v230 offset:37888
    s_waitcnt lgkmcnt(12)
    v_mfma_f32_32x32x16_bf16 v[128:143], v[192:195], v[64:67], 0
    ds_read_b64_tr_b16 v[220:221], v231 offset:36864
    ds_read_b64_tr_b16 v[222:223], v231 offset:37888
    s_waitcnt lgkmcnt(12)
    v_mfma_f32_32x32x16_bf16 v[144:159], v[196:199], v[64:67], 0
    ds_read_b64_tr_b16 v[192:193], v228 offset:40960
    ds_read_b64_tr_b16 v[194:195], v228 offset:41984
    s_add_u32 s76, s75, 8192
    v_cvt_pk_bf16_f32 v0, v0, v1
    v_cvt_pk_bf16_f32 v1, v2, v3
    s_waitcnt lgkmcnt(12)
    v_mfma_f32_32x32x16_bf16 v[160:175], v[200:203], v[64:67], 0
    ds_read_b64_tr_b16 v[196:197], v229 offset:40960
    ds_read_b64_tr_b16 v[198:199], v229 offset:41984
    v_cvt_pk_bf16_f32 v2, v4, v5
    v_cvt_pk_bf16_f32 v3, v6, v7
    buffer_store_dwordx4 v[0:3], v248, s[60:63], s76 offen offset:0 sc0 sc1
    s_waitcnt lgkmcnt(12)
    v_mfma_f32_32x32x16_bf16 v[176:191], v[204:207], v[64:67], 0
    ds_read_b64_tr_b16 v[200:201], v230 offset:40960
    ds_read_b64_tr_b16 v[202:203], v230 offset:41984
    v_cvt_pk_bf16_f32 v8, v8, v9
    v_cvt_pk_bf16_f32 v9, v10, v11
    v_cvt_pk_bf16_f32 v10, v12, v13
    s_waitcnt lgkmcnt(12)
    v_mfma_f32_32x32x16_bf16 v[128:143], v[208:211], v[68:71], v[128:143]
    ds_read_b64_tr_b16 v[204:205], v231 offset:40960
    ds_read_b64_tr_b16 v[206:207], v231 offset:41984
    v_cvt_pk_bf16_f32 v11, v14, v15
    buffer_store_dwordx4 v[8:11], v248, s[60:63], s76 offen offset:1024 sc0 sc1
    v_cvt_pk_bf16_f32 v16, v16, v17
    s_waitcnt lgkmcnt(12)
    v_mfma_f32_32x32x16_bf16 v[144:159], v[212:215], v[68:71], v[144:159]
    ds_read_b64_tr_b16 v[208:209], v228 offset:45056
    ds_read_b64_tr_b16 v[210:211], v228 offset:46080
    v_cvt_pk_bf16_f32 v17, v18, v19
    v_cvt_pk_bf16_f32 v18, v20, v21
    v_cvt_pk_bf16_f32 v19, v22, v23
    s_waitcnt lgkmcnt(12)
    v_mfma_f32_32x32x16_bf16 v[160:175], v[216:219], v[68:71], v[160:175]
    ds_read_b64_tr_b16 v[212:213], v229 offset:45056
    ds_read_b64_tr_b16 v[214:215], v229 offset:46080
    buffer_store_dwordx4 v[16:19], v248, s[60:63], s76 offen offset:2048 sc0 sc1
    v_cvt_pk_bf16_f32 v24, v24, v25
    v_cvt_pk_bf16_f32 v25, v26, v27
    s_waitcnt lgkmcnt(12)
    v_mfma_f32_32x32x16_bf16 v[176:191], v[220:223], v[68:71], v[176:191]
    ds_read_b64_tr_b16 v[216:217], v230 offset:45056
    ds_read_b64_tr_b16 v[218:219], v230 offset:46080
    v_cvt_pk_bf16_f32 v26, v28, v29
    v_cvt_pk_bf16_f32 v27, v30, v31
    buffer_store_dwordx4 v[24:27], v248, s[60:63], s76 offen offset:3072 sc0 sc1
    s_waitcnt lgkmcnt(12)
    v_mfma_f32_32x32x16_bf16 v[128:143], v[192:195], v[72:75], v[128:143]
    ds_read_b64_tr_b16 v[220:221], v231 offset:45056
    ds_read_b64_tr_b16 v[222:223], v231 offset:46080
    s_add_u32 s76, s75, 12288
    v_cvt_pk_bf16_f32 v32, v32, v33
    v_cvt_pk_bf16_f32 v33, v34, v35
    s_waitcnt lgkmcnt(12)
    v_mfma_f32_32x32x16_bf16 v[144:159], v[196:199], v[72:75], v[144:159]
    ds_read_b64_tr_b16 v[192:193], v228 offset:49152
    ds_read_b64_tr_b16 v[194:195], v228 offset:50176
    v_cvt_pk_bf16_f32 v34, v36, v37
    v_cvt_pk_bf16_f32 v35, v38, v39
    buffer_store_dwordx4 v[32:35], v248, s[60:63], s76 offen offset:0 sc0 sc1
    s_waitcnt lgkmcnt(12)
    v_mfma_f32_32x32x16_bf16 v[160:175], v[200:203], v[72:75], v[160:175]
    ds_read_b64_tr_b16 v[196:197], v229 offset:49152
    ds_read_b64_tr_b16 v[198:199], v229 offset:50176
    v_cvt_pk_bf16_f32 v40, v40, v41
    v_cvt_pk_bf16_f32 v41, v42, v43
    v_cvt_pk_bf16_f32 v42, v44, v45
    s_waitcnt lgkmcnt(12)
    v_mfma_f32_32x32x16_bf16 v[176:191], v[204:207], v[72:75], v[176:191]
    ds_read_b64_tr_b16 v[200:201], v230 offset:49152
    ds_read_b64_tr_b16 v[202:203], v230 offset:50176
    v_cvt_pk_bf16_f32 v43, v46, v47
    buffer_store_dwordx4 v[40:43], v248, s[60:63], s76 offen offset:1024 sc0 sc1
    v_cvt_pk_bf16_f32 v48, v48, v49
    s_waitcnt lgkmcnt(12)
    v_mfma_f32_32x32x16_bf16 v[128:143], v[208:211], v[76:79], v[128:143]
    ds_read_b64_tr_b16 v[204:205], v231 offset:49152
    ds_read_b64_tr_b16 v[206:207], v231 offset:50176
    v_cvt_pk_bf16_f32 v49, v50, v51
    v_cvt_pk_bf16_f32 v50, v52, v53
    v_cvt_pk_bf16_f32 v51, v54, v55
    s_waitcnt lgkmcnt(12)
    v_mfma_f32_32x32x16_bf16 v[144:159], v[212:215], v[76:79], v[144:159]
    ds_read_b64_tr_b16 v[208:209], v228 offset:53248
    ds_read_b64_tr_b16 v[210:211], v228 offset:54272
    buffer_store_dwordx4 v[48:51], v248, s[60:63], s76 offen offset:2048 sc0 sc1
    v_cvt_pk_bf16_f32 v56, v56, v57
    v_cvt_pk_bf16_f32 v57, v58, v59
    s_waitcnt lgkmcnt(12)
    v_mfma_f32_32x32x16_bf16 v[160:175], v[216:219], v[76:79], v[160:175]
    ds_read_b64_tr_b16 v[212:213], v229 offset:53248
    ds_read_b64_tr_b16 v[214:215], v229 offset:54272
    v_cvt_pk_bf16_f32 v58, v60, v61
    v_cvt_pk_bf16_f32 v59, v62, v63
    buffer_store_dwordx4 v[56:59], v248, s[60:63], s76 offen offset:3072 sc0 sc1
    s_waitcnt lgkmcnt(12)
    v_mfma_f32_32x32x16_bf16 v[176:191], v[220:223], v[76:79], v[176:191]
    ds_read_b64_tr_b16 v[216:217], v230 offset:53248
    ds_read_b64_tr_b16 v[218:219], v230 offset:54272
    s_waitcnt lgkmcnt(12)
    v_mfma_f32_32x32x16_bf16 v[128:143], v[192:195], v[80:83], v[128:143]
    ds_read_b64_tr_b16 v[220:221], v231 offset:53248
    ds_read_b64_tr_b16 v[222:223], v231 offset:54272
    s_waitcnt lgkmcnt(12)
    v_mfma_f32_32x32x16_bf16 v[144:159], v[196:199], v[80:83], v[144:159]
    ds_read_b64_tr_b16 v[192:193], v228 offset:57344
    ds_read_b64_tr_b16 v[194:195], v228 offset:58368
    s_waitcnt lgkmcnt(12)
    v_mfma_f32_32x32x16_bf16 v[160:175], v[200:203], v[80:83], v[160:175]
    ds_read_b64_tr_b16 v[196:197], v229 offset:57344
    ds_read_b64_tr_b16 v[198:199], v229 offset:58368
    s_waitcnt lgkmcnt(12)
    v_mfma_f32_32x32x16_bf16 v[176:191], v[204:207], v[80:83], v[176:191]
    ds_read_b64_tr_b16 v[200:201], v230 offset:57344
    ds_read_b64_tr_b16 v[202:203], v230 offset:58368
    s_waitcnt lgkmcnt(12)
    v_mfma_f32_32x32x16_bf16 v[128:143], v[208:211], v[84:87], v[128:143]
    ds_read_b64_tr_b16 v[204:205], v231 offset:57344
    ds_read_b64_tr_b16 v[206:207], v231 offset:58368
    s_waitcnt lgkmcnt(12)
    v_mfma_f32_32x32x16_bf16 v[144:159], v[212:215], v[84:87], v[144:159]
    ds_read_b64_tr_b16 v[208:209], v228 offset:61440
    ds_read_b64_tr_b16 v[210:211], v228 offset:62464
    s_waitcnt lgkmcnt(12)
    v_mfma_f32_32x32x16_bf16 v[160:175], v[216:219], v[84:87], v[160:175]
    ds_read_b64_tr_b16 v[212:213], v229 offset:61440
    ds_read_b64_tr_b16 v[214:215], v229 offset:62464
    s_waitcnt lgkmcnt(12)
    v_mfma_f32_32x32x16_bf16 v[176:191], v[220:223], v[84:87], v[176:191]
    ds_read_b64_tr_b16 v[216:217], v230 offset:61440
    ds_read_b64_tr_b16 v[218:219], v230 offset:62464
    s_waitcnt lgkmcnt(12)
    v_mfma_f32_32x32x16_bf16 v[128:143], v[192:195], v[88:91], v[128:143]
    ds_read_b64_tr_b16 v[220:221], v231 offset:61440
    ds_read_b64_tr_b16 v[222:223], v231 offset:62464
    s_waitcnt lgkmcnt(12)
    v_mfma_f32_32x32x16_bf16 v[144:159], v[196:199], v[88:91], v[144:159]
    s_waitcnt vmcnt(24) lgkmcnt(0)
    s_barrier
    ds_read_b64_tr_b16 v[192:193], v252 offset:0
    ds_read_b64_tr_b16 v[194:195], v252 offset:1024
    v_mfma_f32_32x32x16_bf16 v[160:175], v[200:203], v[88:91], v[160:175]
    ds_read_b64_tr_b16 v[196:197], v253 offset:0
    ds_read_b64_tr_b16 v[198:199], v253 offset:1024
    v_mfma_f32_32x32x16_bf16 v[176:191], v[204:207], v[88:91], v[176:191]
    ds_read_b64_tr_b16 v[200:201], v254 offset:0
    ds_read_b64_tr_b16 v[202:203], v254 offset:1024
    v_mfma_f32_32x32x16_bf16 v[128:143], v[208:211], v[92:95], v[128:143]
    ds_read_b64_tr_b16 v[204:205], v255 offset:0
    ds_read_b64_tr_b16 v[206:207], v255 offset:1024
    v_mfma_f32_32x32x16_bf16 v[144:159], v[212:215], v[92:95], v[144:159]
    ds_read_b64_tr_b16 v[208:209], v252 offset:4096
    ds_read_b64_tr_b16 v[210:211], v252 offset:5120
    v_mfma_f32_32x32x16_bf16 v[160:175], v[216:219], v[92:95], v[160:175]
    ds_read_b64_tr_b16 v[212:213], v253 offset:4096
    ds_read_b64_tr_b16 v[214:215], v253 offset:5120
    v_mfma_f32_32x32x16_bf16 v[176:191], v[220:223], v[92:95], v[176:191]
    ds_read_b64_tr_b16 v[216:217], v254 offset:4096
    ds_read_b64_tr_b16 v[218:219], v254 offset:5120
    s_waitcnt lgkmcnt(12)
    v_mfma_f32_32x32x16_bf16 v[128:143], v[192:195], v[96:99], v[128:143]
    ds_read_b64_tr_b16 v[220:221], v255 offset:4096
    ds_read_b64_tr_b16 v[222:223], v255 offset:5120
    s_waitcnt lgkmcnt(12)
    v_mfma_f32_32x32x16_bf16 v[144:159], v[196:199], v[96:99], v[144:159]
    ds_read_b64_tr_b16 v[192:193], v252 offset:8192
    ds_read_b64_tr_b16 v[194:195], v252 offset:9216
    s_waitcnt lgkmcnt(12)
    v_mfma_f32_32x32x16_bf16 v[160:175], v[200:203], v[96:99], v[160:175]
    ds_read_b64_tr_b16 v[196:197], v253 offset:8192
    ds_read_b64_tr_b16 v[198:199], v253 offset:9216
    s_waitcnt lgkmcnt(12)
    v_mfma_f32_32x32x16_bf16 v[176:191], v[204:207], v[96:99], v[176:191]
    ds_read_b64_tr_b16 v[200:201], v254 offset:8192
    ds_read_b64_tr_b16 v[202:203], v254 offset:9216
    s_waitcnt lgkmcnt(12)
    v_mfma_f32_32x32x16_bf16 v[128:143], v[208:211], v[100:103], v[128:143]
    ds_read_b64_tr_b16 v[204:205], v255 offset:8192
    ds_read_b64_tr_b16 v[206:207], v255 offset:9216
    s_waitcnt lgkmcnt(12)
    v_mfma_f32_32x32x16_bf16 v[144:159], v[212:215], v[100:103], v[144:159]
    ds_read_b64_tr_b16 v[208:209], v252 offset:12288
    ds_read_b64_tr_b16 v[210:211], v252 offset:13312
    s_waitcnt lgkmcnt(12)
    v_mfma_f32_32x32x16_bf16 v[160:175], v[216:219], v[100:103], v[160:175]
    ds_read_b64_tr_b16 v[212:213], v253 offset:12288
    ds_read_b64_tr_b16 v[214:215], v253 offset:13312
    s_waitcnt lgkmcnt(12)
    v_mfma_f32_32x32x16_bf16 v[176:191], v[220:223], v[100:103], v[176:191]
    ds_read_b64_tr_b16 v[216:217], v254 offset:12288
    ds_read_b64_tr_b16 v[218:219], v254 offset:13312
    s_waitcnt lgkmcnt(12)
    v_mfma_f32_32x32x16_bf16 v[128:143], v[192:195], v[104:107], v[128:143]
    ds_read_b64_tr_b16 v[220:221], v255 offset:12288
    ds_read_b64_tr_b16 v[222:223], v255 offset:13312
    s_waitcnt lgkmcnt(12)
    v_mfma_f32_32x32x16_bf16 v[144:159], v[196:199], v[104:107], v[144:159]
    ds_read_b64_tr_b16 v[192:193], v252 offset:16384
    ds_read_b64_tr_b16 v[194:195], v252 offset:17408
    s_waitcnt lgkmcnt(12)
    v_mfma_f32_32x32x16_bf16 v[160:175], v[200:203], v[104:107], v[160:175]
    ds_read_b64_tr_b16 v[196:197], v253 offset:16384
    ds_read_b64_tr_b16 v[198:199], v253 offset:17408
    s_waitcnt lgkmcnt(12)
    v_mfma_f32_32x32x16_bf16 v[176:191], v[204:207], v[104:107], v[176:191]
    ds_read_b64_tr_b16 v[200:201], v254 offset:16384
    ds_read_b64_tr_b16 v[202:203], v254 offset:17408
    s_waitcnt lgkmcnt(12)
    v_mfma_f32_32x32x16_bf16 v[128:143], v[208:211], v[108:111], v[128:143]
    ds_read_b64_tr_b16 v[204:205], v255 offset:16384
    ds_read_b64_tr_b16 v[206:207], v255 offset:17408
    s_waitcnt lgkmcnt(12)
    v_mfma_f32_32x32x16_bf16 v[144:159], v[212:215], v[108:111], v[144:159]
    ds_read_b64_tr_b16 v[208:209], v252 offset:20480
    ds_read_b64_tr_b16 v[210:211], v252 offset:21504
    s_waitcnt lgkmcnt(12)
    v_mfma_f32_32x32x16_bf16 v[160:175], v[216:219], v[108:111], v[160:175]
    ds_read_b64_tr_b16 v[212:213], v253 offset:20480
    ds_read_b64_tr_b16 v[214:215], v253 offset:21504
    s_waitcnt lgkmcnt(12)
    v_mfma_f32_32x32x16_bf16 v[176:191], v[220:223], v[108:111], v[176:191]
    ds_read_b64_tr_b16 v[216:217], v254 offset:20480
    ds_read_b64_tr_b16 v[218:219], v254 offset:21504
    s_waitcnt lgkmcnt(12)
    v_mfma_f32_32x32x16_bf16 v[128:143], v[192:195], v[112:115], v[128:143]
    ds_read_b64_tr_b16 v[220:221], v255 offset:20480
    ds_read_b64_tr_b16 v[222:223], v255 offset:21504
    s_waitcnt lgkmcnt(12)
    v_mfma_f32_32x32x16_bf16 v[144:159], v[196:199], v[112:115], v[144:159]
    ds_read_b64_tr_b16 v[192:193], v252 offset:24576
    ds_read_b64_tr_b16 v[194:195], v252 offset:25600
    s_waitcnt lgkmcnt(12)
    v_mfma_f32_32x32x16_bf16 v[160:175], v[200:203], v[112:115], v[160:175]
    ds_read_b64_tr_b16 v[196:197], v253 offset:24576
    ds_read_b64_tr_b16 v[198:199], v253 offset:25600
    s_waitcnt lgkmcnt(12)
    v_mfma_f32_32x32x16_bf16 v[176:191], v[204:207], v[112:115], v[176:191]
    ds_read_b64_tr_b16 v[200:201], v254 offset:24576
    ds_read_b64_tr_b16 v[202:203], v254 offset:25600
    s_waitcnt lgkmcnt(12)
    v_mfma_f32_32x32x16_bf16 v[128:143], v[208:211], v[116:119], v[128:143]
    ds_read_b64_tr_b16 v[204:205], v255 offset:24576
    ds_read_b64_tr_b16 v[206:207], v255 offset:25600
    s_waitcnt lgkmcnt(12)
    v_mfma_f32_32x32x16_bf16 v[144:159], v[212:215], v[116:119], v[144:159]
    ds_read_b64_tr_b16 v[208:209], v252 offset:28672
    ds_read_b64_tr_b16 v[210:211], v252 offset:29696
    s_waitcnt lgkmcnt(12)
    v_mfma_f32_32x32x16_bf16 v[160:175], v[216:219], v[116:119], v[160:175]
    ds_read_b64_tr_b16 v[212:213], v253 offset:28672
    ds_read_b64_tr_b16 v[214:215], v253 offset:29696
    s_waitcnt lgkmcnt(12)
    v_mfma_f32_32x32x16_bf16 v[176:191], v[220:223], v[116:119], v[176:191]
    ds_read_b64_tr_b16 v[216:217], v254 offset:28672
    ds_read_b64_tr_b16 v[218:219], v254 offset:29696
    s_waitcnt lgkmcnt(12)
    v_mfma_f32_32x32x16_bf16 v[128:143], v[192:195], v[120:123], v[128:143]
    ds_read_b64_tr_b16 v[220:221], v255 offset:28672
    ds_read_b64_tr_b16 v[222:223], v255 offset:29696
    s_waitcnt lgkmcnt(12)
    v_mfma_f32_32x32x16_bf16 v[144:159], v[196:199], v[120:123], v[144:159]
    s_waitcnt vmcnt(20) lgkmcnt(0)
    s_barrier
    ds_read_b64_tr_b16 v[192:193], v224 offset:0
    ds_read_b64_tr_b16 v[194:195], v224 offset:1024
    v_mfma_f32_32x32x16_bf16 v[160:175], v[200:203], v[120:123], v[160:175]
    ds_read_b64_tr_b16 v[196:197], v225 offset:0
    ds_read_b64_tr_b16 v[198:199], v225 offset:1024
    v_mfma_f32_32x32x16_bf16 v[176:191], v[204:207], v[120:123], v[176:191]
    ds_read_b64_tr_b16 v[200:201], v226 offset:0
    ds_read_b64_tr_b16 v[202:203], v226 offset:1024
    v_mfma_f32_32x32x16_bf16 v[128:143], v[208:211], v[124:127], v[128:143]
    ds_read_b64_tr_b16 v[204:205], v227 offset:0
    ds_read_b64_tr_b16 v[206:207], v227 offset:1024
    v_mfma_f32_32x32x16_bf16 v[144:159], v[212:215], v[124:127], v[144:159]
    ds_read_b64_tr_b16 v[208:209], v224 offset:4096
    ds_read_b64_tr_b16 v[210:211], v224 offset:5120
    v_mfma_f32_32x32x16_bf16 v[160:175], v[216:219], v[124:127], v[160:175]
    ds_read_b64_tr_b16 v[212:213], v225 offset:4096
    ds_read_b64_tr_b16 v[214:215], v225 offset:5120
    v_mfma_f32_32x32x16_bf16 v[176:191], v[220:223], v[124:127], v[176:191]
    ds_read_b64_tr_b16 v[216:217], v226 offset:4096
    ds_read_b64_tr_b16 v[218:219], v226 offset:5120
    s_waitcnt lgkmcnt(12)
    v_mfma_f32_32x32x16_bf16 v[0:15], v[192:195], v[64:67], 0
    ds_read_b64_tr_b16 v[220:221], v227 offset:4096
    ds_read_b64_tr_b16 v[222:223], v227 offset:5120
    s_waitcnt lgkmcnt(12)
    v_mfma_f32_32x32x16_bf16 v[16:31], v[196:199], v[64:67], 0
    ds_read_b64_tr_b16 v[192:193], v224 offset:8192
    ds_read_b64_tr_b16 v[194:195], v224 offset:9216
    s_add_u32 s76, s75, 16384
    v_cvt_pk_bf16_f32 v128, v128, v129
    v_cvt_pk_bf16_f32 v129, v130, v131
    s_waitcnt lgkmcnt(12)
    v_mfma_f32_32x32x16_bf16 v[32:47], v[200:203], v[64:67], 0
    ds_read_b64_tr_b16 v[196:197], v225 offset:8192
    ds_read_b64_tr_b16 v[198:199], v225 offset:9216
    v_cvt_pk_bf16_f32 v130, v132, v133
    v_cvt_pk_bf16_f32 v131, v134, v135
    buffer_store_dwordx4 v[128:131], v248, s[60:63], s76 offen offset:0 sc0 sc1
    s_waitcnt lgkmcnt(12)
    v_mfma_f32_32x32x16_bf16 v[48:63], v[204:207], v[64:67], 0
    ds_read_b64_tr_b16 v[200:201], v226 offset:8192
    ds_read_b64_tr_b16 v[202:203], v226 offset:9216
    v_cvt_pk_bf16_f32 v136, v136, v137
    v_cvt_pk_bf16_f32 v137, v138, v139
    v_cvt_pk_bf16_f32 v138, v140, v141
    s_waitcnt lgkmcnt(12)
    v_mfma_f32_32x32x16_bf16 v[0:15], v[208:211], v[68:71], v[0:15]
    ds_read_b64_tr_b16 v[204:205], v227 offset:8192
    ds_read_b64_tr_b16 v[206:207], v227 offset:9216
    v_cvt_pk_bf16_f32 v139, v142, v143
    buffer_store_dwordx4 v[136:139], v248, s[60:63], s76 offen offset:1024 sc0 sc1
    v_cvt_pk_bf16_f32 v144, v144, v145
    s_waitcnt lgkmcnt(12)
    v_mfma_f32_32x32x16_bf16 v[16:31], v[212:215], v[68:71], v[16:31]
    ds_read_b64_tr_b16 v[208:209], v224 offset:12288
    ds_read_b64_tr_b16 v[210:211], v224 offset:13312
    v_cvt_pk_bf16_f32 v145, v146, v147
    v_cvt_pk_bf16_f32 v146, v148, v149
    v_cvt_pk_bf16_f32 v147, v150, v151
    s_waitcnt lgkmcnt(12)
    v_mfma_f32_32x32x16_bf16 v[32:47], v[216:219], v[68:71], v[32:47]
    ds_read_b64_tr_b16 v[212:213], v225 offset:12288
    ds_read_b64_tr_b16 v[214:215], v225 offset:13312
    buffer_store_dwordx4 v[144:147], v248, s[60:63], s76 offen offset:2048 sc0 sc1
    v_cvt_pk_bf16_f32 v152, v152, v153
    v_cvt_pk_bf16_f32 v153, v154, v155
    s_waitcnt lgkmcnt(12)
    v_mfma_f32_32x32x16_bf16 v[48:63], v[220:223], v[68:71], v[48:63]
    ds_read_b64_tr_b16 v[216:217], v226 offset:12288
    ds_read_b64_tr_b16 v[218:219], v226 offset:13312
    v_cvt_pk_bf16_f32 v154, v156, v157
    v_cvt_pk_bf16_f32 v155, v158, v159
    buffer_store_dwordx4 v[152:155], v248, s[60:63], s76 offen offset:3072 sc0 sc1
    s_waitcnt lgkmcnt(12)
    v_mfma_f32_32x32x16_bf16 v[0:15], v[192:195], v[72:75], v[0:15]
    ds_read_b64_tr_b16 v[220:221], v227 offset:12288
    ds_read_b64_tr_b16 v[222:223], v227 offset:13312
    s_add_u32 s76, s75, 20480
    v_cvt_pk_bf16_f32 v160, v160, v161
    v_cvt_pk_bf16_f32 v161, v162, v163
    s_waitcnt lgkmcnt(12)
    v_mfma_f32_32x32x16_bf16 v[16:31], v[196:199], v[72:75], v[16:31]
    ds_read_b64_tr_b16 v[192:193], v224 offset:16384
    ds_read_b64_tr_b16 v[194:195], v224 offset:17408
    v_cvt_pk_bf16_f32 v162, v164, v165
    v_cvt_pk_bf16_f32 v163, v166, v167
    buffer_store_dwordx4 v[160:163], v248, s[60:63], s76 offen offset:0 sc0 sc1
    s_waitcnt lgkmcnt(12)
    v_mfma_f32_32x32x16_bf16 v[32:47], v[200:203], v[72:75], v[32:47]
    ds_read_b64_tr_b16 v[196:197], v225 offset:16384
    ds_read_b64_tr_b16 v[198:199], v225 offset:17408
    v_cvt_pk_bf16_f32 v168, v168, v169
    v_cvt_pk_bf16_f32 v169, v170, v171
    v_cvt_pk_bf16_f32 v170, v172, v173
    s_waitcnt lgkmcnt(12)
    v_mfma_f32_32x32x16_bf16 v[48:63], v[204:207], v[72:75], v[48:63]
    ds_read_b64_tr_b16 v[200:201], v226 offset:16384
    ds_read_b64_tr_b16 v[202:203], v226 offset:17408
    v_cvt_pk_bf16_f32 v171, v174, v175
    buffer_store_dwordx4 v[168:171], v248, s[60:63], s76 offen offset:1024 sc0 sc1
    v_cvt_pk_bf16_f32 v176, v176, v177
    s_waitcnt lgkmcnt(12)
    v_mfma_f32_32x32x16_bf16 v[0:15], v[208:211], v[76:79], v[0:15]
    ds_read_b64_tr_b16 v[204:205], v227 offset:16384
    ds_read_b64_tr_b16 v[206:207], v227 offset:17408
    v_cvt_pk_bf16_f32 v177, v178, v179
    v_cvt_pk_bf16_f32 v178, v180, v181
    v_cvt_pk_bf16_f32 v179, v182, v183
    s_waitcnt lgkmcnt(12)
    v_mfma_f32_32x32x16_bf16 v[16:31], v[212:215], v[76:79], v[16:31]
    ds_read_b64_tr_b16 v[208:209], v224 offset:20480
    ds_read_b64_tr_b16 v[210:211], v224 offset:21504
    buffer_store_dwordx4 v[176:179], v248, s[60:63], s76 offen offset:2048 sc0 sc1
    v_cvt_pk_bf16_f32 v184, v184, v185
    v_cvt_pk_bf16_f32 v185, v186, v187
    s_waitcnt lgkmcnt(12)
    v_mfma_f32_32x32x16_bf16 v[32:47], v[216:219], v[76:79], v[32:47]
    ds_read_b64_tr_b16 v[212:213], v225 offset:20480
    ds_read_b64_tr_b16 v[214:215], v225 offset:21504
    v_cvt_pk_bf16_f32 v186, v188, v189
    v_cvt_pk_bf16_f32 v187, v190, v191
    buffer_store_dwordx4 v[184:187], v248, s[60:63], s76 offen offset:3072 sc0 sc1
    s_waitcnt lgkmcnt(12)
    v_mfma_f32_32x32x16_bf16 v[48:63], v[220:223], v[76:79], v[48:63]
    ds_read_b64_tr_b16 v[216:217], v226 offset:20480
    ds_read_b64_tr_b16 v[218:219], v226 offset:21504
    s_waitcnt lgkmcnt(12)
    v_mfma_f32_32x32x16_bf16 v[0:15], v[192:195], v[80:83], v[0:15]
    ds_read_b64_tr_b16 v[220:221], v227 offset:20480
    ds_read_b64_tr_b16 v[222:223], v227 offset:21504
    s_waitcnt lgkmcnt(12)
    v_mfma_f32_32x32x16_bf16 v[16:31], v[196:199], v[80:83], v[16:31]
    ds_read_b64_tr_b16 v[192:193], v224 offset:24576
    ds_read_b64_tr_b16 v[194:195], v224 offset:25600
    s_waitcnt lgkmcnt(12)
    v_mfma_f32_32x32x16_bf16 v[32:47], v[200:203], v[80:83], v[32:47]
    ds_read_b64_tr_b16 v[196:197], v225 offset:24576
    ds_read_b64_tr_b16 v[198:199], v225 offset:25600
    s_waitcnt lgkmcnt(12)
    v_mfma_f32_32x32x16_bf16 v[48:63], v[204:207], v[80:83], v[48:63]
    ds_read_b64_tr_b16 v[200:201], v226 offset:24576
    ds_read_b64_tr_b16 v[202:203], v226 offset:25600
    s_waitcnt lgkmcnt(12)
    v_mfma_f32_32x32x16_bf16 v[0:15], v[208:211], v[84:87], v[0:15]
    ds_read_b64_tr_b16 v[204:205], v227 offset:24576
    ds_read_b64_tr_b16 v[206:207], v227 offset:25600
    s_waitcnt lgkmcnt(12)
    v_mfma_f32_32x32x16_bf16 v[16:31], v[212:215], v[84:87], v[16:31]
    ds_read_b64_tr_b16 v[208:209], v224 offset:28672
    ds_read_b64_tr_b16 v[210:211], v224 offset:29696
    s_waitcnt lgkmcnt(12)
    v_mfma_f32_32x32x16_bf16 v[32:47], v[216:219], v[84:87], v[32:47]
    ds_read_b64_tr_b16 v[212:213], v225 offset:28672
    ds_read_b64_tr_b16 v[214:215], v225 offset:29696
    s_waitcnt lgkmcnt(12)
    v_mfma_f32_32x32x16_bf16 v[48:63], v[220:223], v[84:87], v[48:63]
    ds_read_b64_tr_b16 v[216:217], v226 offset:28672
    ds_read_b64_tr_b16 v[218:219], v226 offset:29696
    s_waitcnt lgkmcnt(12)
    v_mfma_f32_32x32x16_bf16 v[0:15], v[192:195], v[88:91], v[0:15]
    ds_read_b64_tr_b16 v[220:221], v227 offset:28672
    ds_read_b64_tr_b16 v[222:223], v227 offset:29696
    s_waitcnt lgkmcnt(12)
    v_mfma_f32_32x32x16_bf16 v[16:31], v[196:199], v[88:91], v[16:31]
    s_waitcnt vmcnt(16) lgkmcnt(0)
    s_barrier
    ds_read_b64_tr_b16 v[192:193], v224 offset:32768
    ds_read_b64_tr_b16 v[194:195], v224 offset:33792
    v_mfma_f32_32x32x16_bf16 v[32:47], v[200:203], v[88:91], v[32:47]
    ds_read_b64_tr_b16 v[196:197], v225 offset:32768
    ds_read_b64_tr_b16 v[198:199], v225 offset:33792
    v_mfma_f32_32x32x16_bf16 v[48:63], v[204:207], v[88:91], v[48:63]
    ds_read_b64_tr_b16 v[200:201], v226 offset:32768
    ds_read_b64_tr_b16 v[202:203], v226 offset:33792
    v_mfma_f32_32x32x16_bf16 v[0:15], v[208:211], v[92:95], v[0:15]
    ds_read_b64_tr_b16 v[204:205], v227 offset:32768
    ds_read_b64_tr_b16 v[206:207], v227 offset:33792
    v_mfma_f32_32x32x16_bf16 v[16:31], v[212:215], v[92:95], v[16:31]
    ds_read_b64_tr_b16 v[208:209], v224 offset:36864
    ds_read_b64_tr_b16 v[210:211], v224 offset:37888
    v_mfma_f32_32x32x16_bf16 v[32:47], v[216:219], v[92:95], v[32:47]
    ds_read_b64_tr_b16 v[212:213], v225 offset:36864
    ds_read_b64_tr_b16 v[214:215], v225 offset:37888
    v_mfma_f32_32x32x16_bf16 v[48:63], v[220:223], v[92:95], v[48:63]
    ds_read_b64_tr_b16 v[216:217], v226 offset:36864
    ds_read_b64_tr_b16 v[218:219], v226 offset:37888
    s_waitcnt lgkmcnt(12)
    v_mfma_f32_32x32x16_bf16 v[0:15], v[192:195], v[96:99], v[0:15]
    ds_read_b64_tr_b16 v[220:221], v227 offset:36864
    ds_read_b64_tr_b16 v[222:223], v227 offset:37888
    s_waitcnt lgkmcnt(12)
    v_mfma_f32_32x32x16_bf16 v[16:31], v[196:199], v[96:99], v[16:31]
    ds_read_b64_tr_b16 v[192:193], v224 offset:40960
    ds_read_b64_tr_b16 v[194:195], v224 offset:41984
    s_waitcnt lgkmcnt(12)
    v_mfma_f32_32x32x16_bf16 v[32:47], v[200:203], v[96:99], v[32:47]
    ds_read_b64_tr_b16 v[196:197], v225 offset:40960
    ds_read_b64_tr_b16 v[198:199], v225 offset:41984
    s_waitcnt lgkmcnt(12)
    v_mfma_f32_32x32x16_bf16 v[48:63], v[204:207], v[96:99], v[48:63]
    ds_read_b64_tr_b16 v[200:201], v226 offset:40960
    ds_read_b64_tr_b16 v[202:203], v226 offset:41984
    s_waitcnt lgkmcnt(12)
    v_mfma_f32_32x32x16_bf16 v[0:15], v[208:211], v[100:103], v[0:15]
    ds_read_b64_tr_b16 v[204:205], v227 offset:40960
    ds_read_b64_tr_b16 v[206:207], v227 offset:41984
    s_waitcnt lgkmcnt(12)
    v_mfma_f32_32x32x16_bf16 v[16:31], v[212:215], v[100:103], v[16:31]
    ds_read_b64_tr_b16 v[208:209], v224 offset:45056
    ds_read_b64_tr_b16 v[210:211], v224 offset:46080
    s_waitcnt lgkmcnt(12)
    v_mfma_f32_32x32x16_bf16 v[32:47], v[216:219], v[100:103], v[32:47]
    ds_read_b64_tr_b16 v[212:213], v225 offset:45056
    ds_read_b64_tr_b16 v[214:215], v225 offset:46080
    s_waitcnt lgkmcnt(12)
    v_mfma_f32_32x32x16_bf16 v[48:63], v[220:223], v[100:103], v[48:63]
    ds_read_b64_tr_b16 v[216:217], v226 offset:45056
    ds_read_b64_tr_b16 v[218:219], v226 offset:46080
    s_waitcnt lgkmcnt(12)
    v_mfma_f32_32x32x16_bf16 v[0:15], v[192:195], v[104:107], v[0:15]
    ds_read_b64_tr_b16 v[220:221], v227 offset:45056
    ds_read_b64_tr_b16 v[222:223], v227 offset:46080
    s_waitcnt lgkmcnt(12)
    v_mfma_f32_32x32x16_bf16 v[16:31], v[196:199], v[104:107], v[16:31]
    ds_read_b64_tr_b16 v[192:193], v224 offset:49152
    ds_read_b64_tr_b16 v[194:195], v224 offset:50176
    s_waitcnt lgkmcnt(12)
    v_mfma_f32_32x32x16_bf16 v[32:47], v[200:203], v[104:107], v[32:47]
    ds_read_b64_tr_b16 v[196:197], v225 offset:49152
    ds_read_b64_tr_b16 v[198:199], v225 offset:50176
    s_waitcnt lgkmcnt(12)
    v_mfma_f32_32x32x16_bf16 v[48:63], v[204:207], v[104:107], v[48:63]
    ds_read_b64_tr_b16 v[200:201], v226 offset:49152
    ds_read_b64_tr_b16 v[202:203], v226 offset:50176
    s_waitcnt lgkmcnt(12)
    v_mfma_f32_32x32x16_bf16 v[0:15], v[208:211], v[108:111], v[0:15]
    ds_read_b64_tr_b16 v[204:205], v227 offset:49152
    ds_read_b64_tr_b16 v[206:207], v227 offset:50176
    s_waitcnt lgkmcnt(12)
    v_mfma_f32_32x32x16_bf16 v[16:31], v[212:215], v[108:111], v[16:31]
    ds_read_b64_tr_b16 v[208:209], v224 offset:53248
    ds_read_b64_tr_b16 v[210:211], v224 offset:54272
    s_waitcnt lgkmcnt(12)
    v_mfma_f32_32x32x16_bf16 v[32:47], v[216:219], v[108:111], v[32:47]
    ds_read_b64_tr_b16 v[212:213], v225 offset:53248
    ds_read_b64_tr_b16 v[214:215], v225 offset:54272
    s_waitcnt lgkmcnt(12)
    v_mfma_f32_32x32x16_bf16 v[48:63], v[220:223], v[108:111], v[48:63]
    ds_read_b64_tr_b16 v[216:217], v226 offset:53248
    ds_read_b64_tr_b16 v[218:219], v226 offset:54272
    s_waitcnt lgkmcnt(12)
    v_mfma_f32_32x32x16_bf16 v[0:15], v[192:195], v[112:115], v[0:15]
    ds_read_b64_tr_b16 v[220:221], v227 offset:53248
    ds_read_b64_tr_b16 v[222:223], v227 offset:54272
    s_waitcnt lgkmcnt(12)
    v_mfma_f32_32x32x16_bf16 v[16:31], v[196:199], v[112:115], v[16:31]
    ds_read_b64_tr_b16 v[192:193], v224 offset:57344
    ds_read_b64_tr_b16 v[194:195], v224 offset:58368
    s_waitcnt lgkmcnt(12)
    v_mfma_f32_32x32x16_bf16 v[32:47], v[200:203], v[112:115], v[32:47]
    ds_read_b64_tr_b16 v[196:197], v225 offset:57344
    ds_read_b64_tr_b16 v[198:199], v225 offset:58368
    s_waitcnt lgkmcnt(12)
    v_mfma_f32_32x32x16_bf16 v[48:63], v[204:207], v[112:115], v[48:63]
    ds_read_b64_tr_b16 v[200:201], v226 offset:57344
    ds_read_b64_tr_b16 v[202:203], v226 offset:58368
    s_waitcnt lgkmcnt(12)
    v_mfma_f32_32x32x16_bf16 v[0:15], v[208:211], v[116:119], v[0:15]
    ds_read_b64_tr_b16 v[204:205], v227 offset:57344
    ds_read_b64_tr_b16 v[206:207], v227 offset:58368
    s_waitcnt lgkmcnt(12)
    v_mfma_f32_32x32x16_bf16 v[16:31], v[212:215], v[116:119], v[16:31]
    ds_read_b64_tr_b16 v[208:209], v224 offset:61440
    ds_read_b64_tr_b16 v[210:211], v224 offset:62464
    s_waitcnt lgkmcnt(12)
    v_mfma_f32_32x32x16_bf16 v[32:47], v[216:219], v[116:119], v[32:47]
    ds_read_b64_tr_b16 v[212:213], v225 offset:61440
    ds_read_b64_tr_b16 v[214:215], v225 offset:62464
    s_waitcnt lgkmcnt(12)
    v_mfma_f32_32x32x16_bf16 v[48:63], v[220:223], v[116:119], v[48:63]
    ds_read_b64_tr_b16 v[216:217], v226 offset:61440
    ds_read_b64_tr_b16 v[218:219], v226 offset:62464
    s_waitcnt lgkmcnt(12)
    v_mfma_f32_32x32x16_bf16 v[0:15], v[192:195], v[120:123], v[0:15]
    ds_read_b64_tr_b16 v[220:221], v227 offset:61440
    ds_read_b64_tr_b16 v[222:223], v227 offset:62464
    s_waitcnt lgkmcnt(12)
    v_mfma_f32_32x32x16_bf16 v[16:31], v[196:199], v[120:123], v[16:31]
    s_waitcnt lgkmcnt(10)
    v_mfma_f32_32x32x16_bf16 v[32:47], v[200:203], v[120:123], v[32:47]
    s_waitcnt lgkmcnt(8)
    v_mfma_f32_32x32x16_bf16 v[48:63], v[204:207], v[120:123], v[48:63]
    s_waitcnt lgkmcnt(6)
    v_mfma_f32_32x32x16_bf16 v[0:15], v[208:211], v[124:127], v[0:15]
    s_waitcnt lgkmcnt(4)
    v_mfma_f32_32x32x16_bf16 v[16:31], v[212:215], v[124:127], v[16:31]
    s_waitcnt lgkmcnt(2)
    v_mfma_f32_32x32x16_bf16 v[32:47], v[216:219], v[124:127], v[32:47]
    s_waitcnt lgkmcnt(0)
    v_mfma_f32_32x32x16_bf16 v[48:63], v[220:223], v[124:127], v[48:63]
    s_add_u32 s76, s75, 24576
    s_nop 4
    v_cvt_pk_bf16_f32 v0, v0, v1
    v_cvt_pk_bf16_f32 v1, v2, v3
    v_cvt_pk_bf16_f32 v2, v4, v5
    v_cvt_pk_bf16_f32 v3, v6, v7
    buffer_store_dwordx4 v[0:3], v248, s[60:63], s76 offen offset:0 sc0 sc1
    v_cvt_pk_bf16_f32 v8, v8, v9
    v_cvt_pk_bf16_f32 v9, v10, v11
    v_cvt_pk_bf16_f32 v10, v12, v13
    v_cvt_pk_bf16_f32 v11, v14, v15
    buffer_store_dwordx4 v[8:11], v248, s[60:63], s76 offen offset:1024 sc0 sc1
    v_cvt_pk_bf16_f32 v16, v16, v17
    v_cvt_pk_bf16_f32 v17, v18, v19
    v_cvt_pk_bf16_f32 v18, v20, v21
    v_cvt_pk_bf16_f32 v19, v22, v23
    buffer_store_dwordx4 v[16:19], v248, s[60:63], s76 offen offset:2048 sc0 sc1
    v_cvt_pk_bf16_f32 v24, v24, v25
    v_cvt_pk_bf16_f32 v25, v26, v27
    v_cvt_pk_bf16_f32 v26, v28, v29
    v_cvt_pk_bf16_f32 v27, v30, v31
    buffer_store_dwordx4 v[24:27], v248, s[60:63], s76 offen offset:3072 sc0 sc1
    s_nop 1
    s_add_u32 s76, s75, 28672
    v_cvt_pk_bf16_f32 v32, v32, v33
    v_cvt_pk_bf16_f32 v33, v34, v35
    v_cvt_pk_bf16_f32 v34, v36, v37
    v_cvt_pk_bf16_f32 v35, v38, v39
    buffer_store_dwordx4 v[32:35], v248, s[60:63], s76 offen offset:0 sc0 sc1
    v_cvt_pk_bf16_f32 v40, v40, v41
    v_cvt_pk_bf16_f32 v41, v42, v43
    v_cvt_pk_bf16_f32 v42, v44, v45
    v_cvt_pk_bf16_f32 v43, v46, v47
    buffer_store_dwordx4 v[40:43], v248, s[60:63], s76 offen offset:1024 sc0 sc1
    v_cvt_pk_bf16_f32 v48, v48, v49
    v_cvt_pk_bf16_f32 v49, v50, v51
    v_cvt_pk_bf16_f32 v50, v52, v53
    v_cvt_pk_bf16_f32 v51, v54, v55
    buffer_store_dwordx4 v[48:51], v248, s[60:63], s76 offen offset:2048 sc0 sc1
    v_cvt_pk_bf16_f32 v56, v56, v57
    v_cvt_pk_bf16_f32 v57, v58, v59
    v_cvt_pk_bf16_f32 v58, v60, v61
    v_cvt_pk_bf16_f32 v59, v62, v63
    buffer_store_dwordx4 v[56:59], v248, s[60:63], s76 offen offset:3072 sc0 sc1
L_k1_end:
    s_endpgm
L_rare1_1:
    s_nop 4
    v_mul_f32 v239, s73, v238
    v_max_f32 v239, v239, v240
    v_sub_f32 v243, v240, v239
    v_exp_f32 v243, v243
    v_mov_b32 v240, v239
    s_nop 1
    v_mul_f32 v241, v241, v243
    v_mul_f32 v242, v242, v243
    s_mov_b32 s72, 1
    s_nop 4
    s_branch L_back1_1
L_rare2_1:
    s_nop 15
    s_nop 7
    v_mul_f32 v0, v0, v243
    v_mul_f32 v1, v1, v243
    v_mul_f32 v2, v2, v243
    v_mul_f32 v3, v3, v243
    v_mul_f32 v4, v4, v243
    v_mul_f32 v5, v5, v243
    v_mul_f32 v6, v6, v243
    v_mul_f32 v7, v7, v243
    v_mul_f32 v8, v8, v243
    v_mul_f32 v9, v9, v243
    v_mul_f32 v10, v10, v243
    v_mul_f32 v11, v11, v243
    v_mul_f32 v12, v12, v243
    v_mul_f32 v13, v13, v243
    v_mul_f32 v14, v14, v243
    v_mul_f32 v15, v15, v243
    v_mul_f32 v16, v16, v243
    v_mul_f32 v17, v17, v243
    v_mul_f32 v18, v18, v243
    v_mul_f32 v19, v19, v243
    v_mul_f32 v20, v20, v243
    v_mul_f32 v21, v21, v243
    v_mul_f32 v22, v22, v243
    v_mul_f32 v23, v23, v243
    v_mul_f32 v24, v24, v243
    v_mul_f32 v25, v25, v243
    v_mul_f32 v26, v26, v243
    v_mul_f32 v27, v27, v243
    v_mul_f32 v28, v28, v243
    v_mul_f32 v29, v29, v243
    v_mul_f32 v30, v30, v243
    v_mul_f32 v31, v31, v243
    v_mul_f32 v32, v32, v243
    v_mul_f32 v33, v33, v243
    v_mul_f32 v34, v34, v243
    v_mul_f32 v35, v35, v243
    v_mul_f32 v36, v36, v243
    v_mul_f32 v37, v37, v243
    v_mul_f32 v38, v38, v243
    v_mul_f32 v39, v39, v243
    v_mul_f32 v40, v40, v243
    v_mul_f32 v41, v41, v243
    v_mul_f32 v42, v42, v243
    v_mul_f32 v43, v43, v243
    v_mul_f32 v44, v44, v243
    v_mul_f32 v45, v45, v243
    v_mul_f32 v46, v46, v243
    v_mul_f32 v47, v47, v243
    v_mul_f32 v48, v48, v243
    v_mul_f32 v49, v49, v243
    v_mul_f32 v50, v50, v243
    v_mul_f32 v51, v51, v243
    v_mul_f32 v52, v52, v243
    v_mul_f32 v53, v53, v243
    v_mul_f32 v54, v54, v243
    v_mul_f32 v55, v55, v243
    v_mul_f32 v56, v56, v243
    v_mul_f32 v57, v57, v243
    v_mul_f32 v58, v58, v243
    v_mul_f32 v59, v59, v243
    v_mul_f32 v60, v60, v243
    v_mul_f32 v61, v61, v243
    v_mul_f32 v62, v62, v243
    v_mul_f32 v63, v63, v243
    s_mov_b32 s72, 0
    s_nop 7
    s_branch L_back2_1
L_rare1_2:
    s_nop 4
    v_mul_f32 v239, s73, v238
    v_max_f32 v239, v239, v240
    v_sub_f32 v243, v240, v239
    v_exp_f32 v243, v243
    v_mov_b32 v240, v239
    s_nop 1
    v_mul_f32 v241, v241, v243
    v_mul_f32 v242, v242, v243
    s_mov_b32 s72, 1
    s_nop 4
    s_branch L_back1_2
L_rare2_2:
    s_nop 15
    s_nop 7
    v_mul_f32 v0, v0, v243
    v_mul_f32 v1, v1, v243
    v_mul_f32 v2, v2, v243
    v_mul_f32 v3, v3, v243
    v_mul_f32 v4, v4, v243
    v_mul_f32 v5, v5, v243
    v_mul_f32 v6, v6, v243
    v_mul_f32 v7, v7, v243
    v_mul_f32 v8, v8, v243
    v_mul_f32 v9, v9, v243
    v_mul_f32 v10, v10, v243
    v_mul_f32 v11, v11, v243
    v_mul_f32 v12, v12, v243
    v_mul_f32 v13, v13, v243
    v_mul_f32 v14, v14, v243
    v_mul_f32 v15, v15, v243
    v_mul_f32 v16, v16, v243
    v_mul_f32 v17, v17, v243
    v_mul_f32 v18, v18, v243
    v_mul_f32 v19, v19, v243
    v_mul_f32 v20, v20, v243
    v_mul_f32 v21, v21, v243
    v_mul_f32 v22, v22, v243
    v_mul_f32 v23, v23, v243
    v_mul_f32 v24, v24, v243
    v_mul_f32 v25, v25, v243
    v_mul_f32 v26, v26, v243
    v_mul_f32 v27, v27, v243
    v_mul_f32 v28, v28, v243
    v_mul_f32 v29, v29, v243
    v_mul_f32 v30, v30, v243
    v_mul_f32 v31, v31, v243
    v_mul_f32 v32, v32, v243
    v_mul_f32 v33, v33, v243
    v_mul_f32 v34, v34, v243
    v_mul_f32 v35, v35, v243
    v_mul_f32 v36, v36, v243
    v_mul_f32 v37, v37, v243
    v_mul_f32 v38, v38, v243
    v_mul_f32 v39, v39, v243
    v_mul_f32 v40, v40, v243
    v_mul_f32 v41, v41, v243
    v_mul_f32 v42, v42, v243
    v_mul_f32 v43, v43, v243
    v_mul_f32 v44, v44, v243
    v_mul_f32 v45, v45, v243
    v_mul_f32 v46, v46, v243
    v_mul_f32 v47, v47, v243
    v_mul_f32 v48, v48, v243
    v_mul_f32 v49, v49, v243
    v_mul_f32 v50, v50, v243
    v_mul_f32 v51, v51, v243
    v_mul_f32 v52, v52, v243
    v_mul_f32 v53, v53, v243
    v_mul_f32 v54, v54, v243
    v_mul_f32 v55, v55, v243
    v_mul_f32 v56, v56, v243
    v_mul_f32 v57, v57, v243
    v_mul_f32 v58, v58, v243
    v_mul_f32 v59, v59, v243
    v_mul_f32 v60, v60, v243
    v_mul_f32 v61, v61, v243
    v_mul_f32 v62, v62, v243
    v_mul_f32 v63, v63, v243
    s_mov_b32 s72, 0
    s_nop 7
    s_branch L_back2_2
L_rare1_3:
    s_nop 4
    v_mul_f32 v239, s73, v238
    v_max_f32 v239, v239, v240
    v_sub_f32 v243, v240, v239
    v_exp_f32 v243, v243
    v_mov_b32 v240, v239
    s_nop 1
    v_mul_f32 v241, v241, v243
    v_mul_f32 v242, v242, v243
    s_mov_b32 s72, 1
    s_nop 4
    s_branch L_back1_3
L_rare2_3:
    s_nop 15
    s_nop 7
    v_mul_f32 v0, v0, v243
    v_mul_f32 v1, v1, v243
    v_mul_f32 v2, v2, v243
    v_mul_f32 v3, v3, v243
    v_mul_f32 v4, v4, v243
    v_mul_f32 v5, v5, v243
    v_mul_f32 v6, v6, v243
    v_mul_f32 v7, v7, v243
    v_mul_f32 v8, v8, v243
    v_mul_f32 v9, v9, v243
    v_mul_f32 v10, v10, v243
    v_mul_f32 v11, v11, v243
    v_mul_f32 v12, v12, v243
    v_mul_f32 v13, v13, v243
    v_mul_f32 v14, v14, v243
    v_mul_f32 v15, v15, v243
    v_mul_f32 v16, v16, v243
    v_mul_f32 v17, v17, v243
    v_mul_f32 v18, v18, v243
    v_mul_f32 v19, v19, v243
    v_mul_f32 v20, v20, v243
    v_mul_f32 v21, v21, v243
    v_mul_f32 v22, v22, v243
    v_mul_f32 v23, v23, v243
    v_mul_f32 v24, v24, v243
    v_mul_f32 v25, v25, v243
    v_mul_f32 v26, v26, v243
    v_mul_f32 v27, v27, v243
    v_mul_f32 v28, v28, v243
    v_mul_f32 v29, v29, v243
    v_mul_f32 v30, v30, v243
    v_mul_f32 v31, v31, v243
    v_mul_f32 v32, v32, v243
    v_mul_f32 v33, v33, v243
    v_mul_f32 v34, v34, v243
    v_mul_f32 v35, v35, v243
    v_mul_f32 v36, v36, v243
    v_mul_f32 v37, v37, v243
    v_mul_f32 v38, v38, v243
    v_mul_f32 v39, v39, v243
    v_mul_f32 v40, v40, v243
    v_mul_f32 v41, v41, v243
    v_mul_f32 v42, v42, v243
    v_mul_f32 v43, v43, v243
    v_mul_f32 v44, v44, v243
    v_mul_f32 v45, v45, v243
    v_mul_f32 v46, v46, v243
    v_mul_f32 v47, v47, v243
    v_mul_f32 v48, v48, v243
    v_mul_f32 v49, v49, v243
    v_mul_f32 v50, v50, v243
    v_mul_f32 v51, v51, v243
    v_mul_f32 v52, v52, v243
    v_mul_f32 v53, v53, v243
    v_mul_f32 v54, v54, v243
    v_mul_f32 v55, v55, v243
    v_mul_f32 v56, v56, v243
    v_mul_f32 v57, v57, v243
    v_mul_f32 v58, v58, v243
    v_mul_f32 v59, v59, v243
    v_mul_f32 v60, v60, v243
    v_mul_f32 v61, v61, v243
    v_mul_f32 v62, v62, v243
    v_mul_f32 v63, v63, v243
    s_mov_b32 s72, 0
    s_nop 7
    s_branch L_back2_3
L_rare1_4:
    s_nop 4
    v_mul_f32 v239, s73, v238
    v_max_f32 v239, v239, v240
    v_sub_f32 v243, v240, v239
    v_exp_f32 v243, v243
    v_mov_b32 v240, v239
    s_nop 1
    v_mul_f32 v241, v241, v243
    v_mul_f32 v242, v242, v243
    s_mov_b32 s72, 1
    s_nop 4
    s_branch L_back1_4
L_rare2_4:
    s_nop 15
    s_nop 7
    v_mul_f32 v0, v0, v243
    v_mul_f32 v1, v1, v243
    v_mul_f32 v2, v2, v243
    v_mul_f32 v3, v3, v243
    v_mul_f32 v4, v4, v243
    v_mul_f32 v5, v5, v243
    v_mul_f32 v6, v6, v243
    v_mul_f32 v7, v7, v243
    v_mul_f32 v8, v8, v243
    v_mul_f32 v9, v9, v243
    v_mul_f32 v10, v10, v243
    v_mul_f32 v11, v11, v243
    v_mul_f32 v12, v12, v243
    v_mul_f32 v13, v13, v243
    v_mul_f32 v14, v14, v243
    v_mul_f32 v15, v15, v243
    v_mul_f32 v16, v16, v243
    v_mul_f32 v17, v17, v243
    v_mul_f32 v18, v18, v243
    v_mul_f32 v19, v19, v243
    v_mul_f32 v20, v20, v243
    v_mul_f32 v21, v21, v243
    v_mul_f32 v22, v22, v243
    v_mul_f32 v23, v23, v243
    v_mul_f32 v24, v24, v243
    v_mul_f32 v25, v25, v243
    v_mul_f32 v26, v26, v243
    v_mul_f32 v27, v27, v243
    v_mul_f32 v28, v28, v243
    v_mul_f32 v29, v29, v243
    v_mul_f32 v30, v30, v243
    v_mul_f32 v31, v31, v243
    v_mul_f32 v32, v32, v243
    v_mul_f32 v33, v33, v243
    v_mul_f32 v34, v34, v243
    v_mul_f32 v35, v35, v243
    v_mul_f32 v36, v36, v243
    v_mul_f32 v37, v37, v243
    v_mul_f32 v38, v38, v243
    v_mul_f32 v39, v39, v243
    v_mul_f32 v40, v40, v243
    v_mul_f32 v41, v41, v243
    v_mul_f32 v42, v42, v243
    v_mul_f32 v43, v43, v243
    v_mul_f32 v44, v44, v243
    v_mul_f32 v45, v45, v243
    v_mul_f32 v46, v46, v243
    v_mul_f32 v47, v47, v243
    v_mul_f32 v48, v48, v243
    v_mul_f32 v49, v49, v243
    v_mul_f32 v50, v50, v243
    v_mul_f32 v51, v51, v243
    v_mul_f32 v52, v52, v243
    v_mul_f32 v53, v53, v243
    v_mul_f32 v54, v54, v243
    v_mul_f32 v55, v55, v243
    v_mul_f32 v56, v56, v243
    v_mul_f32 v57, v57, v243
    v_mul_f32 v58, v58, v243
    v_mul_f32 v59, v59, v243
    v_mul_f32 v60, v60, v243
    v_mul_f32 v61, v61, v243
    v_mul_f32 v62, v62, v243
    v_mul_f32 v63, v63, v243
    s_mov_b32 s72, 0
    s_nop 7
    s_branch L_back2_4
L_rare1_5:
    s_nop 4
    v_mul_f32 v239, s73, v238
    v_max_f32 v239, v239, v240
    v_sub_f32 v243, v240, v239
    v_exp_f32 v243, v243
    v_mov_b32 v240, v239
    s_nop 1
    v_mul_f32 v241, v241, v243
    v_mul_f32 v242, v242, v243
    s_mov_b32 s72, 1
    s_nop 4
    s_branch L_back1_5
L_rare2_5:
    s_nop 15
    s_nop 7
    v_mul_f32 v0, v0, v243
    v_mul_f32 v1, v1, v243
    v_mul_f32 v2, v2, v243
    v_mul_f32 v3, v3, v243
    v_mul_f32 v4, v4, v243
    v_mul_f32 v5, v5, v243
    v_mul_f32 v6, v6, v243
    v_mul_f32 v7, v7, v243
    v_mul_f32 v8, v8, v243
    v_mul_f32 v9, v9, v243
    v_mul_f32 v10, v10, v243
    v_mul_f32 v11, v11, v243
    v_mul_f32 v12, v12, v243
    v_mul_f32 v13, v13, v243
    v_mul_f32 v14, v14, v243
    v_mul_f32 v15, v15, v243
    v_mul_f32 v16, v16, v243
    v_mul_f32 v17, v17, v243
    v_mul_f32 v18, v18, v243
    v_mul_f32 v19, v19, v243
    v_mul_f32 v20, v20, v243
    v_mul_f32 v21, v21, v243
    v_mul_f32 v22, v22, v243
    v_mul_f32 v23, v23, v243
    v_mul_f32 v24, v24, v243
    v_mul_f32 v25, v25, v243
    v_mul_f32 v26, v26, v243
    v_mul_f32 v27, v27, v243
    v_mul_f32 v28, v28, v243
    v_mul_f32 v29, v29, v243
    v_mul_f32 v30, v30, v243
    v_mul_f32 v31, v31, v243
    v_mul_f32 v32, v32, v243
    v_mul_f32 v33, v33, v243
    v_mul_f32 v34, v34, v243
    v_mul_f32 v35, v35, v243
    v_mul_f32 v36, v36, v243
    v_mul_f32 v37, v37, v243
    v_mul_f32 v38, v38, v243
    v_mul_f32 v39, v39, v243
    v_mul_f32 v40, v40, v243
    v_mul_f32 v41, v41, v243
    v_mul_f32 v42, v42, v243
    v_mul_f32 v43, v43, v243
    v_mul_f32 v44, v44, v243
    v_mul_f32 v45, v45, v243
    v_mul_f32 v46, v46, v243
    v_mul_f32 v47, v47, v243
    v_mul_f32 v48, v48, v243
    v_mul_f32 v49, v49, v243
    v_mul_f32 v50, v50, v243
    v_mul_f32 v51, v51, v243
    v_mul_f32 v52, v52, v243
    v_mul_f32 v53, v53, v243
    v_mul_f32 v54, v54, v243
    v_mul_f32 v55, v55, v243
    v_mul_f32 v56, v56, v243
    v_mul_f32 v57, v57, v243
    v_mul_f32 v58, v58, v243
    v_mul_f32 v59, v59, v243
    v_mul_f32 v60, v60, v243
    v_mul_f32 v61, v61, v243
    v_mul_f32 v62, v62, v243
    v_mul_f32 v63, v63, v243
    s_mov_b32 s72, 0
    s_nop 7
    s_branch L_back2_5
L_rare1_6:
    s_nop 4
    v_mul_f32 v239, s73, v238
    v_max_f32 v239, v239, v240
    v_sub_f32 v243, v240, v239
    v_exp_f32 v243, v243
    v_mov_b32 v240, v239
    s_nop 1
    v_mul_f32 v241, v241, v243
    v_mul_f32 v242, v242, v243
    s_mov_b32 s72, 1
    s_nop 4
    s_branch L_back1_6
L_rare2_6:
    s_nop 15
    s_nop 7
    v_mul_f32 v0, v0, v243
    v_mul_f32 v1, v1, v243
    v_mul_f32 v2, v2, v243
    v_mul_f32 v3, v3, v243
    v_mul_f32 v4, v4, v243
    v_mul_f32 v5, v5, v243
    v_mul_f32 v6, v6, v243
    v_mul_f32 v7, v7, v243
    v_mul_f32 v8, v8, v243
    v_mul_f32 v9, v9, v243
    v_mul_f32 v10, v10, v243
    v_mul_f32 v11, v11, v243
    v_mul_f32 v12, v12, v243
    v_mul_f32 v13, v13, v243
    v_mul_f32 v14, v14, v243
    v_mul_f32 v15, v15, v243
    v_mul_f32 v16, v16, v243
    v_mul_f32 v17, v17, v243
    v_mul_f32 v18, v18, v243
    v_mul_f32 v19, v19, v243
    v_mul_f32 v20, v20, v243
    v_mul_f32 v21, v21, v243
    v_mul_f32 v22, v22, v243
    v_mul_f32 v23, v23, v243
    v_mul_f32 v24, v24, v243
    v_mul_f32 v25, v25, v243
    v_mul_f32 v26, v26, v243
    v_mul_f32 v27, v27, v243
    v_mul_f32 v28, v28, v243
    v_mul_f32 v29, v29, v243
    v_mul_f32 v30, v30, v243
    v_mul_f32 v31, v31, v243
    v_mul_f32 v32, v32, v243
    v_mul_f32 v33, v33, v243
    v_mul_f32 v34, v34, v243
    v_mul_f32 v35, v35, v243
    v_mul_f32 v36, v36, v243
    v_mul_f32 v37, v37, v243
    v_mul_f32 v38, v38, v243
    v_mul_f32 v39, v39, v243
    v_mul_f32 v40, v40, v243
    v_mul_f32 v41, v41, v243
    v_mul_f32 v42, v42, v243
    v_mul_f32 v43, v43, v243
    v_mul_f32 v44, v44, v243
    v_mul_f32 v45, v45, v243
    v_mul_f32 v46, v46, v243
    v_mul_f32 v47, v47, v243
    v_mul_f32 v48, v48, v243
    v_mul_f32 v49, v49, v243
    v_mul_f32 v50, v50, v243
    v_mul_f32 v51, v51, v243
    v_mul_f32 v52, v52, v243
    v_mul_f32 v53, v53, v243
    v_mul_f32 v54, v54, v243
    v_mul_f32 v55, v55, v243
    v_mul_f32 v56, v56, v243
    v_mul_f32 v57, v57, v243
    v_mul_f32 v58, v58, v243
    v_mul_f32 v59, v59, v243
    v_mul_f32 v60, v60, v243
    v_mul_f32 v61, v61, v243
    v_mul_f32 v62, v62, v243
    v_mul_f32 v63, v63, v243
    s_mov_b32 s72, 0
    s_nop 7
    s_branch L_back2_6
L_rare1_7:
    s_nop 4
    v_mul_f32 v239, s73, v238
    v_max_f32 v239, v239, v240
    v_sub_f32 v243, v240, v239
    v_exp_f32 v243, v243
    v_mov_b32 v240, v239
    s_nop 1
    v_mul_f32 v241, v241, v243
    v_mul_f32 v242, v242, v243
    s_mov_b32 s72, 1
    s_nop 4
    s_branch L_back1_7
L_rare2_7:
    s_nop 15
    s_nop 7
    v_mul_f32 v0, v0, v243
    v_mul_f32 v1, v1, v243
    v_mul_f32 v2, v2, v243
    v_mul_f32 v3, v3, v243
    v_mul_f32 v4, v4, v243
    v_mul_f32 v5, v5, v243
    v_mul_f32 v6, v6, v243
    v_mul_f32 v7, v7, v243
    v_mul_f32 v8, v8, v243
    v_mul_f32 v9, v9, v243
    v_mul_f32 v10, v10, v243
    v_mul_f32 v11, v11, v243
    v_mul_f32 v12, v12, v243
    v_mul_f32 v13, v13, v243
    v_mul_f32 v14, v14, v243
    v_mul_f32 v15, v15, v243
    v_mul_f32 v16, v16, v243
    v_mul_f32 v17, v17, v243
    v_mul_f32 v18, v18, v243
    v_mul_f32 v19, v19, v243
    v_mul_f32 v20, v20, v243
    v_mul_f32 v21, v21, v243
    v_mul_f32 v22, v22, v243
    v_mul_f32 v23, v23, v243
    v_mul_f32 v24, v24, v243
    v_mul_f32 v25, v25, v243
    v_mul_f32 v26, v26, v243
    v_mul_f32 v27, v27, v243
    v_mul_f32 v28, v28, v243
    v_mul_f32 v29, v29, v243
    v_mul_f32 v30, v30, v243
    v_mul_f32 v31, v31, v243
    v_mul_f32 v32, v32, v243
    v_mul_f32 v33, v33, v243
    v_mul_f32 v34, v34, v243
    v_mul_f32 v35, v35, v243
    v_mul_f32 v36, v36, v243
    v_mul_f32 v37, v37, v243
    v_mul_f32 v38, v38, v243
    v_mul_f32 v39, v39, v243
    v_mul_f32 v40, v40, v243
    v_mul_f32 v41, v41, v243
    v_mul_f32 v42, v42, v243
    v_mul_f32 v43, v43, v243
    v_mul_f32 v44, v44, v243
    v_mul_f32 v45, v45, v243
    v_mul_f32 v46, v46, v243
    v_mul_f32 v47, v47, v243
    v_mul_f32 v48, v48, v243
    v_mul_f32 v49, v49, v243
    v_mul_f32 v50, v50, v243
    v_mul_f32 v51, v51, v243
    v_mul_f32 v52, v52, v243
    v_mul_f32 v53, v53, v243
    v_mul_f32 v54, v54, v243
    v_mul_f32 v55, v55, v243
    v_mul_f32 v56, v56, v243
    v_mul_f32 v57, v57, v243
    v_mul_f32 v58, v58, v243
    v_mul_f32 v59, v59, v243
    v_mul_f32 v60, v60, v243
    v_mul_f32 v61, v61, v243
    v_mul_f32 v62, v62, v243
    v_mul_f32 v63, v63, v243
    s_mov_b32 s72, 0
    s_nop 7
    s_branch L_back2_7
L_rare1_9:
    s_nop 4
    v_mul_f32 v239, s73, v238
    v_max_f32 v239, v239, v240
    v_sub_f32 v243, v240, v239
    v_exp_f32 v243, v243
    v_mov_b32 v240, v239
    s_nop 1
    v_mul_f32 v241, v241, v243
    v_mul_f32 v242, v242, v243
    s_mov_b32 s72, 1
    s_nop 4
    s_branch L_back1_9
L_rare2_9:
    s_nop 15
    s_nop 7
    v_mul_f32 v0, v0, v243
    v_mul_f32 v1, v1, v243
    v_mul_f32 v2, v2, v243
    v_mul_f32 v3, v3, v243
    v_mul_f32 v4, v4, v243
    v_mul_f32 v5, v5, v243
    v_mul_f32 v6, v6, v243
    v_mul_f32 v7, v7, v243
    v_mul_f32 v8, v8, v243
    v_mul_f32 v9, v9, v243
    v_mul_f32 v10, v10, v243
    v_mul_f32 v11, v11, v243
    v_mul_f32 v12, v12, v243
    v_mul_f32 v13, v13, v243
    v_mul_f32 v14, v14, v243
    v_mul_f32 v15, v15, v243
    v_mul_f32 v16, v16, v243
    v_mul_f32 v17, v17, v243
    v_mul_f32 v18, v18, v243
    v_mul_f32 v19, v19, v243
    v_mul_f32 v20, v20, v243
    v_mul_f32 v21, v21, v243
    v_mul_f32 v22, v22, v243
    v_mul_f32 v23, v23, v243
    v_mul_f32 v24, v24, v243
    v_mul_f32 v25, v25, v243
    v_mul_f32 v26, v26, v243
    v_mul_f32 v27, v27, v243
    v_mul_f32 v28, v28, v243
    v_mul_f32 v29, v29, v243
    v_mul_f32 v30, v30, v243
    v_mul_f32 v31, v31, v243
    v_mul_f32 v32, v32, v243
    v_mul_f32 v33, v33, v243
    v_mul_f32 v34, v34, v243
    v_mul_f32 v35, v35, v243
    v_mul_f32 v36, v36, v243
    v_mul_f32 v37, v37, v243
    v_mul_f32 v38, v38, v243
    v_mul_f32 v39, v39, v243
    v_mul_f32 v40, v40, v243
    v_mul_f32 v41, v41, v243
    v_mul_f32 v42, v42, v243
    v_mul_f32 v43, v43, v243
    v_mul_f32 v44, v44, v243
    v_mul_f32 v45, v45, v243
    v_mul_f32 v46, v46, v243
    v_mul_f32 v47, v47, v243
    v_mul_f32 v48, v48, v243
    v_mul_f32 v49, v49, v243
    v_mul_f32 v50, v50, v243
    v_mul_f32 v51, v51, v243
    v_mul_f32 v52, v52, v243
    v_mul_f32 v53, v53, v243
    v_mul_f32 v54, v54, v243
    v_mul_f32 v55, v55, v243
    v_mul_f32 v56, v56, v243
    v_mul_f32 v57, v57, v243
    v_mul_f32 v58, v58, v243
    v_mul_f32 v59, v59, v243
    v_mul_f32 v60, v60, v243
    v_mul_f32 v61, v61, v243
    v_mul_f32 v62, v62, v243
    v_mul_f32 v63, v63, v243
    s_mov_b32 s72, 0
    s_nop 7
    s_branch L_back2_9
L_rare1_10:
    s_nop 4
    v_mul_f32 v239, s73, v238
    v_max_f32 v239, v239, v240
    v_sub_f32 v243, v240, v239
    v_exp_f32 v243, v243
    v_mov_b32 v240, v239
    s_nop 1
    v_mul_f32 v241, v241, v243
    v_mul_f32 v242, v242, v243
    s_mov_b32 s72, 1
    s_nop 4
    s_branch L_back1_10
L_rare2_10:
    s_nop 15
    s_nop 7
    v_mul_f32 v0, v0, v243
    v_mul_f32 v1, v1, v243
    v_mul_f32 v2, v2, v243
    v_mul_f32 v3, v3, v243
    v_mul_f32 v4, v4, v243
    v_mul_f32 v5, v5, v243
    v_mul_f32 v6, v6, v243
    v_mul_f32 v7, v7, v243
    v_mul_f32 v8, v8, v243
    v_mul_f32 v9, v9, v243
    v_mul_f32 v10, v10, v243
    v_mul_f32 v11, v11, v243
    v_mul_f32 v12, v12, v243
    v_mul_f32 v13, v13, v243
    v_mul_f32 v14, v14, v243
    v_mul_f32 v15, v15, v243
    v_mul_f32 v16, v16, v243
    v_mul_f32 v17, v17, v243
    v_mul_f32 v18, v18, v243
    v_mul_f32 v19, v19, v243
    v_mul_f32 v20, v20, v243
    v_mul_f32 v21, v21, v243
    v_mul_f32 v22, v22, v243
    v_mul_f32 v23, v23, v243
    v_mul_f32 v24, v24, v243
    v_mul_f32 v25, v25, v243
    v_mul_f32 v26, v26, v243
    v_mul_f32 v27, v27, v243
    v_mul_f32 v28, v28, v243
    v_mul_f32 v29, v29, v243
    v_mul_f32 v30, v30, v243
    v_mul_f32 v31, v31, v243
    v_mul_f32 v32, v32, v243
    v_mul_f32 v33, v33, v243
    v_mul_f32 v34, v34, v243
    v_mul_f32 v35, v35, v243
    v_mul_f32 v36, v36, v243
    v_mul_f32 v37, v37, v243
    v_mul_f32 v38, v38, v243
    v_mul_f32 v39, v39, v243
    v_mul_f32 v40, v40, v243
    v_mul_f32 v41, v41, v243
    v_mul_f32 v42, v42, v243
    v_mul_f32 v43, v43, v243
    v_mul_f32 v44, v44, v243
    v_mul_f32 v45, v45, v243
    v_mul_f32 v46, v46, v243
    v_mul_f32 v47, v47, v243
    v_mul_f32 v48, v48, v243
    v_mul_f32 v49, v49, v243
    v_mul_f32 v50, v50, v243
    v_mul_f32 v51, v51, v243
    v_mul_f32 v52, v52, v243
    v_mul_f32 v53, v53, v243
    v_mul_f32 v54, v54, v243
    v_mul_f32 v55, v55, v243
    v_mul_f32 v56, v56, v243
    v_mul_f32 v57, v57, v243
    v_mul_f32 v58, v58, v243
    v_mul_f32 v59, v59, v243
    v_mul_f32 v60, v60, v243
    v_mul_f32 v61, v61, v243
    v_mul_f32 v62, v62, v243
    v_mul_f32 v63, v63, v243
    s_mov_b32 s72, 0
    s_nop 7
    s_branch L_back2_10
L_rare1_11:
    s_nop 4
    v_mul_f32 v239, s73, v238
    v_max_f32 v239, v239, v240
    v_sub_f32 v243, v240, v239
    v_exp_f32 v243, v243
    v_mov_b32 v240, v239
    s_nop 1
    v_mul_f32 v241, v241, v243
    v_mul_f32 v242, v242, v243
    s_mov_b32 s72, 1
    s_nop 4
    s_branch L_back1_11
L_rare2_11:
    s_nop 15
    s_nop 7
    v_mul_f32 v0, v0, v243
    v_mul_f32 v1, v1, v243
    v_mul_f32 v2, v2, v243
    v_mul_f32 v3, v3, v243
    v_mul_f32 v4, v4, v243
    v_mul_f32 v5, v5, v243
    v_mul_f32 v6, v6, v243
    v_mul_f32 v7, v7, v243
    v_mul_f32 v8, v8, v243
    v_mul_f32 v9, v9, v243
    v_mul_f32 v10, v10, v243
    v_mul_f32 v11, v11, v243
    v_mul_f32 v12, v12, v243
    v_mul_f32 v13, v13, v243
    v_mul_f32 v14, v14, v243
    v_mul_f32 v15, v15, v243
    v_mul_f32 v16, v16, v243
    v_mul_f32 v17, v17, v243
    v_mul_f32 v18, v18, v243
    v_mul_f32 v19, v19, v243
    v_mul_f32 v20, v20, v243
    v_mul_f32 v21, v21, v243
    v_mul_f32 v22, v22, v243
    v_mul_f32 v23, v23, v243
    v_mul_f32 v24, v24, v243
    v_mul_f32 v25, v25, v243
    v_mul_f32 v26, v26, v243
    v_mul_f32 v27, v27, v243
    v_mul_f32 v28, v28, v243
    v_mul_f32 v29, v29, v243
    v_mul_f32 v30, v30, v243
    v_mul_f32 v31, v31, v243
    v_mul_f32 v32, v32, v243
    v_mul_f32 v33, v33, v243
    v_mul_f32 v34, v34, v243
    v_mul_f32 v35, v35, v243
    v_mul_f32 v36, v36, v243
    v_mul_f32 v37, v37, v243
    v_mul_f32 v38, v38, v243
    v_mul_f32 v39, v39, v243
    v_mul_f32 v40, v40, v243
    v_mul_f32 v41, v41, v243
    v_mul_f32 v42, v42, v243
    v_mul_f32 v43, v43, v243
    v_mul_f32 v44, v44, v243
    v_mul_f32 v45, v45, v243
    v_mul_f32 v46, v46, v243
    v_mul_f32 v47, v47, v243
    v_mul_f32 v48, v48, v243
    v_mul_f32 v49, v49, v243
    v_mul_f32 v50, v50, v243
    v_mul_f32 v51, v51, v243
    v_mul_f32 v52, v52, v243
    v_mul_f32 v53, v53, v243
    v_mul_f32 v54, v54, v243
    v_mul_f32 v55, v55, v243
    v_mul_f32 v56, v56, v243
    v_mul_f32 v57, v57, v243
    v_mul_f32 v58, v58, v243
    v_mul_f32 v59, v59, v243
    v_mul_f32 v60, v60, v243
    v_mul_f32 v61, v61, v243
    v_mul_f32 v62, v62, v243
    v_mul_f32 v63, v63, v243
    s_mov_b32 s72, 0
    s_nop 7
    s_branch L_back2_11
L_rare1_12:
    s_nop 4
    v_mul_f32 v239, s73, v238
    v_max_f32 v239, v239, v240
    v_sub_f32 v243, v240, v239
    v_exp_f32 v243, v243
    v_mov_b32 v240, v239
    s_nop 1
    v_mul_f32 v241, v241, v243
    v_mul_f32 v242, v242, v243
    s_mov_b32 s72, 1
    s_nop 4
    s_branch L_back1_12
L_rare2_12:
    s_nop 15
    s_nop 7
    v_mul_f32 v0, v0, v243
    v_mul_f32 v1, v1, v243
    v_mul_f32 v2, v2, v243
    v_mul_f32 v3, v3, v243
    v_mul_f32 v4, v4, v243
    v_mul_f32 v5, v5, v243
    v_mul_f32 v6, v6, v243
    v_mul_f32 v7, v7, v243
    v_mul_f32 v8, v8, v243
    v_mul_f32 v9, v9, v243
    v_mul_f32 v10, v10, v243
    v_mul_f32 v11, v11, v243
    v_mul_f32 v12, v12, v243
    v_mul_f32 v13, v13, v243
    v_mul_f32 v14, v14, v243
    v_mul_f32 v15, v15, v243
    v_mul_f32 v16, v16, v243
    v_mul_f32 v17, v17, v243
    v_mul_f32 v18, v18, v243
    v_mul_f32 v19, v19, v243
    v_mul_f32 v20, v20, v243
    v_mul_f32 v21, v21, v243
    v_mul_f32 v22, v22, v243
    v_mul_f32 v23, v23, v243
    v_mul_f32 v24, v24, v243
    v_mul_f32 v25, v25, v243
    v_mul_f32 v26, v26, v243
    v_mul_f32 v27, v27, v243
    v_mul_f32 v28, v28, v243
    v_mul_f32 v29, v29, v243
    v_mul_f32 v30, v30, v243
    v_mul_f32 v31, v31, v243
    v_mul_f32 v32, v32, v243
    v_mul_f32 v33, v33, v243
    v_mul_f32 v34, v34, v243
    v_mul_f32 v35, v35, v243
    v_mul_f32 v36, v36, v243
    v_mul_f32 v37, v37, v243
    v_mul_f32 v38, v38, v243
    v_mul_f32 v39, v39, v243
    v_mul_f32 v40, v40, v243
    v_mul_f32 v41, v41, v243
    v_mul_f32 v42, v42, v243
    v_mul_f32 v43, v43, v243
    v_mul_f32 v44, v44, v243
    v_mul_f32 v45, v45, v243
    v_mul_f32 v46, v46, v243
    v_mul_f32 v47, v47, v243
    v_mul_f32 v48, v48, v243
    v_mul_f32 v49, v49, v243
    v_mul_f32 v50, v50, v243
    v_mul_f32 v51, v51, v243
    v_mul_f32 v52, v52, v243
    v_mul_f32 v53, v53, v243
    v_mul_f32 v54, v54, v243
    v_mul_f32 v55, v55, v243
    v_mul_f32 v56, v56, v243
    v_mul_f32 v57, v57, v243
    v_mul_f32 v58, v58, v243
    v_mul_f32 v59, v59, v243
    v_mul_f32 v60, v60, v243
    v_mul_f32 v61, v61, v243
    v_mul_f32 v62, v62, v243
    v_mul_f32 v63, v63, v243
    s_mov_b32 s72, 0
    s_nop 7
    s_branch L_back2_12
L_rare1_13:
    s_nop 4
    v_mul_f32 v239, s73, v238
    v_max_f32 v239, v239, v240
    v_sub_f32 v243, v240, v239
    v_exp_f32 v243, v243
    v_mov_b32 v240, v239
    s_nop 1
    v_mul_f32 v241, v241, v243
    v_mul_f32 v242, v242, v243
    s_mov_b32 s72, 1
    s_nop 4
    s_branch L_back1_13
L_rare2_13:
    s_nop 15
    s_nop 7
    v_mul_f32 v0, v0, v243
    v_mul_f32 v1, v1, v243
    v_mul_f32 v2, v2, v243
    v_mul_f32 v3, v3, v243
    v_mul_f32 v4, v4, v243
    v_mul_f32 v5, v5, v243
    v_mul_f32 v6, v6, v243
    v_mul_f32 v7, v7, v243
    v_mul_f32 v8, v8, v243
    v_mul_f32 v9, v9, v243
    v_mul_f32 v10, v10, v243
    v_mul_f32 v11, v11, v243
    v_mul_f32 v12, v12, v243
    v_mul_f32 v13, v13, v243
    v_mul_f32 v14, v14, v243
    v_mul_f32 v15, v15, v243
    v_mul_f32 v16, v16, v243
    v_mul_f32 v17, v17, v243
    v_mul_f32 v18, v18, v243
    v_mul_f32 v19, v19, v243
    v_mul_f32 v20, v20, v243
    v_mul_f32 v21, v21, v243
    v_mul_f32 v22, v22, v243
    v_mul_f32 v23, v23, v243
    v_mul_f32 v24, v24, v243
    v_mul_f32 v25, v25, v243
    v_mul_f32 v26, v26, v243
    v_mul_f32 v27, v27, v243
    v_mul_f32 v28, v28, v243
    v_mul_f32 v29, v29, v243
    v_mul_f32 v30, v30, v243
    v_mul_f32 v31, v31, v243
    v_mul_f32 v32, v32, v243
    v_mul_f32 v33, v33, v243
    v_mul_f32 v34, v34, v243
    v_mul_f32 v35, v35, v243
    v_mul_f32 v36, v36, v243
    v_mul_f32 v37, v37, v243
    v_mul_f32 v38, v38, v243
    v_mul_f32 v39, v39, v243
    v_mul_f32 v40, v40, v243
    v_mul_f32 v41, v41, v243
    v_mul_f32 v42, v42, v243
    v_mul_f32 v43, v43, v243
    v_mul_f32 v44, v44, v243
    v_mul_f32 v45, v45, v243
    v_mul_f32 v46, v46, v243
    v_mul_f32 v47, v47, v243
    v_mul_f32 v48, v48, v243
    v_mul_f32 v49, v49, v243
    v_mul_f32 v50, v50, v243
    v_mul_f32 v51, v51, v243
    v_mul_f32 v52, v52, v243
    v_mul_f32 v53, v53, v243
    v_mul_f32 v54, v54, v243
    v_mul_f32 v55, v55, v243
    v_mul_f32 v56, v56, v243
    v_mul_f32 v57, v57, v243
    v_mul_f32 v58, v58, v243
    v_mul_f32 v59, v59, v243
    v_mul_f32 v60, v60, v243
    v_mul_f32 v61, v61, v243
    v_mul_f32 v62, v62, v243
    v_mul_f32 v63, v63, v243
    s_mov_b32 s72, 0
    s_nop 7
    s_branch L_back2_13
L_rare1_14:
    s_nop 4
    v_mul_f32 v239, s73, v238
    v_max_f32 v239, v239, v240
    v_sub_f32 v243, v240, v239
    v_exp_f32 v243, v243
    v_mov_b32 v240, v239
    s_nop 1
    v_mul_f32 v241, v241, v243
    v_mul_f32 v242, v242, v243
    s_mov_b32 s72, 1
    s_nop 4
    s_branch L_back1_14
L_rare2_14:
    s_nop 15
    s_nop 7
    v_mul_f32 v0, v0, v243
    v_mul_f32 v1, v1, v243
    v_mul_f32 v2, v2, v243
    v_mul_f32 v3, v3, v243
    v_mul_f32 v4, v4, v243
    v_mul_f32 v5, v5, v243
    v_mul_f32 v6, v6, v243
    v_mul_f32 v7, v7, v243
    v_mul_f32 v8, v8, v243
    v_mul_f32 v9, v9, v243
    v_mul_f32 v10, v10, v243
    v_mul_f32 v11, v11, v243
    v_mul_f32 v12, v12, v243
    v_mul_f32 v13, v13, v243
    v_mul_f32 v14, v14, v243
    v_mul_f32 v15, v15, v243
    v_mul_f32 v16, v16, v243
    v_mul_f32 v17, v17, v243
    v_mul_f32 v18, v18, v243
    v_mul_f32 v19, v19, v243
    v_mul_f32 v20, v20, v243
    v_mul_f32 v21, v21, v243
    v_mul_f32 v22, v22, v243
    v_mul_f32 v23, v23, v243
    v_mul_f32 v24, v24, v243
    v_mul_f32 v25, v25, v243
    v_mul_f32 v26, v26, v243
    v_mul_f32 v27, v27, v243
    v_mul_f32 v28, v28, v243
    v_mul_f32 v29, v29, v243
    v_mul_f32 v30, v30, v243
    v_mul_f32 v31, v31, v243
    v_mul_f32 v32, v32, v243
    v_mul_f32 v33, v33, v243
    v_mul_f32 v34, v34, v243
    v_mul_f32 v35, v35, v243
    v_mul_f32 v36, v36, v243
    v_mul_f32 v37, v37, v243
    v_mul_f32 v38, v38, v243
    v_mul_f32 v39, v39, v243
    v_mul_f32 v40, v40, v243
    v_mul_f32 v41, v41, v243
    v_mul_f32 v42, v42, v243
    v_mul_f32 v43, v43, v243
    v_mul_f32 v44, v44, v243
    v_mul_f32 v45, v45, v243
    v_mul_f32 v46, v46, v243
    v_mul_f32 v47, v47, v243
    v_mul_f32 v48, v48, v243
    v_mul_f32 v49, v49, v243
    v_mul_f32 v50, v50, v243
    v_mul_f32 v51, v51, v243
    v_mul_f32 v52, v52, v243
    v_mul_f32 v53, v53, v243
    v_mul_f32 v54, v54, v243
    v_mul_f32 v55, v55, v243
    v_mul_f32 v56, v56, v243
    v_mul_f32 v57, v57, v243
    v_mul_f32 v58, v58, v243
    v_mul_f32 v59, v59, v243
    v_mul_f32 v60, v60, v243
    v_mul_f32 v61, v61, v243
    v_mul_f32 v62, v62, v243
    v_mul_f32 v63, v63, v243
    s_mov_b32 s72, 0
    s_nop 7
    s_branch L_back2_14
L_rare1_15:
    s_nop 4
    v_mul_f32 v239, s73, v238
    v_max_f32 v239, v239, v240
    v_sub_f32 v243, v240, v239
    v_exp_f32 v243, v243
    v_mov_b32 v240, v239
    s_nop 1
    v_mul_f32 v241, v241, v243
    v_mul_f32 v242, v242, v243
    s_mov_b32 s72, 1
    s_nop 4
    s_branch L_back1_15
L_rare2_15:
    s_nop 15
    s_nop 7
    v_mul_f32 v0, v0, v243
    v_mul_f32 v1, v1, v243
    v_mul_f32 v2, v2, v243
    v_mul_f32 v3, v3, v243
    v_mul_f32 v4, v4, v243
    v_mul_f32 v5, v5, v243
    v_mul_f32 v6, v6, v243
    v_mul_f32 v7, v7, v243
    v_mul_f32 v8, v8, v243
    v_mul_f32 v9, v9, v243
    v_mul_f32 v10, v10, v243
    v_mul_f32 v11, v11, v243
    v_mul_f32 v12, v12, v243
    v_mul_f32 v13, v13, v243
    v_mul_f32 v14, v14, v243
    v_mul_f32 v15, v15, v243
    v_mul_f32 v16, v16, v243
    v_mul_f32 v17, v17, v243
    v_mul_f32 v18, v18, v243
    v_mul_f32 v19, v19, v243
    v_mul_f32 v20, v20, v243
    v_mul_f32 v21, v21, v243
    v_mul_f32 v22, v22, v243
    v_mul_f32 v23, v23, v243
    v_mul_f32 v24, v24, v243
    v_mul_f32 v25, v25, v243
    v_mul_f32 v26, v26, v243
    v_mul_f32 v27, v27, v243
    v_mul_f32 v28, v28, v243
    v_mul_f32 v29, v29, v243
    v_mul_f32 v30, v30, v243
    v_mul_f32 v31, v31, v243
    v_mul_f32 v32, v32, v243
    v_mul_f32 v33, v33, v243
    v_mul_f32 v34, v34, v243
    v_mul_f32 v35, v35, v243
    v_mul_f32 v36, v36, v243
    v_mul_f32 v37, v37, v243
    v_mul_f32 v38, v38, v243
    v_mul_f32 v39, v39, v243
    v_mul_f32 v40, v40, v243
    v_mul_f32 v41, v41, v243
    v_mul_f32 v42, v42, v243
    v_mul_f32 v43, v43, v243
    v_mul_f32 v44, v44, v243
    v_mul_f32 v45, v45, v243
    v_mul_f32 v46, v46, v243
    v_mul_f32 v47, v47, v243
    v_mul_f32 v48, v48, v243
    v_mul_f32 v49, v49, v243
    v_mul_f32 v50, v50, v243
    v_mul_f32 v51, v51, v243
    v_mul_f32 v52, v52, v243
    v_mul_f32 v53, v53, v243
    v_mul_f32 v54, v54, v243
    v_mul_f32 v55, v55, v243
    v_mul_f32 v56, v56, v243
    v_mul_f32 v57, v57, v243
    v_mul_f32 v58, v58, v243
    v_mul_f32 v59, v59, v243
    v_mul_f32 v60, v60, v243
    v_mul_f32 v61, v61, v243
    v_mul_f32 v62, v62, v243
    v_mul_f32 v63, v63, v243
    s_mov_b32 s72, 0
    s_nop 7
    s_branch L_back2_15
.globl reduce_kernel
.p2align 8
.type reduce_kernel,@function
reduce_kernel:
    s_cmp_ge_u32 s2, 1024
    s_cbranch_scc1 L_k2_end
    s_load_dwordx2 s[4:5], s[0:1], 80
    s_load_dwordx2 s[8:9], s[0:1], 96
    s_and_b32 s12, s2, 7
    s_lshl_b32 s12, s12, 1
    s_lshr_b32 s13, s2, 9
    s_add_u32 s12, s12, s13
    s_bfe_u32 s13, s2, 0x30003
    s_bfe_u32 s14, s2, 0x30006
    s_sub_u32 s14, 7, s14
    s_lshl_b32 s15, s12, 22
    s_lshl_b32 s16, s13, 15
    s_add_u32 s15, s15, s16
    s_lshl_b32 s16, s14, 12
    s_add_u32 s15, s15, s16
    v_lshlrev_b32 v1, 4, v0
    v_and_b32 v2, 31, v0
    s_lshl_b32 s16, s13, 5
    v_add_u32 v2, s16, v2
    v_mov_b32 v6, 0x40000000
    v_cmp_gt_u32 vcc, 240, v2
    s_waitcnt lgkmcnt(0)
    s_mov_b32 s6, 3932160
    s_mov_b32 s7, 0x20000
    s_mov_b32 s10, 67108864
    s_mov_b32 s11, 0x20000
    v_cndmask_b32 v1, v6, v1, vcc
    buffer_load_dwordx4 v[8:11], v1, s[8:11], s15 offen
    s_add_u32 s15, s15, 0x40000
    buffer_load_dwordx4 v[12:15], v1, s[8:11], s15 offen
    s_add_u32 s15, s15, 0x40000
    buffer_load_dwordx4 v[16:19], v1, s[8:11], s15 offen
    s_add_u32 s15, s15, 0x40000
    buffer_load_dwordx4 v[20:23], v1, s[8:11], s15 offen
    s_add_u32 s15, s15, 0x40000
    buffer_load_dwordx4 v[24:27], v1, s[8:11], s15 offen
    s_add_u32 s15, s15, 0x40000
    buffer_load_dwordx4 v[28:31], v1, s[8:11], s15 offen
    s_add_u32 s15, s15, 0x40000
    buffer_load_dwordx4 v[32:35], v1, s[8:11], s15 offen
    s_add_u32 s15, s15, 0x40000
    buffer_load_dwordx4 v[36:39], v1, s[8:11], s15 offen
    s_add_u32 s15, s15, 0x40000
    buffer_load_dwordx4 v[40:43], v1, s[8:11], s15 offen
    s_add_u32 s15, s15, 0x40000
    buffer_load_dwordx4 v[44:47], v1, s[8:11], s15 offen
    s_add_u32 s15, s15, 0x40000
    buffer_load_dwordx4 v[48:51], v1, s[8:11], s15 offen
    s_add_u32 s15, s15, 0x40000
    buffer_load_dwordx4 v[52:55], v1, s[8:11], s15 offen
    s_add_u32 s15, s15, 0x40000
    buffer_load_dwordx4 v[56:59], v1, s[8:11], s15 offen
    s_add_u32 s15, s15, 0x40000
    buffer_load_dwordx4 v[60:63], v1, s[8:11], s15 offen
    s_add_u32 s15, s15, 0x40000
    buffer_load_dwordx4 v[64:67], v1, s[8:11], s15 offen
    s_add_u32 s15, s15, 0x40000
    buffer_load_dwordx4 v[68:71], v1, s[8:11], s15 offen
    v_bfe_u32 v3, v0, 5, 1
    v_lshrrev_b32 v4, 6, v0
    v_lshlrev_b32 v5, 11, v2
    v_lshl_add_u32 v5, v4, 5, v5
    v_lshl_add_u32 v5, v3, 4, v5
    s_and_b32 s16, s12, 7
    s_mul_i32 s16, s16, 491520
    s_lshr_b32 s17, s12, 3
    s_lshl_b32 s17, s17, 10
    s_add_u32 s16, s16, s17
    s_lshl_b32 s17, s14, 7
    s_add_u32 s16, s16, s17
    v_cndmask_b32 v5, v6, v5, vcc
    s_waitcnt vmcnt(15)
    v_lshlrev_b32 v72, 16, v8
    v_and_b32 v73, 0xffff0000, v8
    v_lshlrev_b32 v74, 16, v9
    v_and_b32 v75, 0xffff0000, v9
    v_lshlrev_b32 v76, 16, v10
    v_and_b32 v77, 0xffff0000, v10
    v_lshlrev_b32 v78, 16, v11
    v_and_b32 v79, 0xffff0000, v11
    s_waitcnt vmcnt(14)
    v_lshlrev_b32 v80, 16, v12
    v_and_b32 v81, 0xffff0000, v12
    v_add_f32 v72, v72, v80
    v_add_f32 v73, v73, v81
    v_lshlrev_b32 v80, 16, v13
    v_and_b32 v81, 0xffff0000, v13
    v_add_f32 v74, v74, v80
    v_add_f32 v75, v75, v81
    v_lshlrev_b32 v80, 16, v14
    v_and_b32 v81, 0xffff0000, v14
    v_add_f32 v76, v76, v80
    v_add_f32 v77, v77, v81
    v_lshlrev_b32 v80, 16, v15
    v_and_b32 v81, 0xffff0000, v15
    v_add_f32 v78, v78, v80
    v_add_f32 v79, v79, v81
    s_waitcnt vmcnt(13)
    v_lshlrev_b32 v80, 16, v16
    v_and_b32 v81, 0xffff0000, v16
    v_add_f32 v72, v72, v80
    v_add_f32 v73, v73, v81
    v_lshlrev_b32 v80, 16, v17
    v_and_b32 v81, 0xffff0000, v17
    v_add_f32 v74, v74, v80
    v_add_f32 v75, v75, v81
    v_lshlrev_b32 v80, 16, v18
    v_and_b32 v81, 0xffff0000, v18
    v_add_f32 v76, v76, v80
    v_add_f32 v77, v77, v81
    v_lshlrev_b32 v80, 16, v19
    v_and_b32 v81, 0xffff0000, v19
    v_add_f32 v78, v78, v80
    v_add_f32 v79, v79, v81
    s_waitcnt vmcnt(12)
    v_lshlrev_b32 v80, 16, v20
    v_and_b32 v81, 0xffff0000, v20
    v_add_f32 v72, v72, v80
    v_add_f32 v73, v73, v81
    v_lshlrev_b32 v80, 16, v21
    v_and_b32 v81, 0xffff0000, v21
    v_add_f32 v74, v74, v80
    v_add_f32 v75, v75, v81
    v_lshlrev_b32 v80, 16, v22
    v_and_b32 v81, 0xffff0000, v22
    v_add_f32 v76, v76, v80
    v_add_f32 v77, v77, v81
    v_lshlrev_b32 v80, 16, v23
    v_and_b32 v81, 0xffff0000, v23
    v_add_f32 v78, v78, v80
    v_add_f32 v79, v79, v81
    s_waitcnt vmcnt(11)
    v_lshlrev_b32 v80, 16, v24
    v_and_b32 v81, 0xffff0000, v24
    v_add_f32 v72, v72, v80
    v_add_f32 v73, v73, v81
    v_lshlrev_b32 v80, 16, v25
    v_and_b32 v81, 0xffff0000, v25
    v_add_f32 v74, v74, v80
    v_add_f32 v75, v75, v81
    v_lshlrev_b32 v80, 16, v26
    v_and_b32 v81, 0xffff0000, v26
    v_add_f32 v76, v76, v80
    v_add_f32 v77, v77, v81
    v_lshlrev_b32 v80, 16, v27
    v_and_b32 v81, 0xffff0000, v27
    v_add_f32 v78, v78, v80
    v_add_f32 v79, v79, v81
    s_waitcnt vmcnt(10)
    v_lshlrev_b32 v80, 16, v28
    v_and_b32 v81, 0xffff0000, v28
    v_add_f32 v72, v72, v80
    v_add_f32 v73, v73, v81
    v_lshlrev_b32 v80, 16, v29
    v_and_b32 v81, 0xffff0000, v29
    v_add_f32 v74, v74, v80
    v_add_f32 v75, v75, v81
    v_lshlrev_b32 v80, 16, v30
    v_and_b32 v81, 0xffff0000, v30
    v_add_f32 v76, v76, v80
    v_add_f32 v77, v77, v81
    v_lshlrev_b32 v80, 16, v31
    v_and_b32 v81, 0xffff0000, v31
    v_add_f32 v78, v78, v80
    v_add_f32 v79, v79, v81
    s_waitcnt vmcnt(9)
    v_lshlrev_b32 v80, 16, v32
    v_and_b32 v81, 0xffff0000, v32
    v_add_f32 v72, v72, v80
    v_add_f32 v73, v73, v81
    v_lshlrev_b32 v80, 16, v33
    v_and_b32 v81, 0xffff0000, v33
    v_add_f32 v74, v74, v80
    v_add_f32 v75, v75, v81
    v_lshlrev_b32 v80, 16, v34
    v_and_b32 v81, 0xffff0000, v34
    v_add_f32 v76, v76, v80
    v_add_f32 v77, v77, v81
    v_lshlrev_b32 v80, 16, v35
    v_and_b32 v81, 0xffff0000, v35
    v_add_f32 v78, v78, v80
    v_add_f32 v79, v79, v81
    s_waitcnt vmcnt(8)
    v_lshlrev_b32 v80, 16, v36
    v_and_b32 v81, 0xffff0000, v36
    v_add_f32 v72, v72, v80
    v_add_f32 v73, v73, v81
    v_lshlrev_b32 v80, 16, v37
    v_and_b32 v81, 0xffff0000, v37
    v_add_f32 v74, v74, v80
    v_add_f32 v75, v75, v81
    v_lshlrev_b32 v80, 16, v38
    v_and_b32 v81, 0xffff0000, v38
    v_add_f32 v76, v76, v80
    v_add_f32 v77, v77, v81
    v_lshlrev_b32 v80, 16, v39
    v_and_b32 v81, 0xffff0000, v39
    v_add_f32 v78, v78, v80
    v_add_f32 v79, v79, v81
    s_waitcnt vmcnt(7)
    v_lshlrev_b32 v80, 16, v40
    v_and_b32 v81, 0xffff0000, v40
    v_add_f32 v72, v72, v80
    v_add_f32 v73, v73, v81
    v_lshlrev_b32 v80, 16, v41
    v_and_b32 v81, 0xffff0000, v41
    v_add_f32 v74, v74, v80
    v_add_f32 v75, v75, v81
    v_lshlrev_b32 v80, 16, v42
    v_and_b32 v81, 0xffff0000, v42
    v_add_f32 v76, v76, v80
    v_add_f32 v77, v77, v81
    v_lshlrev_b32 v80, 16, v43
    v_and_b32 v81, 0xffff0000, v43
    v_add_f32 v78, v78, v80
    v_add_f32 v79, v79, v81
    s_waitcnt vmcnt(6)
    v_lshlrev_b32 v80, 16, v44
    v_and_b32 v81, 0xffff0000, v44
    v_add_f32 v72, v72, v80
    v_add_f32 v73, v73, v81
    v_lshlrev_b32 v80, 16, v45
    v_and_b32 v81, 0xffff0000, v45
    v_add_f32 v74, v74, v80
    v_add_f32 v75, v75, v81
    v_lshlrev_b32 v80, 16, v46
    v_and_b32 v81, 0xffff0000, v46
    v_add_f32 v76, v76, v80
    v_add_f32 v77, v77, v81
    v_lshlrev_b32 v80, 16, v47
    v_and_b32 v81, 0xffff0000, v47
    v_add_f32 v78, v78, v80
    v_add_f32 v79, v79, v81
    s_waitcnt vmcnt(5)
    v_lshlrev_b32 v80, 16, v48
    v_and_b32 v81, 0xffff0000, v48
    v_add_f32 v72, v72, v80
    v_add_f32 v73, v73, v81
    v_lshlrev_b32 v80, 16, v49
    v_and_b32 v81, 0xffff0000, v49
    v_add_f32 v74, v74, v80
    v_add_f32 v75, v75, v81
    v_lshlrev_b32 v80, 16, v50
    v_and_b32 v81, 0xffff0000, v50
    v_add_f32 v76, v76, v80
    v_add_f32 v77, v77, v81
    v_lshlrev_b32 v80, 16, v51
    v_and_b32 v81, 0xffff0000, v51
    v_add_f32 v78, v78, v80
    v_add_f32 v79, v79, v81
    s_waitcnt vmcnt(4)
    v_lshlrev_b32 v80, 16, v52
    v_and_b32 v81, 0xffff0000, v52
    v_add_f32 v72, v72, v80
    v_add_f32 v73, v73, v81
    v_lshlrev_b32 v80, 16, v53
    v_and_b32 v81, 0xffff0000, v53
    v_add_f32 v74, v74, v80
    v_add_f32 v75, v75, v81
    v_lshlrev_b32 v80, 16, v54
    v_and_b32 v81, 0xffff0000, v54
    v_add_f32 v76, v76, v80
    v_add_f32 v77, v77, v81
    v_lshlrev_b32 v80, 16, v55
    v_and_b32 v81, 0xffff0000, v55
    v_add_f32 v78, v78, v80
    v_add_f32 v79, v79, v81
    s_waitcnt vmcnt(3)
    v_lshlrev_b32 v80, 16, v56
    v_and_b32 v81, 0xffff0000, v56
    v_add_f32 v72, v72, v80
    v_add_f32 v73, v73, v81
    v_lshlrev_b32 v80, 16, v57
    v_and_b32 v81, 0xffff0000, v57
    v_add_f32 v74, v74, v80
    v_add_f32 v75, v75, v81
    v_lshlrev_b32 v80, 16, v58
    v_and_b32 v81, 0xffff0000, v58
    v_add_f32 v76, v76, v80
    v_add_f32 v77, v77, v81
    v_lshlrev_b32 v80, 16, v59
    v_and_b32 v81, 0xffff0000, v59
    v_add_f32 v78, v78, v80
    v_add_f32 v79, v79, v81
    s_waitcnt vmcnt(2)
    v_lshlrev_b32 v80, 16, v60
    v_and_b32 v81, 0xffff0000, v60
    v_add_f32 v72, v72, v80
    v_add_f32 v73, v73, v81
    v_lshlrev_b32 v80, 16, v61
    v_and_b32 v81, 0xffff0000, v61
    v_add_f32 v74, v74, v80
    v_add_f32 v75, v75, v81
    v_lshlrev_b32 v80, 16, v62
    v_and_b32 v81, 0xffff0000, v62
    v_add_f32 v76, v76, v80
    v_add_f32 v77, v77, v81
    v_lshlrev_b32 v80, 16, v63
    v_and_b32 v81, 0xffff0000, v63
    v_add_f32 v78, v78, v80
    v_add_f32 v79, v79, v81
    s_waitcnt vmcnt(1)
    v_lshlrev_b32 v80, 16, v64
    v_and_b32 v81, 0xffff0000, v64
    v_add_f32 v72, v72, v80
    v_add_f32 v73, v73, v81
    v_lshlrev_b32 v80, 16, v65
    v_and_b32 v81, 0xffff0000, v65
    v_add_f32 v74, v74, v80
    v_add_f32 v75, v75, v81
    v_lshlrev_b32 v80, 16, v66
    v_and_b32 v81, 0xffff0000, v66
    v_add_f32 v76, v76, v80
    v_add_f32 v77, v77, v81
    v_lshlrev_b32 v80, 16, v67
    v_and_b32 v81, 0xffff0000, v67
    v_add_f32 v78, v78, v80
    v_add_f32 v79, v79, v81
    s_waitcnt vmcnt(0)
    v_lshlrev_b32 v80, 16, v68
    v_and_b32 v81, 0xffff0000, v68
    v_add_f32 v72, v72, v80
    v_add_f32 v73, v73, v81
    v_lshlrev_b32 v80, 16, v69
    v_and_b32 v81, 0xffff0000, v69
    v_add_f32 v74, v74, v80
    v_add_f32 v75, v75, v81
    v_lshlrev_b32 v80, 16, v70
    v_and_b32 v81, 0xffff0000, v70
    v_add_f32 v76, v76, v80
    v_add_f32 v77, v77, v81
    v_lshlrev_b32 v80, 16, v71
    v_and_b32 v81, 0xffff0000, v71
    v_add_f32 v78, v78, v80
    v_add_f32 v79, v79, v81
    v_cvt_pk_bf16_f32 v84, v72, v73
    v_cvt_pk_bf16_f32 v85, v74, v75
    v_cvt_pk_bf16_f32 v86, v76, v77
    v_cvt_pk_bf16_f32 v87, v78, v79
    buffer_store_dwordx4 v[84:87], v5, s[4:7], s16 offen
L_k2_end:
    s_endpgm
.section .rodata,"a"
.p2align 6
.amdhsa_kernel attn_kernel
  .amdhsa_next_free_vgpr 256
  .amdhsa_next_free_sgpr 102
  .amdhsa_accum_offset 256
  .amdhsa_group_segment_fixed_size 0
  .amdhsa_kernarg_size 104
  .amdhsa_user_sgpr_count 2
  .amdhsa_user_sgpr_kernarg_segment_ptr 1
  .amdhsa_system_sgpr_workgroup_id_x 1
.end_amdhsa_kernel
.p2align 6
.amdhsa_kernel reduce_kernel
  .amdhsa_next_free_vgpr 88
  .amdhsa_next_free_sgpr 32
  .amdhsa_accum_offset 88
  .amdhsa_group_segment_fixed_size 0
  .amdhsa_kernarg_size 104
  .amdhsa_user_sgpr_count 2
  .amdhsa_user_sgpr_kernarg_segment_ptr 1
  .amdhsa_system_sgpr_workgroup_id_x 1
.end_amdhsa_kernel
```
